```python
import torch

def _softmax(x, axis=-1):
    return torch.softmax(x, dim=axis)
def _gelu(x):
    return torch.nn.functional.gelu(x, approximate="tanh")
def _silu(x):
    return torch.nn.functional.silu(x)
def _sigmoid(x):
    return torch.sigmoid(x)
def _layernorm(x, axis=-1, eps=1e-5):
    m = x.mean(dim=axis, keepdim=True)
    v = x.var(dim=axis, keepdim=True, unbiased=False)
    return (x - m) / torch.sqrt(v + eps)
def _scatter_add(tgt, idx, src, axis=0):
    return tgt.clone().index_add_(axis, idx, src)
def _segment_sum(src, seg, n):
    out = torch.zeros((n,) + src.shape[1:], dtype=src.dtype)
    return out.index_add_(0, seg, src)
def _pad(x, pw):
    flat = tuple(v for pair in reversed(pw) for v in pair)
    return torch.nn.functional.pad(x, flat)

kernel_name = 'recurrent_scan__mha_block__swiglu_ffn__prompt'

def setup_inputs():

    _w = (lambda a: (lambda t: t.to(torch.bfloat16) if t.is_floating_point() else t)(torch.as_tensor(a)))
    def _A_setup():
        B, S, D, H = 1, 2048, 512, 32
        return {
            "x": _w((lambda *s: torch.randn(*s, dtype=torch.bfloat16) * 0.05)(B, S, D)),
            "wqkv": _w((lambda *s: torch.randn(*s, dtype=torch.bfloat16) * 0.05)(D, 3 * D)),
            "wo": _w((lambda *s: torch.randn(*s, dtype=torch.bfloat16) * 0.05)(D, D)),
        }
    _A_in = _A_setup()

    def _B_setup():
        B, S, D, F = 1, 2048, 512, 1376
        return {
            "x": _w((lambda *s: torch.randn(*s, dtype=torch.bfloat16) * 0.05)(B, S, D)),
            "w_gate": _w((lambda *s: torch.randn(*s, dtype=torch.bfloat16) * 0.05)(D, F)),
            "w_up": _w((lambda *s: torch.randn(*s, dtype=torch.bfloat16) * 0.05)(D, F)),
            "w_down": _w((lambda *s: torch.randn(*s, dtype=torch.bfloat16) * 0.05)(F, D)),
        }
    _B_in = _B_setup()

    return {
        "A_x": _A_in["x"],
        "A_wqkv": _A_in["wqkv"],
        "A_wo": _A_in["wo"],
        "B_x": _B_in["x"],
        "B_w_gate": _B_in["w_gate"],
        "B_w_up": _B_in["w_up"],
        "B_w_down": _B_in["w_down"],
    }

def reference(A_x, A_wqkv, A_wo, B_x, B_w_gate, B_w_up, B_w_down):
    def _A_ref(x, wqkv, wo):
        B, S, D = x.shape
        H = 32
        Dh = D // H
        qkv = (lambda x, *d: x.permute(*d))((x @ wqkv).reshape(B, S, 3, H, Dh), 2, 0, 3, 1, 4)
        q, k, v = qkv[0], qkv[1], qkv[2]
        scores = torch.einsum("bhqd,bhkd->bhqk", q, k) * (Dh ** -0.5)
        p = _softmax(scores, axis=-1)
        o = torch.einsum("bhqk,bhkd->bhqd", p, v)
        return (lambda x, *d: x.permute(*d))(o, 0, 2, 1, 3).reshape(B, S, D) @ wo

    def _B_ref(x, w_gate, w_up, w_down):
        g = _silu(x @ w_gate)
        u = x @ w_up
        return (g * u) @ w_down

    x = A_x
    xn = _layernorm(x, axis=-1)
    s = _A_ref(xn, A_wqkv, A_wo)
    g = _silu(_B_ref(xn, B_w_gate, B_w_up, B_w_down))
    return x + s * g
```

```asm
; @launch grid=(256,1,1) block=(512,1,1) lds=163840
.amdgcn_target "amdgcn-amd-amdhsa--gfx950"
.text
.globl recurrent_scan__mha_block__swiglu_ffn__prompt_kernel
.p2align 8
.type recurrent_scan__mha_block__swiglu_ffn__prompt_kernel,@function
recurrent_scan__mha_block__swiglu_ffn__prompt_kernel:
PK_start:
    s_cmp_ge_u32 s2, 256
    s_cbranch_scc1 PK_end
    s_load_dwordx16 s[4:19], s[0:1], 0
    s_load_dwordx4 s[20:23], s[0:1], 64
    v_lshrrev_b32 v1, 6, v0
    v_and_b32 v0, 63, v0
    s_and_b32 s32, s2, 7
    s_lshr_b32 s33, s2, 3
    v_readfirstlane_b32 s24, v1
    s_and_b32 s25, s32, 3
    s_lshl_b32 s25, s25, 2
    s_and_b32 s34, s33, 3
    s_add_u32 s25, s25, s34
    s_lshr_b32 s26, s32, 2
    s_lshl_b32 s26, s26, 3
    s_lshr_b32 s35, s33, 2
    s_add_u32 s26, s26, s35
    s_lshl_b32 s34, s34, 1
    s_add_u32 s29, s34, s35
    s_and_b32 s29, s29, 7
    s_lshl_b32 s27, s32, 2
    s_lshr_b32 s34, s33, 3
    s_add_u32 s27, s27, s34
    s_and_b32 s28, s33, 7
    s_and_b32 s63, s24, 1
    s_lshr_b32 s31, s24, 1
    s_mov_b32 s60, 0xffff0000
    s_mov_b32 s61, 0xbfb8aa3b
    s_mov_b32 s62, 0x3f803f80
    s_mov_b32 s96, 0xffff
    s_mov_b32 s97, 0xffff
    s_xor_b32 s3, s26, 0
    s_mul_i32 s100, s26, 3
    s_lshl_b32 s32, 1, s26
    s_sub_u32 s33, s32, 1
    s_and_b32 s33, s33, 0xa888
    s_bcnt1_i32_b32 s33, s33
    s_sub_u32 s100, s100, s33
    s_and_b32 s32, s32, 0xa888
    s_cselect_b32 s101, 2, 3
    s_cmp_ge_u32 s24, 4
    s_cbranch_scc1 PK_loader
    s_setprio 2
    v_mov_b32 v64, v0
    s_lshl_b32 s30, s25, 2
    s_add_u32 s30, s30, s24
    s_lshl_b32 s32, s30, 15
    s_mul_i32 s33, s24, 24576
    s_add_u32 s33, s33, 49664
    s_lshl_b32 s34, s29, 7
    v_lshrrev_b32 v33, 3, v64
    v_lshlrev_b32 v33, 10, v33
    v_and_b32 v34, 7, v64
    v_lshrrev_b32 v35, 4, v64
    v_add_u32 v35, 2, v35
    v_xor_b32 v34, v34, v35
    v_lshl_add_u32 v36, v34, 4, v33
    v_xor_b32 v37, 64, v36
    v_add_u32 v37, 7168, v37
    v_add_u32 v38, 14336, v36
    v_add_u32 v39, 14336, v37
    s_cmp_lg_u32 s24, 0
    s_cbranch_scc1 PK_nopf
    s_getpc_b64 s[52:53]
PK_pc:
    s_lshr_b32 s35, s2, 3
    s_and_b32 s35, s35, 15
    s_mul_i32 s35, s35, (PK_codeend-PK_start+16*128-1)/(16*128)
    v_add_u32 v48, s35, v64
    v_lshlrev_b32 v48, 7, v48
    v_min_u32 v48, PK_codeend-PK_start-4, v48
    s_sub_u32 s52, s52, PK_pc-PK_start
    s_subb_u32 s53, s53, 0
    v_mov_b32 v49, s53
    v_add_co_u32 v48, vcc, s52, v48
    s_mov_b32 exec_hi, 0
    s_nop 0
    v_addc_co_u32 v49, vcc, 0, v49, vcc
    global_load_dword v58, v[48:49], off
    s_mov_b64 exec, -1
PK_nopf:
    s_waitcnt lgkmcnt(0)
    s_mov_b32 s44, s4
    s_and_b32 s45, s5, 0xffff
    s_mov_b32 s46, 2097152
    s_mov_b32 s47, 0x20000
    s_add_u32 m0, s33, 0
    s_add_u32 s35, s32, s34
    buffer_load_dwordx4 v36, s[44:47], s35 offen offset:0 lds
    buffer_load_dwordx4 v37, s[44:47], s35 offen offset:1024 lds
    buffer_load_dwordx4 v38, s[44:47], s35 offen offset:2048 lds
    buffer_load_dwordx4 v39, s[44:47], s35 offen offset:3072 lds
    s_add_u32 s34, s34, 128
    s_and_b32 s34, s34, 0x380
    s_mov_b32 s48, s6
    s_and_b32 s49, s7, 0xffff
    s_mov_b32 s50, 1572864
    s_mov_b32 s51, 0x20000
    s_lshl_b32 s35, s29, 2
    s_lshl_b32 s36, s24, 1
    s_add_u32 s35, s35, s36
    v_bfe_u32 v48, v64, 3, 1
    v_add_u32 v48, s35, v48
    v_and_b32 v48, 31, v48
    v_lshlrev_b32 v48, 4, v48
    s_lshr_b32 s36, s25, 2
    s_lshl_b32 s36, s36, 2
    v_bfe_u32 v49, v64, 1, 2
    v_add3_u32 v48, v48, v49, s36
    v_and_b32 v49, 1, v64
    v_lshlrev_b32 v49, 7, v49
    s_mul_i32 s35, s3, 192
    v_mul_u32_u24 v48, 3072, v48
    v_add_u32 v48, v48, v49
    s_mov_b64 exec, 0xffff
    buffer_load_dword v56, v48, s[48:51], s35 offen
    s_mov_b64 exec, -1
    s_add_u32 m0, s33, 4096
    s_add_u32 s35, s32, s34
    buffer_load_dwordx4 v36, s[44:47], s35 offen offset:0 lds
    buffer_load_dwordx4 v37, s[44:47], s35 offen offset:1024 lds
    buffer_load_dwordx4 v38, s[44:47], s35 offen offset:2048 lds
    buffer_load_dwordx4 v39, s[44:47], s35 offen offset:3072 lds
    s_add_u32 s34, s34, 128
    s_and_b32 s34, s34, 0x380
    s_add_u32 m0, s33, 8192
    s_add_u32 s35, s32, s34
    buffer_load_dwordx4 v36, s[44:47], s35 offen offset:0 lds
    buffer_load_dwordx4 v37, s[44:47], s35 offen offset:1024 lds
    buffer_load_dwordx4 v38, s[44:47], s35 offen offset:2048 lds
    buffer_load_dwordx4 v39, s[44:47], s35 offen offset:3072 lds
    s_add_u32 s34, s34, 128
    s_and_b32 s34, s34, 0x380
    s_add_u32 m0, s33, 12288
    s_add_u32 s35, s32, s34
    buffer_load_dwordx4 v36, s[44:47], s35 offen offset:0 lds
    buffer_load_dwordx4 v37, s[44:47], s35 offen offset:1024 lds
    buffer_load_dwordx4 v38, s[44:47], s35 offen offset:2048 lds
    buffer_load_dwordx4 v39, s[44:47], s35 offen offset:3072 lds
    s_add_u32 s34, s34, 128
    s_and_b32 s34, s34, 0x380
    s_add_u32 m0, s33, 16384
    s_add_u32 s35, s32, s34
    buffer_load_dwordx4 v36, s[44:47], s35 offen offset:0 lds
    buffer_load_dwordx4 v37, s[44:47], s35 offen offset:1024 lds
    buffer_load_dwordx4 v38, s[44:47], s35 offen offset:2048 lds
    buffer_load_dwordx4 v39, s[44:47], s35 offen offset:3072 lds
    s_add_u32 s34, s34, 128
    s_and_b32 s34, s34, 0x380
    s_add_u32 m0, s33, 20480
    s_add_u32 s35, s32, s34
    buffer_load_dwordx4 v36, s[44:47], s35 offen offset:0 lds
    buffer_load_dwordx4 v37, s[44:47], s35 offen offset:1024 lds
    buffer_load_dwordx4 v38, s[44:47], s35 offen offset:2048 lds
    buffer_load_dwordx4 v39, s[44:47], s35 offen offset:3072 lds
    s_add_u32 s34, s34, 128
    s_and_b32 s34, s34, 0x380
    s_mov_b32 s40, s22
    s_and_b32 s41, s23, 0xffff
    s_mov_b32 s42, 16777216
    s_mov_b32 s43, 0x20000
    s_mov_b32 s52, s20
    s_and_b32 s53, s21, 0xffff
    s_mov_b32 s54, 256
    s_mov_b32 s55, 0x20000
    v_and_b32 v33, 15, v64
    v_lshlrev_b32 v34, 7, v33
    v_lshrrev_b32 v35, 1, v33
    v_add_u32 v35, 2, v35
    v_and_b32 v35, 7, v35
    v_bfe_u32 v33, v64, 4, 1
    v_lshlrev_b32 v33, 1, v33
    v_xor_b32 v35, v35, v33
    v_lshrrev_b32 v33, 5, v64
    v_xor_b32 v35, v35, v33
    v_lshl_add_u32 v34, v35, 4, v34
    v_add_u32 v40, s33, v34
    v_xor_b32 v41, 64, v40
    v_mov_b32 v44, 0
    v_mov_b32 v45, 0
    v_mov_b32 v46, 0
    v_mov_b32 v47, 0
    v_mov_b32 v48, 0
    v_mov_b32 v49, 0
    v_mov_b32 v50, 0
    v_mov_b32 v51, 0
    s_mul_i32 s35, s3, 3
    s_lshl_b32 s93, s35, 17
    s_lshl_b32 s36, s30, 10
    s_add_u32 s93, s93, s36
    s_mul_i32 s94, s24, 2560
    s_add_u32 s94, s94, 148992
    s_lshl_b32 s95, s3, 8
    s_lshl_b32 s36, s30, 2
    s_add_u32 s95, s95, s36
    s_add_u32 s95, s95, 16252928
    s_lshr_b32 s36, s30, 4
    s_mul_i32 s88, s36, 1409024
    s_and_b32 s36, s30, 15
    s_lshl_b32 s36, s36, 10
    s_add_u32 s88, s88, s36
    s_add_u32 s88, s88, 10485760
    s_lshl_b32 s36, s100, 15
    s_add_u32 s88, s88, s36
    s_cmp_lt_u32 s35, 16
    s_cselect_b32 s90, 0x3eb8aa3b, 1.0
    s_cmp_lt_u32 s35, 15
    s_cselect_b32 s91, 0x3eb8aa3b, 1.0
    s_cmp_lt_u32 s35, 14
    s_cselect_b32 s92, 0x3eb8aa3b, 1.0
    v_lshrrev_b32 v33, 5, v64
    v_bfe_u32 v34, v64, 2, 2
    v_lshl_add_u32 v33, v33, 3, v34
    v_mul_u32_u24 v0, 192, v33
    v_bfe_u32 v33, v64, 4, 1
    v_mul_u32_u24 v33, 3104, v33
    v_and_b32 v34, 3, v64
    v_lshl_add_u32 v34, v34, 3, v33
    v_add_u32 v0, v0, v34
    v_add_u32 v1, 49664, v0
    v_add_u32 v2, 99328, v0
    s_waitcnt vmcnt(21)
    ds_read_b128 v[128:131], v40 offset:0
    ds_read_b128 v[132:135], v40 offset:2048
    ds_read_b128 v[136:139], v41 offset:0
    ds_read_b128 v[140:143], v41 offset:2048
    s_waitcnt vmcnt(16)
    ds_read_b128 v[144:147], v40 offset:4096
    ds_read_b128 v[148:151], v40 offset:6144
    ds_read_b128 v[152:155], v41 offset:4096
    ds_read_b128 v[156:159], v41 offset:6144
    s_waitcnt lgkmcnt(4)
    s_add_u32 m0, s33, 0
    s_add_u32 s35, s32, s34
    buffer_load_dwordx4 v36, s[44:47], s35 offen offset:0 lds
    buffer_load_dwordx4 v37, s[44:47], s35 offen offset:1024 lds
    buffer_load_dwordx4 v38, s[44:47], s35 offen offset:2048 lds
    buffer_load_dwordx4 v39, s[44:47], s35 offen offset:3072 lds
    s_add_u32 s34, s34, 128
    s_and_b32 s34, s34, 0x380
    v_dot2c_f32_bf16 v44, s62, v128
    v_dot2c_f32_bf16 v46, v128, v128
    v_dot2c_f32_bf16 v45, s62, v132
    v_dot2c_f32_bf16 v47, v132, v132
    v_dot2c_f32_bf16 v48, s62, v136
    v_dot2c_f32_bf16 v50, v136, v136
    v_dot2c_f32_bf16 v49, s62, v140
    v_dot2c_f32_bf16 v51, v140, v140
    v_dot2c_f32_bf16 v44, s62, v129
    v_dot2c_f32_bf16 v46, v129, v129
    v_dot2c_f32_bf16 v45, s62, v133
    v_dot2c_f32_bf16 v47, v133, v133
    v_dot2c_f32_bf16 v48, s62, v137
    v_dot2c_f32_bf16 v50, v137, v137
    v_dot2c_f32_bf16 v49, s62, v141
    v_dot2c_f32_bf16 v51, v141, v141
    v_dot2c_f32_bf16 v44, s62, v130
    v_dot2c_f32_bf16 v46, v130, v130
    v_dot2c_f32_bf16 v45, s62, v134
    v_dot2c_f32_bf16 v47, v134, v134
    v_dot2c_f32_bf16 v48, s62, v138
    v_dot2c_f32_bf16 v50, v138, v138
    v_dot2c_f32_bf16 v49, s62, v142
    v_dot2c_f32_bf16 v51, v142, v142
    v_dot2c_f32_bf16 v44, s62, v131
    v_dot2c_f32_bf16 v46, v131, v131
    v_dot2c_f32_bf16 v45, s62, v135
    v_dot2c_f32_bf16 v47, v135, v135
    v_dot2c_f32_bf16 v48, s62, v139
    v_dot2c_f32_bf16 v50, v139, v139
    v_dot2c_f32_bf16 v49, s62, v143
    v_dot2c_f32_bf16 v51, v143, v143
    s_waitcnt vmcnt(16)
    ds_read_b128 v[160:163], v40 offset:8192
    ds_read_b128 v[164:167], v40 offset:10240
    ds_read_b128 v[168:171], v41 offset:8192
    ds_read_b128 v[172:175], v41 offset:10240
    s_waitcnt lgkmcnt(4)
    s_add_u32 m0, s33, 4096
    s_add_u32 s35, s32, s34
    buffer_load_dwordx4 v36, s[44:47], s35 offen offset:0 lds
    buffer_load_dwordx4 v37, s[44:47], s35 offen offset:1024 lds
    buffer_load_dwordx4 v38, s[44:47], s35 offen offset:2048 lds
    buffer_load_dwordx4 v39, s[44:47], s35 offen offset:3072 lds
    s_add_u32 s34, s34, 128
    s_and_b32 s34, s34, 0x380
    v_dot2c_f32_bf16 v44, s62, v144
    v_dot2c_f32_bf16 v46, v144, v144
    v_dot2c_f32_bf16 v45, s62, v148
    v_dot2c_f32_bf16 v47, v148, v148
    v_dot2c_f32_bf16 v48, s62, v152
    v_dot2c_f32_bf16 v50, v152, v152
    v_dot2c_f32_bf16 v49, s62, v156
    v_dot2c_f32_bf16 v51, v156, v156
    v_dot2c_f32_bf16 v44, s62, v145
    v_dot2c_f32_bf16 v46, v145, v145
    v_dot2c_f32_bf16 v45, s62, v149
    v_dot2c_f32_bf16 v47, v149, v149
    v_dot2c_f32_bf16 v48, s62, v153
    v_dot2c_f32_bf16 v50, v153, v153
    v_dot2c_f32_bf16 v49, s62, v157
    v_dot2c_f32_bf16 v51, v157, v157
    v_dot2c_f32_bf16 v44, s62, v146
    v_dot2c_f32_bf16 v46, v146, v146
    v_dot2c_f32_bf16 v45, s62, v150
    v_dot2c_f32_bf16 v47, v150, v150
    v_dot2c_f32_bf16 v48, s62, v154
    v_dot2c_f32_bf16 v50, v154, v154
    v_dot2c_f32_bf16 v49, s62, v158
    v_dot2c_f32_bf16 v51, v158, v158
    v_dot2c_f32_bf16 v44, s62, v147
    v_dot2c_f32_bf16 v46, v147, v147
    v_dot2c_f32_bf16 v45, s62, v151
    v_dot2c_f32_bf16 v47, v151, v151
    v_dot2c_f32_bf16 v48, s62, v155
    v_dot2c_f32_bf16 v50, v155, v155
    v_dot2c_f32_bf16 v49, s62, v159
    v_dot2c_f32_bf16 v51, v159, v159
    s_waitcnt vmcnt(16)
    ds_read_b128 v[176:179], v40 offset:12288
    ds_read_b128 v[180:183], v40 offset:14336
    ds_read_b128 v[184:187], v41 offset:12288
    ds_read_b128 v[188:191], v41 offset:14336
    s_waitcnt lgkmcnt(4)
    v_dot2c_f32_bf16 v44, s62, v160
    v_dot2c_f32_bf16 v46, v160, v160
    v_dot2c_f32_bf16 v45, s62, v164
    v_dot2c_f32_bf16 v47, v164, v164
    v_dot2c_f32_bf16 v48, s62, v168
    v_dot2c_f32_bf16 v50, v168, v168
    v_dot2c_f32_bf16 v49, s62, v172
    v_dot2c_f32_bf16 v51, v172, v172
    v_dot2c_f32_bf16 v44, s62, v161
    v_dot2c_f32_bf16 v46, v161, v161
    v_dot2c_f32_bf16 v45, s62, v165
    v_dot2c_f32_bf16 v47, v165, v165
    v_dot2c_f32_bf16 v48, s62, v169
    v_dot2c_f32_bf16 v50, v169, v169
    v_dot2c_f32_bf16 v49, s62, v173
    v_dot2c_f32_bf16 v51, v173, v173
    v_dot2c_f32_bf16 v44, s62, v162
    v_dot2c_f32_bf16 v46, v162, v162
    v_dot2c_f32_bf16 v45, s62, v166
    v_dot2c_f32_bf16 v47, v166, v166
    v_dot2c_f32_bf16 v48, s62, v170
    v_dot2c_f32_bf16 v50, v170, v170
    v_dot2c_f32_bf16 v49, s62, v174
    v_dot2c_f32_bf16 v51, v174, v174
    v_dot2c_f32_bf16 v44, s62, v163
    v_dot2c_f32_bf16 v46, v163, v163
    v_dot2c_f32_bf16 v45, s62, v167
    v_dot2c_f32_bf16 v47, v167, v167
    v_dot2c_f32_bf16 v48, s62, v171
    v_dot2c_f32_bf16 v50, v171, v171
    v_dot2c_f32_bf16 v49, s62, v175
    v_dot2c_f32_bf16 v51, v175, v175
    s_waitcnt vmcnt(12)
    ds_read_b128 v[192:195], v40 offset:16384
    ds_read_b128 v[196:199], v40 offset:18432
    ds_read_b128 v[200:203], v41 offset:16384
    ds_read_b128 v[204:207], v41 offset:18432
    s_waitcnt lgkmcnt(4)
    v_dot2c_f32_bf16 v44, s62, v176
    v_dot2c_f32_bf16 v46, v176, v176
    v_dot2c_f32_bf16 v45, s62, v180
    v_dot2c_f32_bf16 v47, v180, v180
    v_dot2c_f32_bf16 v48, s62, v184
    v_dot2c_f32_bf16 v50, v184, v184
    v_dot2c_f32_bf16 v49, s62, v188
    v_dot2c_f32_bf16 v51, v188, v188
    v_dot2c_f32_bf16 v44, s62, v177
    v_dot2c_f32_bf16 v46, v177, v177
    v_dot2c_f32_bf16 v45, s62, v181
    v_dot2c_f32_bf16 v47, v181, v181
    v_dot2c_f32_bf16 v48, s62, v185
    v_dot2c_f32_bf16 v50, v185, v185
    v_dot2c_f32_bf16 v49, s62, v189
    v_dot2c_f32_bf16 v51, v189, v189
    v_dot2c_f32_bf16 v44, s62, v178
    v_dot2c_f32_bf16 v46, v178, v178
    v_dot2c_f32_bf16 v45, s62, v182
    v_dot2c_f32_bf16 v47, v182, v182
    v_dot2c_f32_bf16 v48, s62, v186
    v_dot2c_f32_bf16 v50, v186, v186
    v_dot2c_f32_bf16 v49, s62, v190
    v_dot2c_f32_bf16 v51, v190, v190
    v_dot2c_f32_bf16 v44, s62, v179
    v_dot2c_f32_bf16 v46, v179, v179
    v_dot2c_f32_bf16 v45, s62, v183
    v_dot2c_f32_bf16 v47, v183, v183
    v_dot2c_f32_bf16 v48, s62, v187
    v_dot2c_f32_bf16 v50, v187, v187
    v_dot2c_f32_bf16 v49, s62, v191
    v_dot2c_f32_bf16 v51, v191, v191
    s_waitcnt vmcnt(8)
    ds_read_b128 v[208:211], v40 offset:20480
    ds_read_b128 v[212:215], v40 offset:22528
    ds_read_b128 v[216:219], v41 offset:20480
    ds_read_b128 v[220:223], v41 offset:22528
    s_waitcnt lgkmcnt(4)
    v_dot2c_f32_bf16 v44, s62, v192
    v_dot2c_f32_bf16 v46, v192, v192
    v_dot2c_f32_bf16 v45, s62, v196
    v_dot2c_f32_bf16 v47, v196, v196
    v_dot2c_f32_bf16 v48, s62, v200
    v_dot2c_f32_bf16 v50, v200, v200
    v_dot2c_f32_bf16 v49, s62, v204
    v_dot2c_f32_bf16 v51, v204, v204
    v_dot2c_f32_bf16 v44, s62, v193
    v_dot2c_f32_bf16 v46, v193, v193
    v_dot2c_f32_bf16 v45, s62, v197
    v_dot2c_f32_bf16 v47, v197, v197
    v_dot2c_f32_bf16 v48, s62, v201
    v_dot2c_f32_bf16 v50, v201, v201
    v_dot2c_f32_bf16 v49, s62, v205
    v_dot2c_f32_bf16 v51, v205, v205
    v_dot2c_f32_bf16 v44, s62, v194
    v_dot2c_f32_bf16 v46, v194, v194
    v_dot2c_f32_bf16 v45, s62, v198
    v_dot2c_f32_bf16 v47, v198, v198
    v_dot2c_f32_bf16 v48, s62, v202
    v_dot2c_f32_bf16 v50, v202, v202
    v_dot2c_f32_bf16 v49, s62, v206
    v_dot2c_f32_bf16 v51, v206, v206
    v_dot2c_f32_bf16 v44, s62, v195
    v_dot2c_f32_bf16 v46, v195, v195
    v_dot2c_f32_bf16 v45, s62, v199
    v_dot2c_f32_bf16 v47, v199, v199
    v_dot2c_f32_bf16 v48, s62, v203
    v_dot2c_f32_bf16 v50, v203, v203
    v_dot2c_f32_bf16 v49, s62, v207
    v_dot2c_f32_bf16 v51, v207, v207
    s_waitcnt vmcnt(4)
    ds_read_b128 v[224:227], v40 offset:0
    ds_read_b128 v[228:231], v40 offset:2048
    ds_read_b128 v[232:235], v41 offset:0
    ds_read_b128 v[236:239], v41 offset:2048
    s_waitcnt lgkmcnt(4)
    v_dot2c_f32_bf16 v44, s62, v208
    v_dot2c_f32_bf16 v46, v208, v208
    v_dot2c_f32_bf16 v45, s62, v212
    v_dot2c_f32_bf16 v47, v212, v212
    v_dot2c_f32_bf16 v48, s62, v216
    v_dot2c_f32_bf16 v50, v216, v216
    v_dot2c_f32_bf16 v49, s62, v220
    v_dot2c_f32_bf16 v51, v220, v220
    v_dot2c_f32_bf16 v44, s62, v209
    v_dot2c_f32_bf16 v46, v209, v209
    v_dot2c_f32_bf16 v45, s62, v213
    v_dot2c_f32_bf16 v47, v213, v213
    v_dot2c_f32_bf16 v48, s62, v217
    v_dot2c_f32_bf16 v50, v217, v217
    v_dot2c_f32_bf16 v49, s62, v221
    v_dot2c_f32_bf16 v51, v221, v221
    v_dot2c_f32_bf16 v44, s62, v210
    v_dot2c_f32_bf16 v46, v210, v210
    v_dot2c_f32_bf16 v45, s62, v214
    v_dot2c_f32_bf16 v47, v214, v214
    v_dot2c_f32_bf16 v48, s62, v218
    v_dot2c_f32_bf16 v50, v218, v218
    v_dot2c_f32_bf16 v49, s62, v222
    v_dot2c_f32_bf16 v51, v222, v222
    v_dot2c_f32_bf16 v44, s62, v211
    v_dot2c_f32_bf16 v46, v211, v211
    v_dot2c_f32_bf16 v45, s62, v215
    v_dot2c_f32_bf16 v47, v215, v215
    v_dot2c_f32_bf16 v48, s62, v219
    v_dot2c_f32_bf16 v50, v219, v219
    v_dot2c_f32_bf16 v49, s62, v223
    v_dot2c_f32_bf16 v51, v223, v223
    s_waitcnt vmcnt(0)
    ds_read_b128 v[240:243], v40 offset:4096
    ds_read_b128 v[244:247], v40 offset:6144
    ds_read_b128 v[248:251], v41 offset:4096
    ds_read_b128 v[252:255], v41 offset:6144
    s_waitcnt lgkmcnt(4)
    v_dot2c_f32_bf16 v44, s62, v224
    v_dot2c_f32_bf16 v46, v224, v224
    v_dot2c_f32_bf16 v45, s62, v228
    v_dot2c_f32_bf16 v47, v228, v228
    v_dot2c_f32_bf16 v48, s62, v232
    v_dot2c_f32_bf16 v50, v232, v232
    v_dot2c_f32_bf16 v49, s62, v236
    v_dot2c_f32_bf16 v51, v236, v236
    v_dot2c_f32_bf16 v44, s62, v225
    v_dot2c_f32_bf16 v46, v225, v225
    v_dot2c_f32_bf16 v45, s62, v229
    v_dot2c_f32_bf16 v47, v229, v229
    v_dot2c_f32_bf16 v48, s62, v233
    v_dot2c_f32_bf16 v50, v233, v233
    v_dot2c_f32_bf16 v49, s62, v237
    v_dot2c_f32_bf16 v51, v237, v237
    v_dot2c_f32_bf16 v44, s62, v226
    v_dot2c_f32_bf16 v46, v226, v226
    v_dot2c_f32_bf16 v45, s62, v230
    v_dot2c_f32_bf16 v47, v230, v230
    v_dot2c_f32_bf16 v48, s62, v234
    v_dot2c_f32_bf16 v50, v234, v234
    v_dot2c_f32_bf16 v49, s62, v238
    v_dot2c_f32_bf16 v51, v238, v238
    v_dot2c_f32_bf16 v44, s62, v227
    v_dot2c_f32_bf16 v46, v227, v227
    v_dot2c_f32_bf16 v45, s62, v231
    v_dot2c_f32_bf16 v47, v231, v231
    v_dot2c_f32_bf16 v48, s62, v235
    v_dot2c_f32_bf16 v50, v235, v235
    v_dot2c_f32_bf16 v49, s62, v239
    v_dot2c_f32_bf16 v51, v239, v239
    s_waitcnt lgkmcnt(0)
    s_barrier
    ds_read_b64_tr_b16 v[8:9], v0 offset:0
    ds_read_b64_tr_b16 v[10:11], v0 offset:768
    ds_read_b64_tr_b16 v[12:13], v0 offset:32
    ds_read_b64_tr_b16 v[14:15], v0 offset:800
    ds_read_b64_tr_b16 v[16:17], v0 offset:64
    ds_read_b64_tr_b16 v[18:19], v0 offset:832
    ds_read_b64_tr_b16 v[20:21], v0 offset:96
    ds_read_b64_tr_b16 v[22:23], v0 offset:864
    ds_read_b64_tr_b16 v[24:25], v0 offset:128
    ds_read_b64_tr_b16 v[26:27], v0 offset:896
    v_dot2c_f32_bf16 v44, s62, v240
    v_dot2c_f32_bf16 v46, v240, v240
    v_dot2c_f32_bf16 v45, s62, v244
    v_dot2c_f32_bf16 v47, v244, v244
    v_dot2c_f32_bf16 v48, s62, v248
    v_dot2c_f32_bf16 v50, v248, v248
    v_dot2c_f32_bf16 v49, s62, v252
    v_dot2c_f32_bf16 v51, v252, v252
    v_dot2c_f32_bf16 v44, s62, v241
    v_dot2c_f32_bf16 v46, v241, v241
    v_dot2c_f32_bf16 v45, s62, v245
    v_dot2c_f32_bf16 v47, v245, v245
    v_dot2c_f32_bf16 v48, s62, v249
    v_dot2c_f32_bf16 v50, v249, v249
    v_dot2c_f32_bf16 v49, s62, v253
    v_dot2c_f32_bf16 v51, v253, v253
    v_dot2c_f32_bf16 v44, s62, v242
    v_dot2c_f32_bf16 v46, v242, v242
    v_dot2c_f32_bf16 v45, s62, v246
    v_dot2c_f32_bf16 v47, v246, v246
    v_dot2c_f32_bf16 v48, s62, v250
    v_dot2c_f32_bf16 v50, v250, v250
    v_dot2c_f32_bf16 v49, s62, v254
    v_dot2c_f32_bf16 v51, v254, v254
    v_dot2c_f32_bf16 v44, s62, v243
    v_dot2c_f32_bf16 v46, v243, v243
    v_dot2c_f32_bf16 v45, s62, v247
    v_dot2c_f32_bf16 v47, v247, v247
    v_dot2c_f32_bf16 v48, s62, v251
    v_dot2c_f32_bf16 v50, v251, v251
    v_dot2c_f32_bf16 v49, s62, v255
    v_dot2c_f32_bf16 v51, v255, v255
    s_nop 2
    v_add_f32 v44, v44, v48
    v_add_f32 v45, v45, v49
    v_add_f32 v46, v46, v50
    v_add_f32 v47, v47, v51
    s_nop 0
    v_permlane16_swap_b32 v44, v45
    v_permlane16_swap_b32 v46, v47
    v_add_f32 v44, v44, v45
    v_add_f32 v46, v46, v47
    v_mov_b32 v45, v44
    v_mov_b32 v47, v46
    s_nop 1
    v_permlane32_swap_b32 v44, v45
    v_permlane32_swap_b32 v46, v47
    v_add_f32 v44, v44, v45
    v_add_f32 v46, v46, v47
    v_mul_f32 v44, 0x3b000000, v44
    v_mul_f32 v46, 0x3b000000, v46
    v_fma_f32 v46, -v44, v44, v46
    v_max_f32 v46, 0, v46
    v_cvt_pk_bf16_f32 v45, v44, v46
    v_and_b32 v46, s60, v45
    v_add_f32 v46, 0x3727c5ac, v46
    v_cvt_pk_bf16_f32 v46, v46, v46
    v_and_b32 v46, s60, v46
    v_sqrt_f32 v46, v46
    v_lshlrev_b32 v44, 16, v45
    v_cvt_pk_bf16_f32 v46, v46, v46
    v_and_b32 v46, s60, v46
    v_rcp_f32 v3, v46
    v_sub_f32 v44, 0, v44
    v_mul_f32 v5, v44, v3
    v_mov_b32 v4, v3
    v_mov_b32 v6, v5
    s_nop 1
    v_permlane16_swap_b32 v3, v4
    v_permlane16_swap_b32 v5, v6
    v_lshlrev_b32 v7, 16, v128
    v_and_b32 v128, s60, v128
    v_fma_f32 v7, v7, v3, v5
    v_fma_f32 v128, v128, v3, v5
    v_cvt_pk_bf16_f32 v128, v7, v128
    v_lshlrev_b32 v7, 16, v129
    v_and_b32 v129, s60, v129
    v_fma_f32 v7, v7, v3, v5
    v_fma_f32 v129, v129, v3, v5
    v_cvt_pk_bf16_f32 v129, v7, v129
    v_lshlrev_b32 v7, 16, v130
    v_and_b32 v130, s60, v130
    v_fma_f32 v7, v7, v3, v5
    v_fma_f32 v130, v130, v3, v5
    v_cvt_pk_bf16_f32 v130, v7, v130
    v_lshlrev_b32 v7, 16, v131
    v_and_b32 v131, s60, v131
    v_fma_f32 v7, v7, v3, v5
    v_fma_f32 v131, v131, v3, v5
    v_cvt_pk_bf16_f32 v131, v7, v131
    v_lshlrev_b32 v7, 16, v132
    v_and_b32 v132, s60, v132
    v_fma_f32 v7, v7, v4, v6
    v_fma_f32 v132, v132, v4, v6
    v_cvt_pk_bf16_f32 v132, v7, v132
    v_lshlrev_b32 v7, 16, v133
    v_and_b32 v133, s60, v133
    v_fma_f32 v7, v7, v4, v6
    v_fma_f32 v133, v133, v4, v6
    v_cvt_pk_bf16_f32 v133, v7, v133
    v_lshlrev_b32 v7, 16, v134
    v_and_b32 v134, s60, v134
    v_fma_f32 v7, v7, v4, v6
    v_fma_f32 v134, v134, v4, v6
    v_cvt_pk_bf16_f32 v134, v7, v134
    v_lshlrev_b32 v7, 16, v135
    v_and_b32 v135, s60, v135
    v_fma_f32 v7, v7, v4, v6
    v_fma_f32 v135, v135, v4, v6
    v_cvt_pk_bf16_f32 v135, v7, v135
    v_lshlrev_b32 v7, 16, v136
    v_and_b32 v136, s60, v136
    v_fma_f32 v7, v7, v3, v5
    v_fma_f32 v136, v136, v3, v5
    v_cvt_pk_bf16_f32 v136, v7, v136
    v_lshlrev_b32 v7, 16, v137
    v_and_b32 v137, s60, v137
    s_nop 0
    s_waitcnt lgkmcnt(4)
    v_mfma_f32_16x16x32_bf16 v[32:35], v[8:11], v[128:131], 0
    ds_read_b64_tr_b16 v[28:29], v0 offset:160
    v_fma_f32 v7, v7, v3, v5
    v_fma_f32 v137, v137, v3, v5
    v_cvt_pk_bf16_f32 v137, v7, v137
    v_lshlrev_b32 v7, 16, v138
    v_mfma_f32_16x16x32_bf16 v[36:39], v[8:11], v[132:135], 0
    ds_read_b64_tr_b16 v[30:31], v0 offset:928
    v_and_b32 v138, s60, v138
    v_fma_f32 v7, v7, v3, v5
    v_fma_f32 v138, v138, v3, v5
    v_mfma_f32_16x16x32_bf16 v[40:43], v[12:15], v[128:131], 0
    ds_read_b64_tr_b16 v[8:9], v0 offset:6208
    v_cvt_pk_bf16_f32 v138, v7, v138
    v_lshlrev_b32 v7, 16, v139
    v_and_b32 v139, s60, v139
    v_mfma_f32_16x16x32_bf16 v[44:47], v[12:15], v[132:135], 0
    ds_read_b64_tr_b16 v[10:11], v0 offset:6976
    v_fma_f32 v7, v7, v3, v5
    v_fma_f32 v139, v139, v3, v5
    v_cvt_pk_bf16_f32 v139, v7, v139
    v_mfma_f32_16x16x32_bf16 v[48:51], v[16:19], v[128:131], 0
    ds_read_b64_tr_b16 v[12:13], v0 offset:6240
    v_lshlrev_b32 v7, 16, v140
    v_and_b32 v140, s60, v140
    v_fma_f32 v7, v7, v4, v6
    v_fma_f32 v140, v140, v4, v6
    v_mfma_f32_16x16x32_bf16 v[52:55], v[16:19], v[132:135], 0
    ds_read_b64_tr_b16 v[14:15], v0 offset:7008
    v_cvt_pk_bf16_f32 v140, v7, v140
    v_lshlrev_b32 v7, 16, v141
    v_and_b32 v141, s60, v141
    s_waitcnt lgkmcnt(4)
    v_mfma_f32_16x16x32_bf16 v[56:59], v[20:23], v[128:131], 0
    ds_read_b64_tr_b16 v[16:17], v0 offset:6272
    v_fma_f32 v7, v7, v4, v6
    v_fma_f32 v141, v141, v4, v6
    v_cvt_pk_bf16_f32 v141, v7, v141
    v_lshlrev_b32 v7, 16, v142
    v_mfma_f32_16x16x32_bf16 v[60:63], v[20:23], v[132:135], 0
    ds_read_b64_tr_b16 v[18:19], v0 offset:7040
    v_and_b32 v142, s60, v142
    v_fma_f32 v7, v7, v4, v6
    v_fma_f32 v142, v142, v4, v6
    v_mfma_f32_16x16x32_bf16 v[64:67], v[24:27], v[128:131], 0
    ds_read_b64_tr_b16 v[20:21], v0 offset:6304
    v_cvt_pk_bf16_f32 v142, v7, v142
    v_lshlrev_b32 v7, 16, v143
    v_and_b32 v143, s60, v143
    v_mfma_f32_16x16x32_bf16 v[68:71], v[24:27], v[132:135], 0
    ds_read_b64_tr_b16 v[22:23], v0 offset:7072
    v_fma_f32 v7, v7, v4, v6
    v_fma_f32 v143, v143, v4, v6
    v_cvt_pk_bf16_f32 v143, v7, v143
    v_mfma_f32_16x16x32_bf16 v[72:75], v[28:31], v[128:131], 0
    ds_read_b64_tr_b16 v[24:25], v0 offset:6336
    v_lshlrev_b32 v7, 16, v144
    v_and_b32 v144, s60, v144
    v_fma_f32 v7, v7, v3, v5
    v_fma_f32 v144, v144, v3, v5
    v_mfma_f32_16x16x32_bf16 v[76:79], v[28:31], v[132:135], 0
    ds_read_b64_tr_b16 v[26:27], v0 offset:7104
    v_cvt_pk_bf16_f32 v144, v7, v144
    v_lshlrev_b32 v7, 16, v145
    v_and_b32 v145, s60, v145
    s_waitcnt lgkmcnt(4)
    v_mfma_f32_16x16x32_bf16 v[32:35], v[8:11], v[136:139], v[32:35]
    ds_read_b64_tr_b16 v[28:29], v0 offset:6368
    v_fma_f32 v7, v7, v3, v5
    v_fma_f32 v145, v145, v3, v5
    v_cvt_pk_bf16_f32 v145, v7, v145
    v_lshlrev_b32 v7, 16, v146
    v_mfma_f32_16x16x32_bf16 v[36:39], v[8:11], v[140:143], v[36:39]
    ds_read_b64_tr_b16 v[30:31], v0 offset:7136
    v_and_b32 v146, s60, v146
    v_fma_f32 v7, v7, v3, v5
    v_fma_f32 v146, v146, v3, v5
    v_mfma_f32_16x16x32_bf16 v[40:43], v[12:15], v[136:139], v[40:43]
    s_barrier
    ds_read_b64_tr_b16 v[8:9], v0 offset:12416
    v_cvt_pk_bf16_f32 v146, v7, v146
    v_lshlrev_b32 v7, 16, v147
    v_and_b32 v147, s60, v147
    v_mfma_f32_16x16x32_bf16 v[44:47], v[12:15], v[140:143], v[44:47]
    ds_read_b64_tr_b16 v[10:11], v0 offset:13184
    v_fma_f32 v7, v7, v3, v5
    v_fma_f32 v147, v147, v3, v5
    v_cvt_pk_bf16_f32 v147, v7, v147
    v_mfma_f32_16x16x32_bf16 v[48:51], v[16:19], v[136:139], v[48:51]
    ds_read_b64_tr_b16 v[12:13], v0 offset:12448
    v_lshlrev_b32 v7, 16, v148
    v_and_b32 v148, s60, v148
    v_fma_f32 v7, v7, v4, v6
    v_fma_f32 v148, v148, v4, v6
    v_mfma_f32_16x16x32_bf16 v[52:55], v[16:19], v[140:143], v[52:55]
    ds_read_b64_tr_b16 v[14:15], v0 offset:13216
    v_cvt_pk_bf16_f32 v148, v7, v148
    v_lshlrev_b32 v7, 16, v149
    v_and_b32 v149, s60, v149
    s_waitcnt lgkmcnt(4)
    v_mfma_f32_16x16x32_bf16 v[56:59], v[20:23], v[136:139], v[56:59]
    ds_read_b64_tr_b16 v[16:17], v0 offset:12480
    v_fma_f32 v7, v7, v4, v6
    v_fma_f32 v149, v149, v4, v6
    v_cvt_pk_bf16_f32 v149, v7, v149
    v_lshlrev_b32 v7, 16, v150
    v_mfma_f32_16x16x32_bf16 v[60:63], v[20:23], v[140:143], v[60:63]
    ds_read_b64_tr_b16 v[18:19], v0 offset:13248
    v_and_b32 v150, s60, v150
    v_fma_f32 v7, v7, v4, v6
    v_fma_f32 v150, v150, v4, v6
    v_mfma_f32_16x16x32_bf16 v[64:67], v[24:27], v[136:139], v[64:67]
    ds_read_b64_tr_b16 v[20:21], v0 offset:12512
    v_cvt_pk_bf16_f32 v150, v7, v150
    v_lshlrev_b32 v7, 16, v151
    v_and_b32 v151, s60, v151
    v_mfma_f32_16x16x32_bf16 v[68:71], v[24:27], v[140:143], v[68:71]
    ds_read_b64_tr_b16 v[22:23], v0 offset:13280
    v_fma_f32 v7, v7, v4, v6
    v_fma_f32 v151, v151, v4, v6
    v_cvt_pk_bf16_f32 v151, v7, v151
    v_mfma_f32_16x16x32_bf16 v[72:75], v[28:31], v[136:139], v[72:75]
    ds_read_b64_tr_b16 v[24:25], v0 offset:12544
    v_lshlrev_b32 v7, 16, v152
    v_and_b32 v152, s60, v152
    v_fma_f32 v7, v7, v3, v5
    v_fma_f32 v152, v152, v3, v5
    v_mfma_f32_16x16x32_bf16 v[76:79], v[28:31], v[140:143], v[76:79]
    ds_read_b64_tr_b16 v[26:27], v0 offset:13312
    v_cvt_pk_bf16_f32 v152, v7, v152
    v_lshlrev_b32 v7, 16, v153
    v_and_b32 v153, s60, v153
    s_waitcnt lgkmcnt(4)
    v_mfma_f32_16x16x32_bf16 v[32:35], v[8:11], v[144:147], v[32:35]
    ds_read_b64_tr_b16 v[28:29], v0 offset:12576
    v_fma_f32 v7, v7, v3, v5
    v_fma_f32 v153, v153, v3, v5
    v_cvt_pk_bf16_f32 v153, v7, v153
    v_lshlrev_b32 v7, 16, v154
    v_mfma_f32_16x16x32_bf16 v[36:39], v[8:11], v[148:151], v[36:39]
    ds_read_b64_tr_b16 v[30:31], v0 offset:13344
    v_and_b32 v154, s60, v154
    v_fma_f32 v7, v7, v3, v5
    v_fma_f32 v154, v154, v3, v5
    v_mfma_f32_16x16x32_bf16 v[40:43], v[12:15], v[144:147], v[40:43]
    ds_read_b64_tr_b16 v[8:9], v0 offset:18624
    v_cvt_pk_bf16_f32 v154, v7, v154
    v_lshlrev_b32 v7, 16, v155
    v_and_b32 v155, s60, v155
    v_mfma_f32_16x16x32_bf16 v[44:47], v[12:15], v[148:151], v[44:47]
    ds_read_b64_tr_b16 v[10:11], v0 offset:19392
    v_fma_f32 v7, v7, v3, v5
    v_fma_f32 v155, v155, v3, v5
    v_cvt_pk_bf16_f32 v155, v7, v155
    v_mfma_f32_16x16x32_bf16 v[48:51], v[16:19], v[144:147], v[48:51]
    ds_read_b64_tr_b16 v[12:13], v0 offset:18656
    v_lshlrev_b32 v7, 16, v156
    v_and_b32 v156, s60, v156
    v_fma_f32 v7, v7, v4, v6
    v_fma_f32 v156, v156, v4, v6
    v_mfma_f32_16x16x32_bf16 v[52:55], v[16:19], v[148:151], v[52:55]
    ds_read_b64_tr_b16 v[14:15], v0 offset:19424
    v_cvt_pk_bf16_f32 v156, v7, v156
    v_lshlrev_b32 v7, 16, v157
    v_and_b32 v157, s60, v157
    s_waitcnt lgkmcnt(4)
    v_mfma_f32_16x16x32_bf16 v[56:59], v[20:23], v[144:147], v[56:59]
    ds_read_b64_tr_b16 v[16:17], v0 offset:18688
    v_fma_f32 v7, v7, v4, v6
    v_fma_f32 v157, v157, v4, v6
    v_cvt_pk_bf16_f32 v157, v7, v157
    v_lshlrev_b32 v7, 16, v158
    v_mfma_f32_16x16x32_bf16 v[60:63], v[20:23], v[148:151], v[60:63]
    ds_read_b64_tr_b16 v[18:19], v0 offset:19456
    v_and_b32 v158, s60, v158
    v_fma_f32 v7, v7, v4, v6
    v_fma_f32 v158, v158, v4, v6
    v_mfma_f32_16x16x32_bf16 v[64:67], v[24:27], v[144:147], v[64:67]
    ds_read_b64_tr_b16 v[20:21], v0 offset:18720
    v_cvt_pk_bf16_f32 v158, v7, v158
    v_lshlrev_b32 v7, 16, v159
    v_and_b32 v159, s60, v159
    v_mfma_f32_16x16x32_bf16 v[68:71], v[24:27], v[148:151], v[68:71]
    ds_read_b64_tr_b16 v[22:23], v0 offset:19488
    v_fma_f32 v7, v7, v4, v6
    v_fma_f32 v159, v159, v4, v6
    v_cvt_pk_bf16_f32 v159, v7, v159
    v_mfma_f32_16x16x32_bf16 v[72:75], v[28:31], v[144:147], v[72:75]
    ds_read_b64_tr_b16 v[24:25], v0 offset:18752
    v_lshlrev_b32 v7, 16, v160
    v_and_b32 v160, s60, v160
    v_fma_f32 v7, v7, v3, v5
    v_fma_f32 v160, v160, v3, v5
    v_mfma_f32_16x16x32_bf16 v[76:79], v[28:31], v[148:151], v[76:79]
    ds_read_b64_tr_b16 v[26:27], v0 offset:19520
    v_cvt_pk_bf16_f32 v160, v7, v160
    v_lshlrev_b32 v7, 16, v161
    v_and_b32 v161, s60, v161
    s_waitcnt lgkmcnt(4)
    v_mfma_f32_16x16x32_bf16 v[32:35], v[8:11], v[152:155], v[32:35]
    ds_read_b64_tr_b16 v[28:29], v0 offset:18784
    v_fma_f32 v7, v7, v3, v5
    v_fma_f32 v161, v161, v3, v5
    v_cvt_pk_bf16_f32 v161, v7, v161
    v_lshlrev_b32 v7, 16, v162
    v_mfma_f32_16x16x32_bf16 v[36:39], v[8:11], v[156:159], v[36:39]
    ds_read_b64_tr_b16 v[30:31], v0 offset:19552
    v_and_b32 v162, s60, v162
    v_fma_f32 v7, v7, v3, v5
    v_fma_f32 v162, v162, v3, v5
    v_mfma_f32_16x16x32_bf16 v[40:43], v[12:15], v[152:155], v[40:43]
    ds_read_b64_tr_b16 v[8:9], v0 offset:24832
    v_cvt_pk_bf16_f32 v162, v7, v162
    v_lshlrev_b32 v7, 16, v163
    v_and_b32 v163, s60, v163
    v_mfma_f32_16x16x32_bf16 v[44:47], v[12:15], v[156:159], v[44:47]
    ds_read_b64_tr_b16 v[10:11], v0 offset:25600
    v_fma_f32 v7, v7, v3, v5
    v_fma_f32 v163, v163, v3, v5
    v_cvt_pk_bf16_f32 v163, v7, v163
    v_mfma_f32_16x16x32_bf16 v[48:51], v[16:19], v[152:155], v[48:51]
    ds_read_b64_tr_b16 v[12:13], v0 offset:24864
    v_lshlrev_b32 v7, 16, v164
    v_and_b32 v164, s60, v164
    v_fma_f32 v7, v7, v4, v6
    v_fma_f32 v164, v164, v4, v6
    v_mfma_f32_16x16x32_bf16 v[52:55], v[16:19], v[156:159], v[52:55]
    ds_read_b64_tr_b16 v[14:15], v0 offset:25632
    v_cvt_pk_bf16_f32 v164, v7, v164
    v_lshlrev_b32 v7, 16, v165
    v_and_b32 v165, s60, v165
    s_waitcnt lgkmcnt(4)
    v_mfma_f32_16x16x32_bf16 v[56:59], v[20:23], v[152:155], v[56:59]
    ds_read_b64_tr_b16 v[16:17], v0 offset:24896
    v_fma_f32 v7, v7, v4, v6
    v_fma_f32 v165, v165, v4, v6
    v_cvt_pk_bf16_f32 v165, v7, v165
    v_lshlrev_b32 v7, 16, v166
    v_mfma_f32_16x16x32_bf16 v[60:63], v[20:23], v[156:159], v[60:63]
    ds_read_b64_tr_b16 v[18:19], v0 offset:25664
    v_and_b32 v166, s60, v166
    v_fma_f32 v7, v7, v4, v6
    v_fma_f32 v166, v166, v4, v6
    v_mfma_f32_16x16x32_bf16 v[64:67], v[24:27], v[152:155], v[64:67]
    ds_read_b64_tr_b16 v[20:21], v0 offset:24928
    v_cvt_pk_bf16_f32 v166, v7, v166
    v_lshlrev_b32 v7, 16, v167
    v_and_b32 v167, s60, v167
    v_mfma_f32_16x16x32_bf16 v[68:71], v[24:27], v[156:159], v[68:71]
    ds_read_b64_tr_b16 v[22:23], v0 offset:25696
    v_fma_f32 v7, v7, v4, v6
    v_fma_f32 v167, v167, v4, v6
    v_cvt_pk_bf16_f32 v167, v7, v167
    v_mfma_f32_16x16x32_bf16 v[72:75], v[28:31], v[152:155], v[72:75]
    ds_read_b64_tr_b16 v[24:25], v0 offset:24960
    v_lshlrev_b32 v7, 16, v168
    v_and_b32 v168, s60, v168
    v_fma_f32 v7, v7, v3, v5
    v_fma_f32 v168, v168, v3, v5
    v_mfma_f32_16x16x32_bf16 v[76:79], v[28:31], v[156:159], v[76:79]
    ds_read_b64_tr_b16 v[26:27], v0 offset:25728
    v_cvt_pk_bf16_f32 v168, v7, v168
    v_lshlrev_b32 v7, 16, v169
    v_and_b32 v169, s60, v169
    s_waitcnt lgkmcnt(4)
    v_mfma_f32_16x16x32_bf16 v[32:35], v[8:11], v[160:163], v[32:35]
    ds_read_b64_tr_b16 v[28:29], v0 offset:24992
    v_fma_f32 v7, v7, v3, v5
    v_fma_f32 v169, v169, v3, v5
    v_cvt_pk_bf16_f32 v169, v7, v169
    v_lshlrev_b32 v7, 16, v170
    v_mfma_f32_16x16x32_bf16 v[36:39], v[8:11], v[164:167], v[36:39]
    ds_read_b64_tr_b16 v[30:31], v0 offset:25760
    v_and_b32 v170, s60, v170
    v_fma_f32 v7, v7, v3, v5
    v_fma_f32 v170, v170, v3, v5
    v_mfma_f32_16x16x32_bf16 v[40:43], v[12:15], v[160:163], v[40:43]
    ds_read_b64_tr_b16 v[8:9], v0 offset:31040
    v_cvt_pk_bf16_f32 v170, v7, v170
    v_lshlrev_b32 v7, 16, v171
    v_and_b32 v171, s60, v171
    v_mfma_f32_16x16x32_bf16 v[44:47], v[12:15], v[164:167], v[44:47]
    ds_read_b64_tr_b16 v[10:11], v0 offset:31808
    v_fma_f32 v7, v7, v3, v5
    v_fma_f32 v171, v171, v3, v5
    v_cvt_pk_bf16_f32 v171, v7, v171
    v_mfma_f32_16x16x32_bf16 v[48:51], v[16:19], v[160:163], v[48:51]
    ds_read_b64_tr_b16 v[12:13], v0 offset:31072
    v_lshlrev_b32 v7, 16, v172
    v_and_b32 v172, s60, v172
    v_fma_f32 v7, v7, v4, v6
    v_fma_f32 v172, v172, v4, v6
    v_mfma_f32_16x16x32_bf16 v[52:55], v[16:19], v[164:167], v[52:55]
    ds_read_b64_tr_b16 v[14:15], v0 offset:31840
    v_cvt_pk_bf16_f32 v172, v7, v172
    v_lshlrev_b32 v7, 16, v173
    v_and_b32 v173, s60, v173
    s_waitcnt lgkmcnt(4)
    v_mfma_f32_16x16x32_bf16 v[56:59], v[20:23], v[160:163], v[56:59]
    ds_read_b64_tr_b16 v[16:17], v0 offset:31104
    v_fma_f32 v7, v7, v4, v6
    v_fma_f32 v173, v173, v4, v6
    v_cvt_pk_bf16_f32 v173, v7, v173
    v_lshlrev_b32 v7, 16, v174
    v_mfma_f32_16x16x32_bf16 v[60:63], v[20:23], v[164:167], v[60:63]
    ds_read_b64_tr_b16 v[18:19], v0 offset:31872
    v_and_b32 v174, s60, v174
    v_fma_f32 v7, v7, v4, v6
    v_fma_f32 v174, v174, v4, v6
    v_mfma_f32_16x16x32_bf16 v[64:67], v[24:27], v[160:163], v[64:67]
    ds_read_b64_tr_b16 v[20:21], v0 offset:31136
    v_cvt_pk_bf16_f32 v174, v7, v174
    v_lshlrev_b32 v7, 16, v175
    v_and_b32 v175, s60, v175
    v_mfma_f32_16x16x32_bf16 v[68:71], v[24:27], v[164:167], v[68:71]
    ds_read_b64_tr_b16 v[22:23], v0 offset:31904
    v_fma_f32 v7, v7, v4, v6
    v_fma_f32 v175, v175, v4, v6
    v_cvt_pk_bf16_f32 v175, v7, v175
    v_mfma_f32_16x16x32_bf16 v[72:75], v[28:31], v[160:163], v[72:75]
    ds_read_b64_tr_b16 v[24:25], v0 offset:31168
    v_lshlrev_b32 v7, 16, v176
    v_and_b32 v176, s60, v176
    v_fma_f32 v7, v7, v3, v5
    v_fma_f32 v176, v176, v3, v5
    v_mfma_f32_16x16x32_bf16 v[76:79], v[28:31], v[164:167], v[76:79]
    ds_read_b64_tr_b16 v[26:27], v0 offset:31936
    v_cvt_pk_bf16_f32 v176, v7, v176
    v_lshlrev_b32 v7, 16, v177
    v_and_b32 v177, s60, v177
    s_waitcnt lgkmcnt(4)
    v_mfma_f32_16x16x32_bf16 v[32:35], v[8:11], v[168:171], v[32:35]
    ds_read_b64_tr_b16 v[28:29], v0 offset:31200
    v_fma_f32 v7, v7, v3, v5
    v_fma_f32 v177, v177, v3, v5
    v_cvt_pk_bf16_f32 v177, v7, v177
    v_lshlrev_b32 v7, 16, v178
    v_mfma_f32_16x16x32_bf16 v[36:39], v[8:11], v[172:175], v[36:39]
    ds_read_b64_tr_b16 v[30:31], v0 offset:31968
    v_and_b32 v178, s60, v178
    v_fma_f32 v7, v7, v3, v5
    v_fma_f32 v178, v178, v3, v5
    v_mfma_f32_16x16x32_bf16 v[40:43], v[12:15], v[168:171], v[40:43]
    s_barrier
    ds_read_b64_tr_b16 v[8:9], v0 offset:37248
    v_cvt_pk_bf16_f32 v178, v7, v178
    v_lshlrev_b32 v7, 16, v179
    v_and_b32 v179, s60, v179
    v_mfma_f32_16x16x32_bf16 v[44:47], v[12:15], v[172:175], v[44:47]
    ds_read_b64_tr_b16 v[10:11], v0 offset:38016
    v_fma_f32 v7, v7, v3, v5
    v_fma_f32 v179, v179, v3, v5
    v_cvt_pk_bf16_f32 v179, v7, v179
    v_mfma_f32_16x16x32_bf16 v[48:51], v[16:19], v[168:171], v[48:51]
    ds_read_b64_tr_b16 v[12:13], v0 offset:37280
    v_lshlrev_b32 v7, 16, v180
    v_and_b32 v180, s60, v180
    v_fma_f32 v7, v7, v4, v6
    v_fma_f32 v180, v180, v4, v6
    v_mfma_f32_16x16x32_bf16 v[52:55], v[16:19], v[172:175], v[52:55]
    ds_read_b64_tr_b16 v[14:15], v0 offset:38048
    v_cvt_pk_bf16_f32 v180, v7, v180
    v_lshlrev_b32 v7, 16, v181
    v_and_b32 v181, s60, v181
    s_waitcnt lgkmcnt(4)
    v_mfma_f32_16x16x32_bf16 v[56:59], v[20:23], v[168:171], v[56:59]
    ds_read_b64_tr_b16 v[16:17], v0 offset:37312
    v_fma_f32 v7, v7, v4, v6
    v_fma_f32 v181, v181, v4, v6
    v_cvt_pk_bf16_f32 v181, v7, v181
    v_lshlrev_b32 v7, 16, v182
    v_mfma_f32_16x16x32_bf16 v[60:63], v[20:23], v[172:175], v[60:63]
    ds_read_b64_tr_b16 v[18:19], v0 offset:38080
    v_and_b32 v182, s60, v182
    v_fma_f32 v7, v7, v4, v6
    v_fma_f32 v182, v182, v4, v6
    v_mfma_f32_16x16x32_bf16 v[64:67], v[24:27], v[168:171], v[64:67]
    ds_read_b64_tr_b16 v[20:21], v0 offset:37344
    v_cvt_pk_bf16_f32 v182, v7, v182
    v_lshlrev_b32 v7, 16, v183
    v_and_b32 v183, s60, v183
    v_mfma_f32_16x16x32_bf16 v[68:71], v[24:27], v[172:175], v[68:71]
    ds_read_b64_tr_b16 v[22:23], v0 offset:38112
    v_fma_f32 v7, v7, v4, v6
    v_fma_f32 v183, v183, v4, v6
    v_cvt_pk_bf16_f32 v183, v7, v183
    v_mfma_f32_16x16x32_bf16 v[72:75], v[28:31], v[168:171], v[72:75]
    ds_read_b64_tr_b16 v[24:25], v0 offset:37376
    v_lshlrev_b32 v7, 16, v184
    v_and_b32 v184, s60, v184
    v_fma_f32 v7, v7, v3, v5
    v_fma_f32 v184, v184, v3, v5
    v_mfma_f32_16x16x32_bf16 v[76:79], v[28:31], v[172:175], v[76:79]
    ds_read_b64_tr_b16 v[26:27], v0 offset:38144
    v_cvt_pk_bf16_f32 v184, v7, v184
    v_lshlrev_b32 v7, 16, v185
    v_and_b32 v185, s60, v185
    s_waitcnt lgkmcnt(4)
    v_mfma_f32_16x16x32_bf16 v[32:35], v[8:11], v[176:179], v[32:35]
    ds_read_b64_tr_b16 v[28:29], v0 offset:37408
    v_fma_f32 v7, v7, v3, v5
    v_fma_f32 v185, v185, v3, v5
    v_cvt_pk_bf16_f32 v185, v7, v185
    v_lshlrev_b32 v7, 16, v186
    v_mfma_f32_16x16x32_bf16 v[36:39], v[8:11], v[180:183], v[36:39]
    ds_read_b64_tr_b16 v[30:31], v0 offset:38176
    v_and_b32 v186, s60, v186
    v_fma_f32 v7, v7, v3, v5
    v_fma_f32 v186, v186, v3, v5
    v_mfma_f32_16x16x32_bf16 v[40:43], v[12:15], v[176:179], v[40:43]
    ds_read_b64_tr_b16 v[8:9], v0 offset:43456
    v_cvt_pk_bf16_f32 v186, v7, v186
    v_lshlrev_b32 v7, 16, v187
    v_and_b32 v187, s60, v187
    v_mfma_f32_16x16x32_bf16 v[44:47], v[12:15], v[180:183], v[44:47]
    ds_read_b64_tr_b16 v[10:11], v0 offset:44224
    v_fma_f32 v7, v7, v3, v5
    v_fma_f32 v187, v187, v3, v5
    v_cvt_pk_bf16_f32 v187, v7, v187
    v_mfma_f32_16x16x32_bf16 v[48:51], v[16:19], v[176:179], v[48:51]
    ds_read_b64_tr_b16 v[12:13], v0 offset:43488
    v_lshlrev_b32 v7, 16, v188
    v_and_b32 v188, s60, v188
    v_fma_f32 v7, v7, v4, v6
    v_fma_f32 v188, v188, v4, v6
    v_mfma_f32_16x16x32_bf16 v[52:55], v[16:19], v[180:183], v[52:55]
    ds_read_b64_tr_b16 v[14:15], v0 offset:44256
    v_cvt_pk_bf16_f32 v188, v7, v188
    v_lshlrev_b32 v7, 16, v189
    v_and_b32 v189, s60, v189
    s_waitcnt lgkmcnt(4)
    v_mfma_f32_16x16x32_bf16 v[56:59], v[20:23], v[176:179], v[56:59]
    ds_read_b64_tr_b16 v[16:17], v0 offset:43520
    v_fma_f32 v7, v7, v4, v6
    v_fma_f32 v189, v189, v4, v6
    v_cvt_pk_bf16_f32 v189, v7, v189
    v_lshlrev_b32 v7, 16, v190
    v_mfma_f32_16x16x32_bf16 v[60:63], v[20:23], v[180:183], v[60:63]
    ds_read_b64_tr_b16 v[18:19], v0 offset:44288
    v_and_b32 v190, s60, v190
    v_fma_f32 v7, v7, v4, v6
    v_fma_f32 v190, v190, v4, v6
    v_mfma_f32_16x16x32_bf16 v[64:67], v[24:27], v[176:179], v[64:67]
    ds_read_b64_tr_b16 v[20:21], v0 offset:43552
    v_cvt_pk_bf16_f32 v190, v7, v190
    v_lshlrev_b32 v7, 16, v191
    v_and_b32 v191, s60, v191
    v_mfma_f32_16x16x32_bf16 v[68:71], v[24:27], v[180:183], v[68:71]
    ds_read_b64_tr_b16 v[22:23], v0 offset:44320
    v_fma_f32 v7, v7, v4, v6
    v_fma_f32 v191, v191, v4, v6
    v_cvt_pk_bf16_f32 v191, v7, v191
    v_mfma_f32_16x16x32_bf16 v[72:75], v[28:31], v[176:179], v[72:75]
    ds_read_b64_tr_b16 v[24:25], v0 offset:43584
    v_lshlrev_b32 v7, 16, v192
    v_and_b32 v192, s60, v192
    v_fma_f32 v7, v7, v3, v5
    v_fma_f32 v192, v192, v3, v5
    v_mfma_f32_16x16x32_bf16 v[76:79], v[28:31], v[180:183], v[76:79]
    ds_read_b64_tr_b16 v[26:27], v0 offset:44352
    v_cvt_pk_bf16_f32 v192, v7, v192
    v_lshlrev_b32 v7, 16, v193
    v_and_b32 v193, s60, v193
    s_waitcnt lgkmcnt(4)
    v_mfma_f32_16x16x32_bf16 v[32:35], v[8:11], v[184:187], v[32:35]
    ds_read_b64_tr_b16 v[28:29], v0 offset:43616
    v_fma_f32 v7, v7, v3, v5
    v_fma_f32 v193, v193, v3, v5
    v_cvt_pk_bf16_f32 v193, v7, v193
    v_lshlrev_b32 v7, 16, v194
    v_mfma_f32_16x16x32_bf16 v[36:39], v[8:11], v[188:191], v[36:39]
    ds_read_b64_tr_b16 v[30:31], v0 offset:44384
    v_and_b32 v194, s60, v194
    v_fma_f32 v7, v7, v3, v5
    v_fma_f32 v194, v194, v3, v5
    v_mfma_f32_16x16x32_bf16 v[40:43], v[12:15], v[184:187], v[40:43]
    ds_read_b64_tr_b16 v[8:9], v1 offset:0
    v_cvt_pk_bf16_f32 v194, v7, v194
    v_lshlrev_b32 v7, 16, v195
    v_and_b32 v195, s60, v195
    v_mfma_f32_16x16x32_bf16 v[44:47], v[12:15], v[188:191], v[44:47]
    ds_read_b64_tr_b16 v[10:11], v1 offset:768
    v_fma_f32 v7, v7, v3, v5
    v_fma_f32 v195, v195, v3, v5
    v_cvt_pk_bf16_f32 v195, v7, v195
    v_mfma_f32_16x16x32_bf16 v[48:51], v[16:19], v[184:187], v[48:51]
    ds_read_b64_tr_b16 v[12:13], v1 offset:32
    v_lshlrev_b32 v7, 16, v196
    v_and_b32 v196, s60, v196
    v_fma_f32 v7, v7, v4, v6
    v_fma_f32 v196, v196, v4, v6
    v_mfma_f32_16x16x32_bf16 v[52:55], v[16:19], v[188:191], v[52:55]
    ds_read_b64_tr_b16 v[14:15], v1 offset:800
    v_cvt_pk_bf16_f32 v196, v7, v196
    v_lshlrev_b32 v7, 16, v197
    v_and_b32 v197, s60, v197
    s_waitcnt lgkmcnt(4)
    v_mfma_f32_16x16x32_bf16 v[56:59], v[20:23], v[184:187], v[56:59]
    ds_read_b64_tr_b16 v[16:17], v1 offset:64
    v_fma_f32 v7, v7, v4, v6
    v_fma_f32 v197, v197, v4, v6
    v_cvt_pk_bf16_f32 v197, v7, v197
    v_lshlrev_b32 v7, 16, v198
    v_mfma_f32_16x16x32_bf16 v[60:63], v[20:23], v[188:191], v[60:63]
    ds_read_b64_tr_b16 v[18:19], v1 offset:832
    v_and_b32 v198, s60, v198
    v_fma_f32 v7, v7, v4, v6
    v_fma_f32 v198, v198, v4, v6
    v_mfma_f32_16x16x32_bf16 v[64:67], v[24:27], v[184:187], v[64:67]
    ds_read_b64_tr_b16 v[20:21], v1 offset:96
    v_cvt_pk_bf16_f32 v198, v7, v198
    v_lshlrev_b32 v7, 16, v199
    v_and_b32 v199, s60, v199
    v_mfma_f32_16x16x32_bf16 v[68:71], v[24:27], v[188:191], v[68:71]
    ds_read_b64_tr_b16 v[22:23], v1 offset:864
    v_fma_f32 v7, v7, v4, v6
    v_fma_f32 v199, v199, v4, v6
    v_cvt_pk_bf16_f32 v199, v7, v199
    v_mfma_f32_16x16x32_bf16 v[72:75], v[28:31], v[184:187], v[72:75]
    ds_read_b64_tr_b16 v[24:25], v1 offset:128
    v_lshlrev_b32 v7, 16, v200
    v_and_b32 v200, s60, v200
    v_fma_f32 v7, v7, v3, v5
    v_fma_f32 v200, v200, v3, v5
    v_mfma_f32_16x16x32_bf16 v[76:79], v[28:31], v[188:191], v[76:79]
    ds_read_b64_tr_b16 v[26:27], v1 offset:896
    v_cvt_pk_bf16_f32 v200, v7, v200
    v_lshlrev_b32 v7, 16, v201
    v_and_b32 v201, s60, v201
    s_waitcnt lgkmcnt(4)
    v_mfma_f32_16x16x32_bf16 v[32:35], v[8:11], v[192:195], v[32:35]
    ds_read_b64_tr_b16 v[28:29], v1 offset:160
    v_fma_f32 v7, v7, v3, v5
    v_fma_f32 v201, v201, v3, v5
    v_cvt_pk_bf16_f32 v201, v7, v201
    v_lshlrev_b32 v7, 16, v202
    v_mfma_f32_16x16x32_bf16 v[36:39], v[8:11], v[196:199], v[36:39]
    ds_read_b64_tr_b16 v[30:31], v1 offset:928
    v_and_b32 v202, s60, v202
    v_fma_f32 v7, v7, v3, v5
    v_fma_f32 v202, v202, v3, v5
    v_mfma_f32_16x16x32_bf16 v[40:43], v[12:15], v[192:195], v[40:43]
    ds_read_b64_tr_b16 v[8:9], v1 offset:6208
    v_cvt_pk_bf16_f32 v202, v7, v202
    v_lshlrev_b32 v7, 16, v203
    v_and_b32 v203, s60, v203
    v_mfma_f32_16x16x32_bf16 v[44:47], v[12:15], v[196:199], v[44:47]
    ds_read_b64_tr_b16 v[10:11], v1 offset:6976
    v_fma_f32 v7, v7, v3, v5
    v_fma_f32 v203, v203, v3, v5
    v_cvt_pk_bf16_f32 v203, v7, v203
    v_mfma_f32_16x16x32_bf16 v[48:51], v[16:19], v[192:195], v[48:51]
    ds_read_b64_tr_b16 v[12:13], v1 offset:6240
    v_lshlrev_b32 v7, 16, v204
    v_and_b32 v204, s60, v204
    v_fma_f32 v7, v7, v4, v6
    v_fma_f32 v204, v204, v4, v6
    v_mfma_f32_16x16x32_bf16 v[52:55], v[16:19], v[196:199], v[52:55]
    ds_read_b64_tr_b16 v[14:15], v1 offset:7008
    v_cvt_pk_bf16_f32 v204, v7, v204
    v_lshlrev_b32 v7, 16, v205
    v_and_b32 v205, s60, v205
    s_waitcnt lgkmcnt(4)
    v_mfma_f32_16x16x32_bf16 v[56:59], v[20:23], v[192:195], v[56:59]
    ds_read_b64_tr_b16 v[16:17], v1 offset:6272
    v_fma_f32 v7, v7, v4, v6
    v_fma_f32 v205, v205, v4, v6
    v_cvt_pk_bf16_f32 v205, v7, v205
    v_lshlrev_b32 v7, 16, v206
    v_mfma_f32_16x16x32_bf16 v[60:63], v[20:23], v[196:199], v[60:63]
    ds_read_b64_tr_b16 v[18:19], v1 offset:7040
    v_and_b32 v206, s60, v206
    v_fma_f32 v7, v7, v4, v6
    v_fma_f32 v206, v206, v4, v6
    v_mfma_f32_16x16x32_bf16 v[64:67], v[24:27], v[192:195], v[64:67]
    ds_read_b64_tr_b16 v[20:21], v1 offset:6304
    v_cvt_pk_bf16_f32 v206, v7, v206
    v_lshlrev_b32 v7, 16, v207
    v_and_b32 v207, s60, v207
    v_mfma_f32_16x16x32_bf16 v[68:71], v[24:27], v[196:199], v[68:71]
    ds_read_b64_tr_b16 v[22:23], v1 offset:7072
    v_fma_f32 v7, v7, v4, v6
    v_fma_f32 v207, v207, v4, v6
    v_cvt_pk_bf16_f32 v207, v7, v207
    v_mfma_f32_16x16x32_bf16 v[72:75], v[28:31], v[192:195], v[72:75]
    ds_read_b64_tr_b16 v[24:25], v1 offset:6336
    v_lshlrev_b32 v7, 16, v208
    v_and_b32 v208, s60, v208
    v_fma_f32 v7, v7, v3, v5
    v_fma_f32 v208, v208, v3, v5
    v_mfma_f32_16x16x32_bf16 v[76:79], v[28:31], v[196:199], v[76:79]
    ds_read_b64_tr_b16 v[26:27], v1 offset:7104
    v_cvt_pk_bf16_f32 v208, v7, v208
    v_lshlrev_b32 v7, 16, v209
    v_and_b32 v209, s60, v209
    s_waitcnt lgkmcnt(4)
    v_mfma_f32_16x16x32_bf16 v[32:35], v[8:11], v[200:203], v[32:35]
    ds_read_b64_tr_b16 v[28:29], v1 offset:6368
    v_fma_f32 v7, v7, v3, v5
    v_fma_f32 v209, v209, v3, v5
    v_cvt_pk_bf16_f32 v209, v7, v209
    v_lshlrev_b32 v7, 16, v210
    v_mfma_f32_16x16x32_bf16 v[36:39], v[8:11], v[204:207], v[36:39]
    ds_read_b64_tr_b16 v[30:31], v1 offset:7136
    v_and_b32 v210, s60, v210
    v_fma_f32 v7, v7, v3, v5
    v_fma_f32 v210, v210, v3, v5
    v_mfma_f32_16x16x32_bf16 v[40:43], v[12:15], v[200:203], v[40:43]
    ds_read_b64_tr_b16 v[8:9], v1 offset:12416
    v_cvt_pk_bf16_f32 v210, v7, v210
    v_lshlrev_b32 v7, 16, v211
    v_and_b32 v211, s60, v211
    v_mfma_f32_16x16x32_bf16 v[44:47], v[12:15], v[204:207], v[44:47]
    ds_read_b64_tr_b16 v[10:11], v1 offset:13184
    v_fma_f32 v7, v7, v3, v5
    v_fma_f32 v211, v211, v3, v5
    v_cvt_pk_bf16_f32 v211, v7, v211
    v_mfma_f32_16x16x32_bf16 v[48:51], v[16:19], v[200:203], v[48:51]
    ds_read_b64_tr_b16 v[12:13], v1 offset:12448
    v_lshlrev_b32 v7, 16, v212
    v_and_b32 v212, s60, v212
    v_fma_f32 v7, v7, v4, v6
    v_fma_f32 v212, v212, v4, v6
    v_mfma_f32_16x16x32_bf16 v[52:55], v[16:19], v[204:207], v[52:55]
    ds_read_b64_tr_b16 v[14:15], v1 offset:13216
    v_cvt_pk_bf16_f32 v212, v7, v212
    v_lshlrev_b32 v7, 16, v213
    v_and_b32 v213, s60, v213
    s_waitcnt lgkmcnt(4)
    v_mfma_f32_16x16x32_bf16 v[56:59], v[20:23], v[200:203], v[56:59]
    ds_read_b64_tr_b16 v[16:17], v1 offset:12480
    v_fma_f32 v7, v7, v4, v6
    v_fma_f32 v213, v213, v4, v6
    v_cvt_pk_bf16_f32 v213, v7, v213
    v_lshlrev_b32 v7, 16, v214
    v_mfma_f32_16x16x32_bf16 v[60:63], v[20:23], v[204:207], v[60:63]
    ds_read_b64_tr_b16 v[18:19], v1 offset:13248
    v_and_b32 v214, s60, v214
    v_fma_f32 v7, v7, v4, v6
    v_fma_f32 v214, v214, v4, v6
    v_mfma_f32_16x16x32_bf16 v[64:67], v[24:27], v[200:203], v[64:67]
    ds_read_b64_tr_b16 v[20:21], v1 offset:12512
    v_cvt_pk_bf16_f32 v214, v7, v214
    v_lshlrev_b32 v7, 16, v215
    v_and_b32 v215, s60, v215
    v_mfma_f32_16x16x32_bf16 v[68:71], v[24:27], v[204:207], v[68:71]
    ds_read_b64_tr_b16 v[22:23], v1 offset:13280
    v_fma_f32 v7, v7, v4, v6
    v_fma_f32 v215, v215, v4, v6
    v_cvt_pk_bf16_f32 v215, v7, v215
    v_mfma_f32_16x16x32_bf16 v[72:75], v[28:31], v[200:203], v[72:75]
    ds_read_b64_tr_b16 v[24:25], v1 offset:12544
    v_lshlrev_b32 v7, 16, v216
    v_and_b32 v216, s60, v216
    v_fma_f32 v7, v7, v3, v5
    v_fma_f32 v216, v216, v3, v5
    v_mfma_f32_16x16x32_bf16 v[76:79], v[28:31], v[204:207], v[76:79]
    ds_read_b64_tr_b16 v[26:27], v1 offset:13312
    v_cvt_pk_bf16_f32 v216, v7, v216
    v_lshlrev_b32 v7, 16, v217
    v_and_b32 v217, s60, v217
    s_waitcnt lgkmcnt(4)
    v_mfma_f32_16x16x32_bf16 v[32:35], v[8:11], v[208:211], v[32:35]
    ds_read_b64_tr_b16 v[28:29], v1 offset:12576
    v_fma_f32 v7, v7, v3, v5
    v_fma_f32 v217, v217, v3, v5
    v_cvt_pk_bf16_f32 v217, v7, v217
    v_lshlrev_b32 v7, 16, v218
    v_mfma_f32_16x16x32_bf16 v[36:39], v[8:11], v[212:215], v[36:39]
    ds_read_b64_tr_b16 v[30:31], v1 offset:13344
    v_and_b32 v218, s60, v218
    v_fma_f32 v7, v7, v3, v5
    v_fma_f32 v218, v218, v3, v5
    v_mfma_f32_16x16x32_bf16 v[40:43], v[12:15], v[208:211], v[40:43]
    ds_read_b64_tr_b16 v[8:9], v1 offset:18624
    v_cvt_pk_bf16_f32 v218, v7, v218
    v_lshlrev_b32 v7, 16, v219
    v_and_b32 v219, s60, v219
    v_mfma_f32_16x16x32_bf16 v[44:47], v[12:15], v[212:215], v[44:47]
    ds_read_b64_tr_b16 v[10:11], v1 offset:19392
    v_fma_f32 v7, v7, v3, v5
    v_fma_f32 v219, v219, v3, v5
    v_cvt_pk_bf16_f32 v219, v7, v219
    v_mfma_f32_16x16x32_bf16 v[48:51], v[16:19], v[208:211], v[48:51]
    ds_read_b64_tr_b16 v[12:13], v1 offset:18656
    v_lshlrev_b32 v7, 16, v220
    v_and_b32 v220, s60, v220
    v_fma_f32 v7, v7, v4, v6
    v_fma_f32 v220, v220, v4, v6
    v_mfma_f32_16x16x32_bf16 v[52:55], v[16:19], v[212:215], v[52:55]
    ds_read_b64_tr_b16 v[14:15], v1 offset:19424
    v_cvt_pk_bf16_f32 v220, v7, v220
    v_lshlrev_b32 v7, 16, v221
    v_and_b32 v221, s60, v221
    s_waitcnt lgkmcnt(4)
    v_mfma_f32_16x16x32_bf16 v[56:59], v[20:23], v[208:211], v[56:59]
    ds_read_b64_tr_b16 v[16:17], v1 offset:18688
    v_fma_f32 v7, v7, v4, v6
    v_fma_f32 v221, v221, v4, v6
    v_cvt_pk_bf16_f32 v221, v7, v221
    v_lshlrev_b32 v7, 16, v222
    v_mfma_f32_16x16x32_bf16 v[60:63], v[20:23], v[212:215], v[60:63]
    ds_read_b64_tr_b16 v[18:19], v1 offset:19456
    v_and_b32 v222, s60, v222
    v_fma_f32 v7, v7, v4, v6
    v_fma_f32 v222, v222, v4, v6
    v_mfma_f32_16x16x32_bf16 v[64:67], v[24:27], v[208:211], v[64:67]
    ds_read_b64_tr_b16 v[20:21], v1 offset:18720
    v_cvt_pk_bf16_f32 v222, v7, v222
    v_lshlrev_b32 v7, 16, v223
    v_and_b32 v223, s60, v223
    v_mfma_f32_16x16x32_bf16 v[68:71], v[24:27], v[212:215], v[68:71]
    ds_read_b64_tr_b16 v[22:23], v1 offset:19488
    v_fma_f32 v7, v7, v4, v6
    v_fma_f32 v223, v223, v4, v6
    v_cvt_pk_bf16_f32 v223, v7, v223
    v_mfma_f32_16x16x32_bf16 v[72:75], v[28:31], v[208:211], v[72:75]
    ds_read_b64_tr_b16 v[24:25], v1 offset:18752
    v_lshlrev_b32 v7, 16, v224
    v_and_b32 v224, s60, v224
    v_fma_f32 v7, v7, v3, v5
    v_fma_f32 v224, v224, v3, v5
    v_mfma_f32_16x16x32_bf16 v[76:79], v[28:31], v[212:215], v[76:79]
    ds_read_b64_tr_b16 v[26:27], v1 offset:19520
    v_cvt_pk_bf16_f32 v224, v7, v224
    v_lshlrev_b32 v7, 16, v225
    v_and_b32 v225, s60, v225
    s_waitcnt lgkmcnt(4)
    v_mfma_f32_16x16x32_bf16 v[32:35], v[8:11], v[216:219], v[32:35]
    ds_read_b64_tr_b16 v[28:29], v1 offset:18784
    v_fma_f32 v7, v7, v3, v5
    v_fma_f32 v225, v225, v3, v5
    v_cvt_pk_bf16_f32 v225, v7, v225
    v_lshlrev_b32 v7, 16, v226
    v_mfma_f32_16x16x32_bf16 v[36:39], v[8:11], v[220:223], v[36:39]
    ds_read_b64_tr_b16 v[30:31], v1 offset:19552
    v_and_b32 v226, s60, v226
    v_fma_f32 v7, v7, v3, v5
    v_fma_f32 v226, v226, v3, v5
    v_mfma_f32_16x16x32_bf16 v[40:43], v[12:15], v[216:219], v[40:43]
    s_barrier
    ds_read_b64_tr_b16 v[8:9], v1 offset:24832
    v_cvt_pk_bf16_f32 v226, v7, v226
    v_lshlrev_b32 v7, 16, v227
    v_and_b32 v227, s60, v227
    v_mfma_f32_16x16x32_bf16 v[44:47], v[12:15], v[220:223], v[44:47]
    ds_read_b64_tr_b16 v[10:11], v1 offset:25600
    v_fma_f32 v7, v7, v3, v5
    v_fma_f32 v227, v227, v3, v5
    v_cvt_pk_bf16_f32 v227, v7, v227
    v_mfma_f32_16x16x32_bf16 v[48:51], v[16:19], v[216:219], v[48:51]
    ds_read_b64_tr_b16 v[12:13], v1 offset:24864
    v_lshlrev_b32 v7, 16, v228
    v_and_b32 v228, s60, v228
    v_fma_f32 v7, v7, v4, v6
    v_fma_f32 v228, v228, v4, v6
    v_mfma_f32_16x16x32_bf16 v[52:55], v[16:19], v[220:223], v[52:55]
    ds_read_b64_tr_b16 v[14:15], v1 offset:25632
    v_cvt_pk_bf16_f32 v228, v7, v228
    s_cmp_lg_u32 s24, 1
    s_cbranch_scc1 PK_noadd
    s_and_b32 s35, s2, 15
    s_lshl_b32 s35, s35, 4
    v_mov_b32 v7, 1
    s_mov_b64 exec, 1
    buffer_atomic_add v7, off, s[52:55], s35 sc1
    s_mov_b64 exec, -1
PK_noadd:
    v_lshlrev_b32 v7, 16, v229
    v_and_b32 v229, s60, v229
    s_waitcnt lgkmcnt(4)
    v_mfma_f32_16x16x32_bf16 v[56:59], v[20:23], v[216:219], v[56:59]
    ds_read_b64_tr_b16 v[16:17], v1 offset:24896
    v_fma_f32 v7, v7, v4, v6
    v_fma_f32 v229, v229, v4, v6
    v_cvt_pk_bf16_f32 v229, v7, v229
    v_lshlrev_b32 v7, 16, v230
    v_mfma_f32_16x16x32_bf16 v[60:63], v[20:23], v[220:223], v[60:63]
    ds_read_b64_tr_b16 v[18:19], v1 offset:25664
    v_and_b32 v230, s60, v230
    v_fma_f32 v7, v7, v4, v6
    v_fma_f32 v230, v230, v4, v6
    v_mfma_f32_16x16x32_bf16 v[64:67], v[24:27], v[216:219], v[64:67]
    ds_read_b64_tr_b16 v[20:21], v1 offset:24928
    v_cvt_pk_bf16_f32 v230, v7, v230
    v_lshlrev_b32 v7, 16, v231
    v_and_b32 v231, s60, v231
    v_mfma_f32_16x16x32_bf16 v[68:71], v[24:27], v[220:223], v[68:71]
    ds_read_b64_tr_b16 v[22:23], v1 offset:25696
    v_fma_f32 v7, v7, v4, v6
    v_fma_f32 v231, v231, v4, v6
    v_cvt_pk_bf16_f32 v231, v7, v231
    v_mfma_f32_16x16x32_bf16 v[72:75], v[28:31], v[216:219], v[72:75]
    ds_read_b64_tr_b16 v[24:25], v1 offset:24960
    v_lshlrev_b32 v7, 16, v232
    v_and_b32 v232, s60, v232
    v_fma_f32 v7, v7, v3, v5
    v_fma_f32 v232, v232, v3, v5
    v_mfma_f32_16x16x32_bf16 v[76:79], v[28:31], v[220:223], v[76:79]
    ds_read_b64_tr_b16 v[26:27], v1 offset:25728
    v_cvt_pk_bf16_f32 v232, v7, v232
    v_lshlrev_b32 v7, 16, v233
    v_and_b32 v233, s60, v233
    s_waitcnt lgkmcnt(4)
    v_mfma_f32_16x16x32_bf16 v[32:35], v[8:11], v[224:227], v[32:35]
    ds_read_b64_tr_b16 v[28:29], v1 offset:24992
    v_fma_f32 v7, v7, v3, v5
    v_fma_f32 v233, v233, v3, v5
    v_cvt_pk_bf16_f32 v233, v7, v233
    v_lshlrev_b32 v7, 16, v234
    v_mfma_f32_16x16x32_bf16 v[36:39], v[8:11], v[228:231], v[36:39]
    ds_read_b64_tr_b16 v[30:31], v1 offset:25760
    v_and_b32 v234, s60, v234
    v_fma_f32 v7, v7, v3, v5
    v_fma_f32 v234, v234, v3, v5
    v_mfma_f32_16x16x32_bf16 v[40:43], v[12:15], v[224:227], v[40:43]
    ds_read_b64_tr_b16 v[8:9], v1 offset:31040
    v_cvt_pk_bf16_f32 v234, v7, v234
    v_lshlrev_b32 v7, 16, v235
    v_and_b32 v235, s60, v235
    v_mfma_f32_16x16x32_bf16 v[44:47], v[12:15], v[228:231], v[44:47]
    ds_read_b64_tr_b16 v[10:11], v1 offset:31808
    v_fma_f32 v7, v7, v3, v5
    v_fma_f32 v235, v235, v3, v5
    v_cvt_pk_bf16_f32 v235, v7, v235
    v_mfma_f32_16x16x32_bf16 v[48:51], v[16:19], v[224:227], v[48:51]
    ds_read_b64_tr_b16 v[12:13], v1 offset:31072
    v_lshlrev_b32 v7, 16, v236
    v_and_b32 v236, s60, v236
    v_fma_f32 v7, v7, v4, v6
    v_fma_f32 v236, v236, v4, v6
    v_mfma_f32_16x16x32_bf16 v[52:55], v[16:19], v[228:231], v[52:55]
    ds_read_b64_tr_b16 v[14:15], v1 offset:31840
    v_cvt_pk_bf16_f32 v236, v7, v236
    v_lshlrev_b32 v7, 16, v237
    v_and_b32 v237, s60, v237
    s_waitcnt lgkmcnt(4)
    v_mfma_f32_16x16x32_bf16 v[56:59], v[20:23], v[224:227], v[56:59]
    ds_read_b64_tr_b16 v[16:17], v1 offset:31104
    v_fma_f32 v7, v7, v4, v6
    v_fma_f32 v237, v237, v4, v6
    v_cvt_pk_bf16_f32 v237, v7, v237
    v_lshlrev_b32 v7, 16, v238
    v_mfma_f32_16x16x32_bf16 v[60:63], v[20:23], v[228:231], v[60:63]
    ds_read_b64_tr_b16 v[18:19], v1 offset:31872
    v_and_b32 v238, s60, v238
    v_fma_f32 v7, v7, v4, v6
    v_fma_f32 v238, v238, v4, v6
    v_mfma_f32_16x16x32_bf16 v[64:67], v[24:27], v[224:227], v[64:67]
    ds_read_b64_tr_b16 v[20:21], v1 offset:31136
    v_cvt_pk_bf16_f32 v238, v7, v238
    v_lshlrev_b32 v7, 16, v239
    v_and_b32 v239, s60, v239
    v_mfma_f32_16x16x32_bf16 v[68:71], v[24:27], v[228:231], v[68:71]
    ds_read_b64_tr_b16 v[22:23], v1 offset:31904
    v_fma_f32 v7, v7, v4, v6
    v_fma_f32 v239, v239, v4, v6
    v_cvt_pk_bf16_f32 v239, v7, v239
    v_mfma_f32_16x16x32_bf16 v[72:75], v[28:31], v[224:227], v[72:75]
    ds_read_b64_tr_b16 v[24:25], v1 offset:31168
    v_lshlrev_b32 v7, 16, v240
    v_and_b32 v240, s60, v240
    v_fma_f32 v7, v7, v3, v5
    v_fma_f32 v240, v240, v3, v5
    v_mfma_f32_16x16x32_bf16 v[76:79], v[28:31], v[228:231], v[76:79]
    ds_read_b64_tr_b16 v[26:27], v1 offset:31936
    v_cvt_pk_bf16_f32 v240, v7, v240
    v_lshlrev_b32 v7, 16, v241
    v_and_b32 v241, s60, v241
    s_waitcnt lgkmcnt(4)
    v_mfma_f32_16x16x32_bf16 v[32:35], v[8:11], v[232:235], v[32:35]
    ds_read_b64_tr_b16 v[28:29], v1 offset:31200
    v_fma_f32 v7, v7, v3, v5
    v_fma_f32 v241, v241, v3, v5
    v_cvt_pk_bf16_f32 v241, v7, v241
    v_lshlrev_b32 v7, 16, v242
    v_mfma_f32_16x16x32_bf16 v[36:39], v[8:11], v[236:239], v[36:39]
    ds_read_b64_tr_b16 v[30:31], v1 offset:31968
    v_and_b32 v242, s60, v242
    v_fma_f32 v7, v7, v3, v5
    v_fma_f32 v242, v242, v3, v5
    v_mfma_f32_16x16x32_bf16 v[40:43], v[12:15], v[232:235], v[40:43]
    ds_read_b64_tr_b16 v[8:9], v0 offset:0
    v_cvt_pk_bf16_f32 v242, v7, v242
    v_lshlrev_b32 v7, 16, v243
    v_and_b32 v243, s60, v243
    v_mfma_f32_16x16x32_bf16 v[44:47], v[12:15], v[236:239], v[44:47]
    ds_read_b64_tr_b16 v[10:11], v0 offset:768
    v_fma_f32 v7, v7, v3, v5
    v_fma_f32 v243, v243, v3, v5
    v_cvt_pk_bf16_f32 v243, v7, v243
    v_mfma_f32_16x16x32_bf16 v[48:51], v[16:19], v[232:235], v[48:51]
    ds_read_b64_tr_b16 v[12:13], v0 offset:32
    v_lshlrev_b32 v7, 16, v244
    v_and_b32 v244, s60, v244
    v_fma_f32 v7, v7, v4, v6
    v_fma_f32 v244, v244, v4, v6
    v_mfma_f32_16x16x32_bf16 v[52:55], v[16:19], v[236:239], v[52:55]
    ds_read_b64_tr_b16 v[14:15], v0 offset:800
    v_cvt_pk_bf16_f32 v244, v7, v244
    v_lshlrev_b32 v7, 16, v245
    v_and_b32 v245, s60, v245
    s_waitcnt lgkmcnt(4)
    v_mfma_f32_16x16x32_bf16 v[56:59], v[20:23], v[232:235], v[56:59]
    ds_read_b64_tr_b16 v[16:17], v0 offset:64
    v_fma_f32 v7, v7, v4, v6
    v_fma_f32 v245, v245, v4, v6
    v_cvt_pk_bf16_f32 v245, v7, v245
    v_lshlrev_b32 v7, 16, v246
    v_mfma_f32_16x16x32_bf16 v[60:63], v[20:23], v[236:239], v[60:63]
    ds_read_b64_tr_b16 v[18:19], v0 offset:832
    v_and_b32 v246, s60, v246
    v_fma_f32 v7, v7, v4, v6
    v_fma_f32 v246, v246, v4, v6
    v_mfma_f32_16x16x32_bf16 v[64:67], v[24:27], v[232:235], v[64:67]
    ds_read_b64_tr_b16 v[20:21], v0 offset:96
    v_cvt_pk_bf16_f32 v246, v7, v246
    v_lshlrev_b32 v7, 16, v247
    v_and_b32 v247, s60, v247
    v_mfma_f32_16x16x32_bf16 v[68:71], v[24:27], v[236:239], v[68:71]
    ds_read_b64_tr_b16 v[22:23], v0 offset:864
    v_fma_f32 v7, v7, v4, v6
    v_fma_f32 v247, v247, v4, v6
    v_cvt_pk_bf16_f32 v247, v7, v247
    v_mfma_f32_16x16x32_bf16 v[72:75], v[28:31], v[232:235], v[72:75]
    ds_read_b64_tr_b16 v[24:25], v0 offset:128
    v_lshlrev_b32 v7, 16, v248
    v_and_b32 v248, s60, v248
    v_fma_f32 v7, v7, v3, v5
    v_fma_f32 v248, v248, v3, v5
    v_mfma_f32_16x16x32_bf16 v[76:79], v[28:31], v[236:239], v[76:79]
    ds_read_b64_tr_b16 v[26:27], v0 offset:896
    v_cvt_pk_bf16_f32 v248, v7, v248
    v_lshlrev_b32 v7, 16, v249
    v_and_b32 v249, s60, v249
    s_waitcnt lgkmcnt(4)
    v_mfma_f32_16x16x32_bf16 v[32:35], v[8:11], v[240:243], v[32:35]
    ds_read_b64_tr_b16 v[28:29], v0 offset:160
    v_fma_f32 v7, v7, v3, v5
    v_fma_f32 v249, v249, v3, v5
    v_cvt_pk_bf16_f32 v249, v7, v249
    v_lshlrev_b32 v7, 16, v250
    v_mfma_f32_16x16x32_bf16 v[36:39], v[8:11], v[244:247], v[36:39]
    ds_read_b64_tr_b16 v[30:31], v0 offset:928
    v_and_b32 v250, s60, v250
    v_fma_f32 v7, v7, v3, v5
    v_fma_f32 v250, v250, v3, v5
    v_mfma_f32_16x16x32_bf16 v[40:43], v[12:15], v[240:243], v[40:43]
    ds_read_b64_tr_b16 v[8:9], v0 offset:6208
    v_cvt_pk_bf16_f32 v250, v7, v250
    v_lshlrev_b32 v7, 16, v251
    v_and_b32 v251, s60, v251
    v_mfma_f32_16x16x32_bf16 v[44:47], v[12:15], v[244:247], v[44:47]
    ds_read_b64_tr_b16 v[10:11], v0 offset:6976
    v_fma_f32 v7, v7, v3, v5
    v_fma_f32 v251, v251, v3, v5
    v_cvt_pk_bf16_f32 v251, v7, v251
    v_mfma_f32_16x16x32_bf16 v[48:51], v[16:19], v[240:243], v[48:51]
    ds_read_b64_tr_b16 v[12:13], v0 offset:6240
    v_lshlrev_b32 v7, 16, v252
    v_and_b32 v252, s60, v252
    v_fma_f32 v7, v7, v4, v6
    v_fma_f32 v252, v252, v4, v6
    v_mfma_f32_16x16x32_bf16 v[52:55], v[16:19], v[244:247], v[52:55]
    ds_read_b64_tr_b16 v[14:15], v0 offset:7008
    v_cvt_pk_bf16_f32 v252, v7, v252
    v_lshlrev_b32 v7, 16, v253
    v_and_b32 v253, s60, v253
    s_waitcnt lgkmcnt(4)
    v_mfma_f32_16x16x32_bf16 v[56:59], v[20:23], v[240:243], v[56:59]
    ds_read_b64_tr_b16 v[16:17], v0 offset:6272
    v_fma_f32 v7, v7, v4, v6
    v_fma_f32 v253, v253, v4, v6
    v_cvt_pk_bf16_f32 v253, v7, v253
    v_lshlrev_b32 v7, 16, v254
    v_mfma_f32_16x16x32_bf16 v[60:63], v[20:23], v[244:247], v[60:63]
    ds_read_b64_tr_b16 v[18:19], v0 offset:7040
    v_and_b32 v254, s60, v254
    v_fma_f32 v7, v7, v4, v6
    v_fma_f32 v254, v254, v4, v6
    v_mfma_f32_16x16x32_bf16 v[64:67], v[24:27], v[240:243], v[64:67]
    ds_read_b64_tr_b16 v[20:21], v0 offset:6304
    v_cvt_pk_bf16_f32 v254, v7, v254
    v_lshlrev_b32 v7, 16, v255
    v_and_b32 v255, s60, v255
    v_mfma_f32_16x16x32_bf16 v[68:71], v[24:27], v[244:247], v[68:71]
    ds_read_b64_tr_b16 v[22:23], v0 offset:7072
    v_fma_f32 v7, v7, v4, v6
    v_fma_f32 v255, v255, v4, v6
    v_cvt_pk_bf16_f32 v255, v7, v255
    v_mfma_f32_16x16x32_bf16 v[72:75], v[28:31], v[240:243], v[72:75]
    ds_read_b64_tr_b16 v[24:25], v0 offset:6336
    v_mfma_f32_16x16x32_bf16 v[76:79], v[28:31], v[244:247], v[76:79]
    ds_read_b64_tr_b16 v[26:27], v0 offset:7104
    s_waitcnt lgkmcnt(4)
    v_mfma_f32_16x16x32_bf16 v[32:35], v[8:11], v[248:251], v[32:35]
    ds_read_b64_tr_b16 v[28:29], v0 offset:6368
    v_mfma_f32_16x16x32_bf16 v[36:39], v[8:11], v[252:255], v[36:39]
    ds_read_b64_tr_b16 v[30:31], v0 offset:7136
    v_mfma_f32_16x16x32_bf16 v[40:43], v[12:15], v[248:251], v[40:43]
    s_barrier
    ds_read_b64_tr_b16 v[8:9], v1 offset:37248
    v_mfma_f32_16x16x32_bf16 v[44:47], v[12:15], v[252:255], v[44:47]
    ds_read_b64_tr_b16 v[10:11], v1 offset:38016
    v_mfma_f32_16x16x32_bf16 v[48:51], v[16:19], v[248:251], v[48:51]
    ds_read_b64_tr_b16 v[12:13], v1 offset:37280
    v_mfma_f32_16x16x32_bf16 v[52:55], v[16:19], v[252:255], v[52:55]
    ds_read_b64_tr_b16 v[14:15], v1 offset:38048
    s_waitcnt lgkmcnt(4)
    v_mfma_f32_16x16x32_bf16 v[56:59], v[20:23], v[248:251], v[56:59]
    ds_read_b64_tr_b16 v[16:17], v1 offset:37312
    v_mfma_f32_16x16x32_bf16 v[60:63], v[20:23], v[252:255], v[60:63]
    ds_read_b64_tr_b16 v[18:19], v1 offset:38080
    v_mfma_f32_16x16x32_bf16 v[64:67], v[24:27], v[248:251], v[64:67]
    ds_read_b64_tr_b16 v[20:21], v1 offset:37344
    v_mfma_f32_16x16x32_bf16 v[68:71], v[24:27], v[252:255], v[68:71]
    ds_read_b64_tr_b16 v[22:23], v1 offset:38112
    v_mfma_f32_16x16x32_bf16 v[72:75], v[28:31], v[248:251], v[72:75]
    ds_read_b64_tr_b16 v[24:25], v1 offset:37376
    v_mfma_f32_16x16x32_bf16 v[76:79], v[28:31], v[252:255], v[76:79]
    ds_read_b64_tr_b16 v[26:27], v1 offset:38144
    s_cmp_lt_u32 s3, 10
    s_cbranch_scc1 PK_alt
    s_cmp_eq_u32 s3, 10
    s_cbranch_scc1 PK_kkv
    s_waitcnt lgkmcnt(4)
    v_mfma_f32_16x16x32_bf16 v[80:83], v[8:11], v[128:131], 0
    ds_read_b64_tr_b16 v[28:29], v1 offset:37408
    v_mbcnt_lo_u32_b32 v7, -1, 0
    v_mbcnt_hi_u32_b32 v7, -1, v7
    v_mfma_f32_16x16x32_bf16 v[84:87], v[8:11], v[132:135], 0
    ds_read_b64_tr_b16 v[30:31], v1 offset:38176
    v_and_b32 v4, 31, v7
    v_mul_u32_u24 v4, 80, v4
    v_mfma_f32_16x16x32_bf16 v[88:91], v[12:15], v[128:131], 0
    ds_read_b64_tr_b16 v[8:9], v1 offset:43456
    v_lshrrev_b32 v3, 5, v7
    v_lshl_add_u32 v4, v3, 4, v4
    v_mfma_f32_16x16x32_bf16 v[92:95], v[12:15], v[132:135], 0
    ds_read_b64_tr_b16 v[10:11], v1 offset:44224
    v_add_u32 v4, s94, v4
    v_lshrrev_b32 v3, 5, v7
    v_mfma_f32_16x16x32_bf16 v[96:99], v[16:19], v[128:131], 0
    ds_read_b64_tr_b16 v[12:13], v1 offset:43488
    v_bfe_u32 v6, v7, 2, 2
    v_lshl_add_u32 v3, v3, 3, v6
    v_mfma_f32_16x16x32_bf16 v[100:103], v[16:19], v[132:135], 0
    ds_read_b64_tr_b16 v[14:15], v1 offset:44256
    v_mul_u32_u24 v5, 80, v3
    v_bfe_u32 v3, v7, 4, 1
    s_waitcnt lgkmcnt(4)
    v_mfma_f32_16x16x32_bf16 v[104:107], v[20:23], v[128:131], 0
    ds_read_b64_tr_b16 v[16:17], v1 offset:43520
    v_lshl_add_u32 v5, v3, 5, v5
    v_and_b32 v3, 1, v7
    v_mfma_f32_16x16x32_bf16 v[108:111], v[20:23], v[132:135], 0
    ds_read_b64_tr_b16 v[18:19], v1 offset:44288
    v_lshl_add_u32 v5, v3, 4, v5
    v_bfe_u32 v3, v7, 1, 1
    v_mfma_f32_16x16x32_bf16 v[112:115], v[24:27], v[128:131], 0
    ds_read_b64_tr_b16 v[20:21], v1 offset:43552
    v_lshl_add_u32 v5, v3, 3, v5
    v_add_u32 v5, s94, v5
    v_mfma_f32_16x16x32_bf16 v[116:119], v[24:27], v[132:135], 0
    ds_read_b64_tr_b16 v[22:23], v1 offset:44320
    v_bfe_u32 v6, v7, 4, 1
    v_lshlrev_b32 v6, 16, v6
    v_mfma_f32_16x16x32_bf16 v[120:123], v[28:31], v[128:131], 0
    ds_read_b64_tr_b16 v[24:25], v1 offset:43584
    v_lshrrev_b32 v3, 5, v7
    v_lshl_add_u32 v6, v3, 8, v6
    v_mfma_f32_16x16x32_bf16 v[124:127], v[28:31], v[132:135], 0
    ds_read_b64_tr_b16 v[26:27], v1 offset:44352
    v_and_b32 v3, 15, v7
    v_lshl_add_u32 v6, v3, 4, v6
    s_waitcnt lgkmcnt(4)
    v_mfma_f32_16x16x32_bf16 v[80:83], v[8:11], v[136:139], v[80:83]
    ds_read_b64_tr_b16 v[28:29], v1 offset:43616
    v_lshlrev_b32 v3, 4, v7
    v_cvt_pk_bf16_f32 v32, v32, v33
    v_mfma_f32_16x16x32_bf16 v[84:87], v[8:11], v[140:143], v[84:87]
    ds_read_b64_tr_b16 v[30:31], v1 offset:44384
    v_cvt_pk_bf16_f32 v33, v34, v35
    v_cvt_pk_bf16_f32 v34, v36, v37
    v_mfma_f32_16x16x32_bf16 v[88:91], v[12:15], v[136:139], v[88:91]
    ds_read_b64_tr_b16 v[8:9], v2 offset:0
    v_cvt_pk_bf16_f32 v35, v38, v39
    v_cvt_pk_bf16_f32 v40, v40, v41
    v_mfma_f32_16x16x32_bf16 v[92:95], v[12:15], v[140:143], v[92:95]
    ds_read_b64_tr_b16 v[10:11], v2 offset:768
    v_cvt_pk_bf16_f32 v41, v42, v43
    v_cvt_pk_bf16_f32 v42, v44, v45
    v_mfma_f32_16x16x32_bf16 v[96:99], v[16:19], v[136:139], v[96:99]
    ds_read_b64_tr_b16 v[12:13], v2 offset:32
    v_cvt_pk_bf16_f32 v43, v46, v47
    v_permlane16_swap_b32 v32, v34
    v_mfma_f32_16x16x32_bf16 v[100:103], v[16:19], v[140:143], v[100:103]
    ds_read_b64_tr_b16 v[14:15], v2 offset:800
    v_permlane16_swap_b32 v33, v35
    v_permlane16_swap_b32 v40, v42
    s_waitcnt lgkmcnt(4)
    v_mfma_f32_16x16x32_bf16 v[104:107], v[20:23], v[136:139], v[104:107]
    ds_read_b64_tr_b16 v[16:17], v2 offset:64
    v_permlane16_swap_b32 v41, v43
    v_mfma_f32_16x16x32_bf16 v[108:111], v[20:23], v[140:143], v[108:111]
    ds_read_b64_tr_b16 v[18:19], v2 offset:832
    v_mfma_f32_16x16x32_bf16 v[112:115], v[24:27], v[136:139], v[112:115]
    ds_read_b64_tr_b16 v[20:21], v2 offset:96
    ds_write_b128 v4, v[32:35]
    ds_write_b128 v4, v[40:43] offset:32
    v_cvt_pk_bf16_f32 v48, v48, v49
    v_mfma_f32_16x16x32_bf16 v[116:119], v[24:27], v[140:143], v[116:119]
    ds_read_b64_tr_b16 v[22:23], v2 offset:864
    v_cvt_pk_bf16_f32 v49, v50, v51
    v_mfma_f32_16x16x32_bf16 v[120:123], v[28:31], v[136:139], v[120:123]
    ds_read_b64_tr_b16 v[24:25], v2 offset:128
    v_cvt_pk_bf16_f32 v50, v52, v53
    v_cvt_pk_bf16_f32 v51, v54, v55
    v_mfma_f32_16x16x32_bf16 v[124:127], v[28:31], v[140:143], v[124:127]
    ds_read_b64_tr_b16 v[26:27], v2 offset:896
    v_cvt_pk_bf16_f32 v56, v56, v57
    v_cvt_pk_bf16_f32 v57, v58, v59
    s_waitcnt lgkmcnt(6)
    v_mfma_f32_16x16x32_bf16 v[80:83], v[8:11], v[144:147], v[80:83]
    ds_read_b64_tr_b16 v[28:29], v2 offset:160
    v_cvt_pk_bf16_f32 v58, v60, v61
    v_cvt_pk_bf16_f32 v59, v62, v63
    v_mfma_f32_16x16x32_bf16 v[84:87], v[8:11], v[148:151], v[84:87]
    ds_read_b64_tr_b16 v[30:31], v2 offset:928
    v_permlane16_swap_b32 v48, v50
    v_permlane16_swap_b32 v49, v51
    v_mfma_f32_16x16x32_bf16 v[88:91], v[12:15], v[144:147], v[88:91]
    ds_read_b64_tr_b16 v[8:9], v2 offset:6208
    v_permlane16_swap_b32 v56, v58
    v_mfma_f32_16x16x32_bf16 v[92:95], v[12:15], v[148:151], v[92:95]
    ds_read_b64_tr_b16 v[10:11], v2 offset:6976
    v_permlane16_swap_b32 v57, v59
    v_mfma_f32_16x16x32_bf16 v[96:99], v[16:19], v[144:147], v[96:99]
    ds_read_b64_tr_b16 v[12:13], v2 offset:6240
    s_waitcnt lgkmcnt(8)
    ds_read_b64_tr_b16 v[36:37], v5 offset:0
    ds_read_b64_tr_b16 v[38:39], v5 offset:320
    ds_read_b64_tr_b16 v[44:45], v5 offset:1280
    v_mfma_f32_16x16x32_bf16 v[100:103], v[16:19], v[148:151], v[100:103]
    ds_read_b64_tr_b16 v[14:15], v2 offset:7008
    s_waitcnt lgkmcnt(7)
    v_mfma_f32_16x16x32_bf16 v[104:107], v[20:23], v[144:147], v[104:107]
    ds_read_b64_tr_b16 v[16:17], v2 offset:6272
    ds_read_b64_tr_b16 v[46:47], v5 offset:1600
    v_mfma_f32_16x16x32_bf16 v[108:111], v[20:23], v[148:151], v[108:111]
    ds_read_b64_tr_b16 v[18:19], v2 offset:7040
    v_mfma_f32_16x16x32_bf16 v[112:115], v[24:27], v[144:147], v[112:115]
    ds_read_b64_tr_b16 v[20:21], v2 offset:6304
    v_mfma_f32_16x16x32_bf16 v[116:119], v[24:27], v[148:151], v[116:119]
    ds_read_b64_tr_b16 v[22:23], v2 offset:7072
    v_mfma_f32_16x16x32_bf16 v[120:123], v[28:31], v[144:147], v[120:123]
    ds_read_b64_tr_b16 v[24:25], v2 offset:6336
    s_waitcnt lgkmcnt(4)
    ds_write_b128 v4, v[48:51]
    ds_write_b128 v4, v[56:59] offset:32
    v_cvt_pk_bf16_f32 v64, v64, v65
    v_mfma_f32_16x16x32_bf16 v[124:127], v[28:31], v[148:151], v[124:127]
    ds_read_b64_tr_b16 v[26:27], v2 offset:7104
    s_waitcnt lgkmcnt(6)
    v_mfma_f32_16x16x32_bf16 v[80:83], v[8:11], v[152:155], v[80:83]
    ds_read_b64_tr_b16 v[28:29], v2 offset:6368
    buffer_store_dwordx4 v[36:39], v6, s[40:43], s93 offen sc1
    v_cvt_pk_bf16_f32 v65, v66, v67
    v_mfma_f32_16x16x32_bf16 v[84:87], v[8:11], v[156:159], v[84:87]
    ds_read_b64_tr_b16 v[30:31], v2 offset:7136
    v_cvt_pk_bf16_f32 v66, v68, v69
    v_mfma_f32_16x16x32_bf16 v[88:91], v[12:15], v[152:155], v[88:91]
    ds_read_b64_tr_b16 v[8:9], v0 offset:12416
    v_cvt_pk_bf16_f32 v67, v70, v71
    v_cvt_pk_bf16_f32 v72, v72, v73
    v_mfma_f32_16x16x32_bf16 v[92:95], v[12:15], v[156:159], v[92:95]
    ds_read_b64_tr_b16 v[10:11], v0 offset:13184
    v_cvt_pk_bf16_f32 v73, v74, v75
    v_cvt_pk_bf16_f32 v74, v76, v77
    v_mfma_f32_16x16x32_bf16 v[96:99], v[16:19], v[152:155], v[96:99]
    ds_read_b64_tr_b16 v[12:13], v0 offset:12448
    v_cvt_pk_bf16_f32 v75, v78, v79
    v_permlane16_swap_b32 v64, v66
    v_mfma_f32_16x16x32_bf16 v[100:103], v[16:19], v[156:159], v[100:103]
    ds_read_b64_tr_b16 v[14:15], v0 offset:13216
    v_permlane16_swap_b32 v65, v67
    v_permlane16_swap_b32 v72, v74
    s_waitcnt lgkmcnt(4)
    v_mfma_f32_16x16x32_bf16 v[104:107], v[20:23], v[152:155], v[104:107]
    ds_read_b64_tr_b16 v[16:17], v0 offset:12480
    v_permlane16_swap_b32 v73, v75
    v_mfma_f32_16x16x32_bf16 v[108:111], v[20:23], v[156:159], v[108:111]
    ds_read_b64_tr_b16 v[18:19], v0 offset:13248
    v_mfma_f32_16x16x32_bf16 v[112:115], v[24:27], v[152:155], v[112:115]
    ds_read_b64_tr_b16 v[20:21], v0 offset:12512
    ds_read_b64_tr_b16 v[52:53], v5 offset:0
    ds_read_b64_tr_b16 v[54:55], v5 offset:320
    ds_read_b64_tr_b16 v[60:61], v5 offset:1280
    v_mfma_f32_16x16x32_bf16 v[116:119], v[24:27], v[156:159], v[116:119]
    ds_read_b64_tr_b16 v[22:23], v0 offset:13280
    v_mfma_f32_16x16x32_bf16 v[120:123], v[28:31], v[152:155], v[120:123]
    ds_read_b64_tr_b16 v[24:25], v0 offset:12544
    ds_read_b64_tr_b16 v[62:63], v5 offset:1600
    v_mfma_f32_16x16x32_bf16 v[124:127], v[28:31], v[156:159], v[124:127]
    ds_read_b64_tr_b16 v[26:27], v0 offset:13312
    s_waitcnt lgkmcnt(8)
    v_mfma_f32_16x16x32_bf16 v[80:83], v[8:11], v[160:163], v[80:83]
    ds_read_b64_tr_b16 v[28:29], v0 offset:12576
    buffer_store_dwordx4 v[44:47], v6, s[40:43], s93 offen offset:512 sc1
    s_add_u32 s93, s93, 0x20000
    v_mfma_f32_16x16x32_bf16 v[84:87], v[8:11], v[164:167], v[84:87]
    ds_read_b64_tr_b16 v[30:31], v0 offset:13344
    v_mfma_f32_16x16x32_bf16 v[88:91], v[12:15], v[160:163], v[88:91]
    ds_read_b64_tr_b16 v[8:9], v0 offset:18624
    s_waitcnt lgkmcnt(4)
    ds_write_b128 v4, v[64:67]
    ds_write_b128 v4, v[72:75] offset:32
    v_mfma_f32_16x16x32_bf16 v[92:95], v[12:15], v[164:167], v[92:95]
    ds_read_b64_tr_b16 v[10:11], v0 offset:19392
    v_mfma_f32_16x16x32_bf16 v[96:99], v[16:19], v[160:163], v[96:99]
    ds_read_b64_tr_b16 v[12:13], v0 offset:18656
    v_mfma_f32_16x16x32_bf16 v[100:103], v[16:19], v[164:167], v[100:103]
    ds_read_b64_tr_b16 v[14:15], v0 offset:19424
    s_waitcnt lgkmcnt(6)
    v_mfma_f32_16x16x32_bf16 v[104:107], v[20:23], v[160:163], v[104:107]
    ds_read_b64_tr_b16 v[16:17], v0 offset:18688
    v_mfma_f32_16x16x32_bf16 v[108:111], v[20:23], v[164:167], v[108:111]
    ds_read_b64_tr_b16 v[18:19], v0 offset:19456
    v_mfma_f32_16x16x32_bf16 v[112:115], v[24:27], v[160:163], v[112:115]
    ds_read_b64_tr_b16 v[20:21], v0 offset:18720
    s_waitcnt lgkmcnt(6)
    ds_read_b64_tr_b16 v[68:69], v5 offset:0
    ds_read_b64_tr_b16 v[70:71], v5 offset:320
    ds_read_b64_tr_b16 v[76:77], v5 offset:1280
    v_mfma_f32_16x16x32_bf16 v[116:119], v[24:27], v[164:167], v[116:119]
    ds_read_b64_tr_b16 v[22:23], v0 offset:19488
    v_mfma_f32_16x16x32_bf16 v[120:123], v[28:31], v[160:163], v[120:123]
    ds_read_b64_tr_b16 v[24:25], v0 offset:18752
    ds_read_b64_tr_b16 v[78:79], v5 offset:1600
    v_mfma_f32_16x16x32_bf16 v[124:127], v[28:31], v[164:167], v[124:127]
    ds_read_b64_tr_b16 v[26:27], v0 offset:19520
    s_waitcnt lgkmcnt(8)
    v_mfma_f32_16x16x32_bf16 v[80:83], v[8:11], v[168:171], v[80:83]
    ds_read_b64_tr_b16 v[28:29], v0 offset:18784
    buffer_store_dwordx4 v[52:55], v6, s[40:43], s93 offen sc1
    v_mfma_f32_16x16x32_bf16 v[84:87], v[8:11], v[172:175], v[84:87]
    ds_read_b64_tr_b16 v[30:31], v0 offset:19552
    v_mfma_f32_16x16x32_bf16 v[88:91], v[12:15], v[168:171], v[88:91]
    ds_read_b64_tr_b16 v[8:9], v2 offset:24832
    s_waitcnt lgkmcnt(4)
    v_mfma_f32_16x16x32_bf16 v[92:95], v[12:15], v[172:175], v[92:95]
    ds_read_b64_tr_b16 v[10:11], v2 offset:25600
    v_mfma_f32_16x16x32_bf16 v[96:99], v[16:19], v[168:171], v[96:99]
    ds_read_b64_tr_b16 v[12:13], v2 offset:24864
    v_mfma_f32_16x16x32_bf16 v[100:103], v[16:19], v[172:175], v[100:103]
    ds_read_b64_tr_b16 v[14:15], v2 offset:25632
    s_waitcnt lgkmcnt(4)
    v_mfma_f32_16x16x32_bf16 v[104:107], v[20:23], v[168:171], v[104:107]
    ds_read_b64_tr_b16 v[16:17], v2 offset:24896
    v_mfma_f32_16x16x32_bf16 v[108:111], v[20:23], v[172:175], v[108:111]
    ds_read_b64_tr_b16 v[18:19], v2 offset:25664
    v_mfma_f32_16x16x32_bf16 v[112:115], v[24:27], v[168:171], v[112:115]
    ds_read_b64_tr_b16 v[20:21], v2 offset:24928
    v_mfma_f32_16x16x32_bf16 v[116:119], v[24:27], v[172:175], v[116:119]
    ds_read_b64_tr_b16 v[22:23], v2 offset:25696
    v_mfma_f32_16x16x32_bf16 v[120:123], v[28:31], v[168:171], v[120:123]
    ds_read_b64_tr_b16 v[24:25], v2 offset:24960
    v_mfma_f32_16x16x32_bf16 v[124:127], v[28:31], v[172:175], v[124:127]
    ds_read_b64_tr_b16 v[26:27], v2 offset:25728
    s_waitcnt lgkmcnt(4)
    v_mfma_f32_16x16x32_bf16 v[80:83], v[8:11], v[176:179], v[80:83]
    ds_read_b64_tr_b16 v[28:29], v2 offset:24992
    buffer_store_dwordx4 v[60:63], v6, s[40:43], s93 offen offset:512 sc1
    s_add_u32 s93, s93, 0x20000
    v_mfma_f32_16x16x32_bf16 v[84:87], v[8:11], v[180:183], v[84:87]
    ds_read_b64_tr_b16 v[30:31], v2 offset:25760
    v_mfma_f32_16x16x32_bf16 v[88:91], v[12:15], v[176:179], v[88:91]
    ds_read_b64_tr_b16 v[8:9], v2 offset:31040
    v_mfma_f32_16x16x32_bf16 v[92:95], v[12:15], v[180:183], v[92:95]
    ds_read_b64_tr_b16 v[10:11], v2 offset:31808
    v_mfma_f32_16x16x32_bf16 v[96:99], v[16:19], v[176:179], v[96:99]
    ds_read_b64_tr_b16 v[12:13], v2 offset:31072
    v_mfma_f32_16x16x32_bf16 v[100:103], v[16:19], v[180:183], v[100:103]
    ds_read_b64_tr_b16 v[14:15], v2 offset:31840
    s_waitcnt lgkmcnt(4)
    v_mfma_f32_16x16x32_bf16 v[104:107], v[20:23], v[176:179], v[104:107]
    ds_read_b64_tr_b16 v[16:17], v2 offset:31104
    v_mfma_f32_16x16x32_bf16 v[108:111], v[20:23], v[180:183], v[108:111]
    ds_read_b64_tr_b16 v[18:19], v2 offset:31872
    v_mfma_f32_16x16x32_bf16 v[112:115], v[24:27], v[176:179], v[112:115]
    ds_read_b64_tr_b16 v[20:21], v2 offset:31136
    v_mfma_f32_16x16x32_bf16 v[116:119], v[24:27], v[180:183], v[116:119]
    ds_read_b64_tr_b16 v[22:23], v2 offset:31904
    v_mfma_f32_16x16x32_bf16 v[120:123], v[28:31], v[176:179], v[120:123]
    ds_read_b64_tr_b16 v[24:25], v2 offset:31168
    v_mfma_f32_16x16x32_bf16 v[124:127], v[28:31], v[180:183], v[124:127]
    ds_read_b64_tr_b16 v[26:27], v2 offset:31936
    s_waitcnt lgkmcnt(4)
    v_mfma_f32_16x16x32_bf16 v[80:83], v[8:11], v[184:187], v[80:83]
    ds_read_b64_tr_b16 v[28:29], v2 offset:31200
    buffer_store_dwordx4 v[68:71], v6, s[40:43], s93 offen sc1
    v_mfma_f32_16x16x32_bf16 v[84:87], v[8:11], v[188:191], v[84:87]
    ds_read_b64_tr_b16 v[30:31], v2 offset:31968
    v_mfma_f32_16x16x32_bf16 v[88:91], v[12:15], v[184:187], v[88:91]
    ds_read_b64_tr_b16 v[8:9], v0 offset:24832
    v_mfma_f32_16x16x32_bf16 v[92:95], v[12:15], v[188:191], v[92:95]
    ds_read_b64_tr_b16 v[10:11], v0 offset:25600
    v_mfma_f32_16x16x32_bf16 v[96:99], v[16:19], v[184:187], v[96:99]
    ds_read_b64_tr_b16 v[12:13], v0 offset:24864
    v_mfma_f32_16x16x32_bf16 v[100:103], v[16:19], v[188:191], v[100:103]
    ds_read_b64_tr_b16 v[14:15], v0 offset:25632
    s_waitcnt lgkmcnt(4)
    v_mfma_f32_16x16x32_bf16 v[104:107], v[20:23], v[184:187], v[104:107]
    ds_read_b64_tr_b16 v[16:17], v0 offset:24896
    v_mfma_f32_16x16x32_bf16 v[108:111], v[20:23], v[188:191], v[108:111]
    ds_read_b64_tr_b16 v[18:19], v0 offset:25664
    v_mfma_f32_16x16x32_bf16 v[112:115], v[24:27], v[184:187], v[112:115]
    ds_read_b64_tr_b16 v[20:21], v0 offset:24928
    v_mfma_f32_16x16x32_bf16 v[116:119], v[24:27], v[188:191], v[116:119]
    ds_read_b64_tr_b16 v[22:23], v0 offset:25696
    v_mfma_f32_16x16x32_bf16 v[120:123], v[28:31], v[184:187], v[120:123]
    ds_read_b64_tr_b16 v[24:25], v0 offset:24960
    v_mfma_f32_16x16x32_bf16 v[124:127], v[28:31], v[188:191], v[124:127]
    ds_read_b64_tr_b16 v[26:27], v0 offset:25728
    s_waitcnt lgkmcnt(4)
    v_mfma_f32_16x16x32_bf16 v[80:83], v[8:11], v[192:195], v[80:83]
    ds_read_b64_tr_b16 v[28:29], v0 offset:24992
    buffer_store_dwordx4 v[76:79], v6, s[40:43], s93 offen offset:512 sc1
    s_add_u32 s93, s93, 0x20000
    v_mfma_f32_16x16x32_bf16 v[84:87], v[8:11], v[196:199], v[84:87]
    ds_read_b64_tr_b16 v[30:31], v0 offset:25760
    v_mfma_f32_16x16x32_bf16 v[88:91], v[12:15], v[192:195], v[88:91]
    ds_read_b64_tr_b16 v[8:9], v0 offset:31040
    v_mfma_f32_16x16x32_bf16 v[92:95], v[12:15], v[196:199], v[92:95]
    ds_read_b64_tr_b16 v[10:11], v0 offset:31808
    v_mfma_f32_16x16x32_bf16 v[96:99], v[16:19], v[192:195], v[96:99]
    ds_read_b64_tr_b16 v[12:13], v0 offset:31072
    v_mfma_f32_16x16x32_bf16 v[100:103], v[16:19], v[196:199], v[100:103]
    ds_read_b64_tr_b16 v[14:15], v0 offset:31840
    s_waitcnt lgkmcnt(4)
    v_mfma_f32_16x16x32_bf16 v[104:107], v[20:23], v[192:195], v[104:107]
    ds_read_b64_tr_b16 v[16:17], v0 offset:31104
    v_mfma_f32_16x16x32_bf16 v[108:111], v[20:23], v[196:199], v[108:111]
    ds_read_b64_tr_b16 v[18:19], v0 offset:31872
    v_mfma_f32_16x16x32_bf16 v[112:115], v[24:27], v[192:195], v[112:115]
    ds_read_b64_tr_b16 v[20:21], v0 offset:31136
    v_mfma_f32_16x16x32_bf16 v[116:119], v[24:27], v[196:199], v[116:119]
    ds_read_b64_tr_b16 v[22:23], v0 offset:31904
    v_mfma_f32_16x16x32_bf16 v[120:123], v[28:31], v[192:195], v[120:123]
    ds_read_b64_tr_b16 v[24:25], v0 offset:31168
    v_mfma_f32_16x16x32_bf16 v[124:127], v[28:31], v[196:199], v[124:127]
    ds_read_b64_tr_b16 v[26:27], v0 offset:31936
    s_waitcnt lgkmcnt(4)
    v_mfma_f32_16x16x32_bf16 v[80:83], v[8:11], v[200:203], v[80:83]
    ds_read_b64_tr_b16 v[28:29], v0 offset:31200
    v_mfma_f32_16x16x32_bf16 v[84:87], v[8:11], v[204:207], v[84:87]
    ds_read_b64_tr_b16 v[30:31], v0 offset:31968
    v_mfma_f32_16x16x32_bf16 v[88:91], v[12:15], v[200:203], v[88:91]
    s_barrier
    ds_read_b64_tr_b16 v[8:9], v0 offset:37248
    v_mfma_f32_16x16x32_bf16 v[92:95], v[12:15], v[204:207], v[92:95]
    ds_read_b64_tr_b16 v[10:11], v0 offset:38016
    v_mfma_f32_16x16x32_bf16 v[96:99], v[16:19], v[200:203], v[96:99]
    ds_read_b64_tr_b16 v[12:13], v0 offset:37280
    v_mfma_f32_16x16x32_bf16 v[100:103], v[16:19], v[204:207], v[100:103]
    ds_read_b64_tr_b16 v[14:15], v0 offset:38048
    s_waitcnt lgkmcnt(4)
    v_mfma_f32_16x16x32_bf16 v[104:107], v[20:23], v[200:203], v[104:107]
    ds_read_b64_tr_b16 v[16:17], v0 offset:37312
    v_mfma_f32_16x16x32_bf16 v[108:111], v[20:23], v[204:207], v[108:111]
    ds_read_b64_tr_b16 v[18:19], v0 offset:38080
    v_mfma_f32_16x16x32_bf16 v[112:115], v[24:27], v[200:203], v[112:115]
    ds_read_b64_tr_b16 v[20:21], v0 offset:37344
    v_mfma_f32_16x16x32_bf16 v[116:119], v[24:27], v[204:207], v[116:119]
    ds_read_b64_tr_b16 v[22:23], v0 offset:38112
    v_mfma_f32_16x16x32_bf16 v[120:123], v[28:31], v[200:203], v[120:123]
    ds_read_b64_tr_b16 v[24:25], v0 offset:37376
    v_mfma_f32_16x16x32_bf16 v[124:127], v[28:31], v[204:207], v[124:127]
    ds_read_b64_tr_b16 v[26:27], v0 offset:38144
    s_waitcnt lgkmcnt(4)
    v_mfma_f32_16x16x32_bf16 v[80:83], v[8:11], v[208:211], v[80:83]
    ds_read_b64_tr_b16 v[28:29], v0 offset:37408
    v_mfma_f32_16x16x32_bf16 v[84:87], v[8:11], v[212:215], v[84:87]
    ds_read_b64_tr_b16 v[30:31], v0 offset:38176
    v_mfma_f32_16x16x32_bf16 v[88:91], v[12:15], v[208:211], v[88:91]
    ds_read_b64_tr_b16 v[8:9], v0 offset:43456
    v_mfma_f32_16x16x32_bf16 v[92:95], v[12:15], v[212:215], v[92:95]
    ds_read_b64_tr_b16 v[10:11], v0 offset:44224
    v_mfma_f32_16x16x32_bf16 v[96:99], v[16:19], v[208:211], v[96:99]
    ds_read_b64_tr_b16 v[12:13], v0 offset:43488
    v_mfma_f32_16x16x32_bf16 v[100:103], v[16:19], v[212:215], v[100:103]
    ds_read_b64_tr_b16 v[14:15], v0 offset:44256
    s_waitcnt lgkmcnt(4)
    v_mfma_f32_16x16x32_bf16 v[104:107], v[20:23], v[208:211], v[104:107]
    ds_read_b64_tr_b16 v[16:17], v0 offset:43520
    v_mfma_f32_16x16x32_bf16 v[108:111], v[20:23], v[212:215], v[108:111]
    ds_read_b64_tr_b16 v[18:19], v0 offset:44288
    v_mfma_f32_16x16x32_bf16 v[112:115], v[24:27], v[208:211], v[112:115]
    ds_read_b64_tr_b16 v[20:21], v0 offset:43552
    v_mfma_f32_16x16x32_bf16 v[116:119], v[24:27], v[212:215], v[116:119]
    ds_read_b64_tr_b16 v[22:23], v0 offset:44320
    v_mfma_f32_16x16x32_bf16 v[120:123], v[28:31], v[208:211], v[120:123]
    ds_read_b64_tr_b16 v[24:25], v0 offset:43584
    v_mfma_f32_16x16x32_bf16 v[124:127], v[28:31], v[212:215], v[124:127]
    ds_read_b64_tr_b16 v[26:27], v0 offset:44352
    s_waitcnt lgkmcnt(4)
    v_mfma_f32_16x16x32_bf16 v[80:83], v[8:11], v[216:219], v[80:83]
    ds_read_b64_tr_b16 v[28:29], v0 offset:43616
    v_mfma_f32_16x16x32_bf16 v[84:87], v[8:11], v[220:223], v[84:87]
    ds_read_b64_tr_b16 v[30:31], v0 offset:44384
    v_mfma_f32_16x16x32_bf16 v[88:91], v[12:15], v[216:219], v[88:91]
    ds_read_b64_tr_b16 v[8:9], v1 offset:0
    v_mfma_f32_16x16x32_bf16 v[92:95], v[12:15], v[220:223], v[92:95]
    ds_read_b64_tr_b16 v[10:11], v1 offset:768
    v_mfma_f32_16x16x32_bf16 v[96:99], v[16:19], v[216:219], v[96:99]
    ds_read_b64_tr_b16 v[12:13], v1 offset:32
    v_mfma_f32_16x16x32_bf16 v[100:103], v[16:19], v[220:223], v[100:103]
    ds_read_b64_tr_b16 v[14:15], v1 offset:800
    s_waitcnt lgkmcnt(4)
    v_mfma_f32_16x16x32_bf16 v[104:107], v[20:23], v[216:219], v[104:107]
    ds_read_b64_tr_b16 v[16:17], v1 offset:64
    v_mfma_f32_16x16x32_bf16 v[108:111], v[20:23], v[220:223], v[108:111]
    ds_read_b64_tr_b16 v[18:19], v1 offset:832
    v_mfma_f32_16x16x32_bf16 v[112:115], v[24:27], v[216:219], v[112:115]
    ds_read_b64_tr_b16 v[20:21], v1 offset:96
    v_mfma_f32_16x16x32_bf16 v[116:119], v[24:27], v[220:223], v[116:119]
    ds_read_b64_tr_b16 v[22:23], v1 offset:864
    v_mfma_f32_16x16x32_bf16 v[120:123], v[28:31], v[216:219], v[120:123]
    ds_read_b64_tr_b16 v[24:25], v1 offset:128
    v_mfma_f32_16x16x32_bf16 v[124:127], v[28:31], v[220:223], v[124:127]
    ds_read_b64_tr_b16 v[26:27], v1 offset:896
    s_waitcnt lgkmcnt(4)
    v_mfma_f32_16x16x32_bf16 v[80:83], v[8:11], v[224:227], v[80:83]
    ds_read_b64_tr_b16 v[28:29], v1 offset:160
    v_mfma_f32_16x16x32_bf16 v[84:87], v[8:11], v[228:231], v[84:87]
    ds_read_b64_tr_b16 v[30:31], v1 offset:928
    v_mfma_f32_16x16x32_bf16 v[88:91], v[12:15], v[224:227], v[88:91]
    ds_read_b64_tr_b16 v[8:9], v1 offset:6208
    v_mfma_f32_16x16x32_bf16 v[92:95], v[12:15], v[228:231], v[92:95]
    ds_read_b64_tr_b16 v[10:11], v1 offset:6976
    v_mfma_f32_16x16x32_bf16 v[96:99], v[16:19], v[224:227], v[96:99]
    ds_read_b64_tr_b16 v[12:13], v1 offset:6240
    v_mfma_f32_16x16x32_bf16 v[100:103], v[16:19], v[228:231], v[100:103]
    ds_read_b64_tr_b16 v[14:15], v1 offset:7008
    s_waitcnt lgkmcnt(4)
    v_mfma_f32_16x16x32_bf16 v[104:107], v[20:23], v[224:227], v[104:107]
    ds_read_b64_tr_b16 v[16:17], v1 offset:6272
    v_mfma_f32_16x16x32_bf16 v[108:111], v[20:23], v[228:231], v[108:111]
    ds_read_b64_tr_b16 v[18:19], v1 offset:7040
    v_mfma_f32_16x16x32_bf16 v[112:115], v[24:27], v[224:227], v[112:115]
    ds_read_b64_tr_b16 v[20:21], v1 offset:6304
    v_mfma_f32_16x16x32_bf16 v[116:119], v[24:27], v[228:231], v[116:119]
    ds_read_b64_tr_b16 v[22:23], v1 offset:7072
    v_mfma_f32_16x16x32_bf16 v[120:123], v[28:31], v[224:227], v[120:123]
    ds_read_b64_tr_b16 v[24:25], v1 offset:6336
    v_mfma_f32_16x16x32_bf16 v[124:127], v[28:31], v[228:231], v[124:127]
    ds_read_b64_tr_b16 v[26:27], v1 offset:7104
    s_waitcnt lgkmcnt(4)
    v_mfma_f32_16x16x32_bf16 v[80:83], v[8:11], v[232:235], v[80:83]
    ds_read_b64_tr_b16 v[28:29], v1 offset:6368
    v_mfma_f32_16x16x32_bf16 v[84:87], v[8:11], v[236:239], v[84:87]
    ds_read_b64_tr_b16 v[30:31], v1 offset:7136
    v_mfma_f32_16x16x32_bf16 v[88:91], v[12:15], v[232:235], v[88:91]
    ds_read_b64_tr_b16 v[8:9], v1 offset:12416
    v_mfma_f32_16x16x32_bf16 v[92:95], v[12:15], v[236:239], v[92:95]
    ds_read_b64_tr_b16 v[10:11], v1 offset:13184
    v_mfma_f32_16x16x32_bf16 v[96:99], v[16:19], v[232:235], v[96:99]
    ds_read_b64_tr_b16 v[12:13], v1 offset:12448
    v_mfma_f32_16x16x32_bf16 v[100:103], v[16:19], v[236:239], v[100:103]
    ds_read_b64_tr_b16 v[14:15], v1 offset:13216
    s_waitcnt lgkmcnt(4)
    v_mfma_f32_16x16x32_bf16 v[104:107], v[20:23], v[232:235], v[104:107]
    ds_read_b64_tr_b16 v[16:17], v1 offset:12480
    v_mfma_f32_16x16x32_bf16 v[108:111], v[20:23], v[236:239], v[108:111]
    ds_read_b64_tr_b16 v[18:19], v1 offset:13248
    v_mfma_f32_16x16x32_bf16 v[112:115], v[24:27], v[232:235], v[112:115]
    ds_read_b64_tr_b16 v[20:21], v1 offset:12512
    v_mfma_f32_16x16x32_bf16 v[116:119], v[24:27], v[236:239], v[116:119]
    ds_read_b64_tr_b16 v[22:23], v1 offset:13280
    v_mfma_f32_16x16x32_bf16 v[120:123], v[28:31], v[232:235], v[120:123]
    ds_read_b64_tr_b16 v[24:25], v1 offset:12544
    v_mfma_f32_16x16x32_bf16 v[124:127], v[28:31], v[236:239], v[124:127]
    ds_read_b64_tr_b16 v[26:27], v1 offset:13312
    s_waitcnt lgkmcnt(4)
    v_mfma_f32_16x16x32_bf16 v[80:83], v[8:11], v[240:243], v[80:83]
    ds_read_b64_tr_b16 v[28:29], v1 offset:12576
    v_mfma_f32_16x16x32_bf16 v[84:87], v[8:11], v[244:247], v[84:87]
    ds_read_b64_tr_b16 v[30:31], v1 offset:13344
    s_waitcnt vmcnt(0)
    v_mov_b32 v3, 0
    v_mov_b32 v4, 1
    s_mov_b64 exec, 1
    buffer_store_dword v4, v3, s[40:43], s95 offen sc1
    s_mov_b64 exec, -1
    v_mfma_f32_16x16x32_bf16 v[88:91], v[12:15], v[240:243], v[88:91]
    ds_read_b64_tr_b16 v[8:9], v1 offset:18624
    v_mfma_f32_16x16x32_bf16 v[92:95], v[12:15], v[244:247], v[92:95]
    ds_read_b64_tr_b16 v[10:11], v1 offset:19392
    v_mfma_f32_16x16x32_bf16 v[96:99], v[16:19], v[240:243], v[96:99]
    ds_read_b64_tr_b16 v[12:13], v1 offset:18656
    v_mfma_f32_16x16x32_bf16 v[100:103], v[16:19], v[244:247], v[100:103]
    ds_read_b64_tr_b16 v[14:15], v1 offset:19424
    s_waitcnt lgkmcnt(4)
    v_mfma_f32_16x16x32_bf16 v[104:107], v[20:23], v[240:243], v[104:107]
    ds_read_b64_tr_b16 v[16:17], v1 offset:18688
    v_mfma_f32_16x16x32_bf16 v[108:111], v[20:23], v[244:247], v[108:111]
    ds_read_b64_tr_b16 v[18:19], v1 offset:19456
    v_mfma_f32_16x16x32_bf16 v[112:115], v[24:27], v[240:243], v[112:115]
    ds_read_b64_tr_b16 v[20:21], v1 offset:18720
    v_mfma_f32_16x16x32_bf16 v[116:119], v[24:27], v[244:247], v[116:119]
    ds_read_b64_tr_b16 v[22:23], v1 offset:19488
    v_mfma_f32_16x16x32_bf16 v[120:123], v[28:31], v[240:243], v[120:123]
    ds_read_b64_tr_b16 v[24:25], v1 offset:18752
    v_mfma_f32_16x16x32_bf16 v[124:127], v[28:31], v[244:247], v[124:127]
    ds_read_b64_tr_b16 v[26:27], v1 offset:19520
    s_waitcnt lgkmcnt(4)
    v_mfma_f32_16x16x32_bf16 v[80:83], v[8:11], v[248:251], v[80:83]
    ds_read_b64_tr_b16 v[28:29], v1 offset:18784
    v_mfma_f32_16x16x32_bf16 v[84:87], v[8:11], v[252:255], v[84:87]
    ds_read_b64_tr_b16 v[30:31], v1 offset:19552
    v_mfma_f32_16x16x32_bf16 v[88:91], v[12:15], v[248:251], v[88:91]
    ds_read_b64_tr_b16 v[8:9], v2 offset:12416
    v_mfma_f32_16x16x32_bf16 v[92:95], v[12:15], v[252:255], v[92:95]
    ds_read_b64_tr_b16 v[10:11], v2 offset:13184
    v_mfma_f32_16x16x32_bf16 v[96:99], v[16:19], v[248:251], v[96:99]
    ds_read_b64_tr_b16 v[12:13], v2 offset:12448
    v_mfma_f32_16x16x32_bf16 v[100:103], v[16:19], v[252:255], v[100:103]
    ds_read_b64_tr_b16 v[14:15], v2 offset:13216
    s_waitcnt lgkmcnt(4)
    v_mfma_f32_16x16x32_bf16 v[104:107], v[20:23], v[248:251], v[104:107]
    ds_read_b64_tr_b16 v[16:17], v2 offset:12480
    v_mfma_f32_16x16x32_bf16 v[108:111], v[20:23], v[252:255], v[108:111]
    ds_read_b64_tr_b16 v[18:19], v2 offset:13248
    v_mfma_f32_16x16x32_bf16 v[112:115], v[24:27], v[248:251], v[112:115]
    ds_read_b64_tr_b16 v[20:21], v2 offset:12512
    v_mfma_f32_16x16x32_bf16 v[116:119], v[24:27], v[252:255], v[116:119]
    ds_read_b64_tr_b16 v[22:23], v2 offset:13280
    v_mfma_f32_16x16x32_bf16 v[120:123], v[28:31], v[248:251], v[120:123]
    ds_read_b64_tr_b16 v[24:25], v2 offset:12544
    v_mfma_f32_16x16x32_bf16 v[124:127], v[28:31], v[252:255], v[124:127]
    ds_read_b64_tr_b16 v[26:27], v2 offset:13312
    s_nop 0
PK_part2:
    s_waitcnt lgkmcnt(4)
    v_mfma_f32_16x16x32_bf16 v[32:35], v[8:11], v[128:131], 0
    ds_read_b64_tr_b16 v[28:29], v2 offset:12576
    v_mfma_f32_16x16x32_bf16 v[36:39], v[8:11], v[132:135], 0
    ds_read_b64_tr_b16 v[30:31], v2 offset:13344
    v_mfma_f32_16x16x32_bf16 v[40:43], v[12:15], v[128:131], 0
    ds_read_b64_tr_b16 v[8:9], v2 offset:18624
    v_mfma_f32_16x16x32_bf16 v[44:47], v[12:15], v[132:135], 0
    ds_read_b64_tr_b16 v[10:11], v2 offset:19392
    v_mfma_f32_16x16x32_bf16 v[48:51], v[16:19], v[128:131], 0
    ds_read_b64_tr_b16 v[12:13], v2 offset:18656
    v_mul_f32 v7, s61, v80
    v_mul_f32 v6, s61, v81
    v_mfma_f32_16x16x32_bf16 v[52:55], v[16:19], v[132:135], 0
    ds_read_b64_tr_b16 v[14:15], v2 offset:19424
    v_exp_f32 v7, v7
    s_waitcnt lgkmcnt(4)
    v_mfma_f32_16x16x32_bf16 v[56:59], v[20:23], v[128:131], 0
    ds_read_b64_tr_b16 v[16:17], v2 offset:18688
    v_exp_f32 v6, v6
    v_add_f32 v7, 1.0, v7
    v_mfma_f32_16x16x32_bf16 v[60:63], v[20:23], v[132:135], 0
    ds_read_b64_tr_b16 v[18:19], v2 offset:19456
    v_add_f32 v6, 1.0, v6
    v_mfma_f32_16x16x32_bf16 v[64:67], v[24:27], v[128:131], 0
    ds_read_b64_tr_b16 v[20:21], v2 offset:18720
    v_rcp_f32 v7, v7
    v_mfma_f32_16x16x32_bf16 v[68:71], v[24:27], v[132:135], 0
    ds_read_b64_tr_b16 v[22:23], v2 offset:19488
    v_rcp_f32 v6, v6
    v_mfma_f32_16x16x32_bf16 v[72:75], v[28:31], v[128:131], 0
    ds_read_b64_tr_b16 v[24:25], v2 offset:18752
    v_mul_f32 v80, v80, v7
    v_mul_f32 v81, v81, v6
    v_mfma_f32_16x16x32_bf16 v[76:79], v[28:31], v[132:135], 0
    ds_read_b64_tr_b16 v[26:27], v2 offset:19520
    v_mul_f32 v7, s61, v82
    v_mul_f32 v6, s61, v83
    s_waitcnt lgkmcnt(4)
    v_mfma_f32_16x16x32_bf16 v[32:35], v[8:11], v[136:139], v[32:35]
    ds_read_b64_tr_b16 v[28:29], v2 offset:18784
    v_exp_f32 v7, v7
    v_mfma_f32_16x16x32_bf16 v[36:39], v[8:11], v[140:143], v[36:39]
    ds_read_b64_tr_b16 v[30:31], v2 offset:19552
    v_exp_f32 v6, v6
    v_mfma_f32_16x16x32_bf16 v[40:43], v[12:15], v[136:139], v[40:43]
    s_barrier
    ds_read_b64_tr_b16 v[8:9], v2 offset:37248
    v_add_f32 v7, 1.0, v7
    v_add_f32 v6, 1.0, v6
    v_mfma_f32_16x16x32_bf16 v[44:47], v[12:15], v[140:143], v[44:47]
    ds_read_b64_tr_b16 v[10:11], v2 offset:38016
    v_rcp_f32 v7, v7
    v_mfma_f32_16x16x32_bf16 v[48:51], v[16:19], v[136:139], v[48:51]
    ds_read_b64_tr_b16 v[12:13], v2 offset:37280
    v_rcp_f32 v6, v6
    v_mul_f32 v82, v82, v7
    v_mfma_f32_16x16x32_bf16 v[52:55], v[16:19], v[140:143], v[52:55]
    ds_read_b64_tr_b16 v[14:15], v2 offset:38048
    v_mul_f32 v83, v83, v6
    s_waitcnt lgkmcnt(4)
    v_mfma_f32_16x16x32_bf16 v[56:59], v[20:23], v[136:139], v[56:59]
    ds_read_b64_tr_b16 v[16:17], v2 offset:37312
    v_mul_f32 v7, s61, v84
    v_mul_f32 v6, s61, v85
    v_mfma_f32_16x16x32_bf16 v[60:63], v[20:23], v[140:143], v[60:63]
    ds_read_b64_tr_b16 v[18:19], v2 offset:38080
    v_exp_f32 v7, v7
    v_mfma_f32_16x16x32_bf16 v[64:67], v[24:27], v[136:139], v[64:67]
    ds_read_b64_tr_b16 v[20:21], v2 offset:37344
    v_exp_f32 v6, v6
    v_add_f32 v7, 1.0, v7
    v_mfma_f32_16x16x32_bf16 v[68:71], v[24:27], v[140:143], v[68:71]
    ds_read_b64_tr_b16 v[22:23], v2 offset:38112
    v_add_f32 v6, 1.0, v6
    v_mfma_f32_16x16x32_bf16 v[72:75], v[28:31], v[136:139], v[72:75]
    ds_read_b64_tr_b16 v[24:25], v2 offset:37376
    v_rcp_f32 v7, v7
    v_mfma_f32_16x16x32_bf16 v[76:79], v[28:31], v[140:143], v[76:79]
    ds_read_b64_tr_b16 v[26:27], v2 offset:38144
    v_rcp_f32 v6, v6
    s_waitcnt lgkmcnt(4)
    v_mfma_f32_16x16x32_bf16 v[32:35], v[8:11], v[144:147], v[32:35]
    ds_read_b64_tr_b16 v[28:29], v2 offset:37408
    v_mul_f32 v84, v84, v7
    v_mul_f32 v85, v85, v6
    v_mfma_f32_16x16x32_bf16 v[36:39], v[8:11], v[148:151], v[36:39]
    ds_read_b64_tr_b16 v[30:31], v2 offset:38176
    v_mul_f32 v7, s61, v86
    v_mul_f32 v6, s61, v87
    v_mfma_f32_16x16x32_bf16 v[40:43], v[12:15], v[144:147], v[40:43]
    ds_read_b64_tr_b16 v[8:9], v2 offset:43456
    v_exp_f32 v7, v7
    v_mfma_f32_16x16x32_bf16 v[44:47], v[12:15], v[148:151], v[44:47]
    ds_read_b64_tr_b16 v[10:11], v2 offset:44224
    v_exp_f32 v6, v6
    v_mfma_f32_16x16x32_bf16 v[48:51], v[16:19], v[144:147], v[48:51]
    ds_read_b64_tr_b16 v[12:13], v2 offset:43488
    v_add_f32 v7, 1.0, v7
    v_add_f32 v6, 1.0, v6
    v_mfma_f32_16x16x32_bf16 v[52:55], v[16:19], v[148:151], v[52:55]
    ds_read_b64_tr_b16 v[14:15], v2 offset:44256
    v_rcp_f32 v7, v7
    s_waitcnt lgkmcnt(4)
    v_mfma_f32_16x16x32_bf16 v[56:59], v[20:23], v[144:147], v[56:59]
    ds_read_b64_tr_b16 v[16:17], v2 offset:43520
    v_rcp_f32 v6, v6
    v_mul_f32 v86, v86, v7
    v_mfma_f32_16x16x32_bf16 v[60:63], v[20:23], v[148:151], v[60:63]
    ds_read_b64_tr_b16 v[18:19], v2 offset:44288
    v_mul_f32 v87, v87, v6
    v_mfma_f32_16x16x32_bf16 v[64:67], v[24:27], v[144:147], v[64:67]
    ds_read_b64_tr_b16 v[20:21], v2 offset:43552
    v_mul_f32 v7, s61, v88
    v_mul_f32 v6, s61, v89
    v_mfma_f32_16x16x32_bf16 v[68:71], v[24:27], v[148:151], v[68:71]
    ds_read_b64_tr_b16 v[22:23], v2 offset:44320
    v_exp_f32 v7, v7
    v_mfma_f32_16x16x32_bf16 v[72:75], v[28:31], v[144:147], v[72:75]
    ds_read_b64_tr_b16 v[24:25], v2 offset:43584
    v_exp_f32 v6, v6
    v_add_f32 v7, 1.0, v7
    v_mfma_f32_16x16x32_bf16 v[76:79], v[28:31], v[148:151], v[76:79]
    ds_read_b64_tr_b16 v[26:27], v2 offset:44352
    v_add_f32 v6, 1.0, v6
    s_waitcnt lgkmcnt(4)
    v_mfma_f32_16x16x32_bf16 v[32:35], v[8:11], v[152:155], v[32:35]
    ds_read_b64_tr_b16 v[28:29], v2 offset:43616
    v_rcp_f32 v7, v7
    v_mfma_f32_16x16x32_bf16 v[36:39], v[8:11], v[156:159], v[36:39]
    ds_read_b64_tr_b16 v[30:31], v2 offset:44384
    v_rcp_f32 v6, v6
    v_mfma_f32_16x16x32_bf16 v[40:43], v[12:15], v[152:155], v[40:43]
    ds_read_b64_tr_b16 v[8:9], v1 offset:24832
    v_mul_f32 v88, v88, v7
    v_mul_f32 v89, v89, v6
    v_mfma_f32_16x16x32_bf16 v[44:47], v[12:15], v[156:159], v[44:47]
    ds_read_b64_tr_b16 v[10:11], v1 offset:25600
    v_mul_f32 v7, s61, v90
    v_mul_f32 v6, s61, v91
    v_mfma_f32_16x16x32_bf16 v[48:51], v[16:19], v[152:155], v[48:51]
    ds_read_b64_tr_b16 v[12:13], v1 offset:24864
    v_exp_f32 v7, v7
    v_mfma_f32_16x16x32_bf16 v[52:55], v[16:19], v[156:159], v[52:55]
    ds_read_b64_tr_b16 v[14:15], v1 offset:25632
    v_exp_f32 v6, v6
    s_waitcnt lgkmcnt(4)
    v_mfma_f32_16x16x32_bf16 v[56:59], v[20:23], v[152:155], v[56:59]
    ds_read_b64_tr_b16 v[16:17], v1 offset:24896
    v_add_f32 v7, 1.0, v7
    v_add_f32 v6, 1.0, v6
    v_mfma_f32_16x16x32_bf16 v[60:63], v[20:23], v[156:159], v[60:63]
    ds_read_b64_tr_b16 v[18:19], v1 offset:25664
    v_rcp_f32 v7, v7
    v_mfma_f32_16x16x32_bf16 v[64:67], v[24:27], v[152:155], v[64:67]
    ds_read_b64_tr_b16 v[20:21], v1 offset:24928
    v_rcp_f32 v6, v6
    v_mul_f32 v90, v90, v7
    v_mfma_f32_16x16x32_bf16 v[68:71], v[24:27], v[156:159], v[68:71]
    ds_read_b64_tr_b16 v[22:23], v1 offset:25696
    v_mul_f32 v91, v91, v6
    v_mfma_f32_16x16x32_bf16 v[72:75], v[28:31], v[152:155], v[72:75]
    ds_read_b64_tr_b16 v[24:25], v1 offset:24960
    v_mul_f32 v7, s61, v92
    v_mul_f32 v6, s61, v93
    v_mfma_f32_16x16x32_bf16 v[76:79], v[28:31], v[156:159], v[76:79]
    ds_read_b64_tr_b16 v[26:27], v1 offset:25728
    v_exp_f32 v7, v7
    s_waitcnt lgkmcnt(4)
    v_mfma_f32_16x16x32_bf16 v[32:35], v[8:11], v[160:163], v[32:35]
    ds_read_b64_tr_b16 v[28:29], v1 offset:24992
    v_exp_f32 v6, v6
    v_add_f32 v7, 1.0, v7
    v_mfma_f32_16x16x32_bf16 v[36:39], v[8:11], v[164:167], v[36:39]
    ds_read_b64_tr_b16 v[30:31], v1 offset:25760
    v_add_f32 v6, 1.0, v6
    v_mfma_f32_16x16x32_bf16 v[40:43], v[12:15], v[160:163], v[40:43]
    ds_read_b64_tr_b16 v[8:9], v1 offset:31040
    v_rcp_f32 v7, v7
    v_mfma_f32_16x16x32_bf16 v[44:47], v[12:15], v[164:167], v[44:47]
    ds_read_b64_tr_b16 v[10:11], v1 offset:31808
    v_rcp_f32 v6, v6
    v_mfma_f32_16x16x32_bf16 v[48:51], v[16:19], v[160:163], v[48:51]
    ds_read_b64_tr_b16 v[12:13], v1 offset:31072
    v_mul_f32 v92, v92, v7
    v_mul_f32 v93, v93, v6
    v_mfma_f32_16x16x32_bf16 v[52:55], v[16:19], v[164:167], v[52:55]
    ds_read_b64_tr_b16 v[14:15], v1 offset:31840
    v_mul_f32 v7, s61, v94
    v_mul_f32 v6, s61, v95
    s_waitcnt lgkmcnt(4)
    v_mfma_f32_16x16x32_bf16 v[56:59], v[20:23], v[160:163], v[56:59]
    ds_read_b64_tr_b16 v[16:17], v1 offset:31104
    v_exp_f32 v7, v7
    v_mfma_f32_16x16x32_bf16 v[60:63], v[20:23], v[164:167], v[60:63]
    ds_read_b64_tr_b16 v[18:19], v1 offset:31872
    v_exp_f32 v6, v6
    v_mfma_f32_16x16x32_bf16 v[64:67], v[24:27], v[160:163], v[64:67]
    ds_read_b64_tr_b16 v[20:21], v1 offset:31136
    v_add_f32 v7, 1.0, v7
    v_add_f32 v6, 1.0, v6
    v_mfma_f32_16x16x32_bf16 v[68:71], v[24:27], v[164:167], v[68:71]
    ds_read_b64_tr_b16 v[22:23], v1 offset:31904
    v_rcp_f32 v7, v7
    v_mfma_f32_16x16x32_bf16 v[72:75], v[28:31], v[160:163], v[72:75]
    ds_read_b64_tr_b16 v[24:25], v1 offset:31168
    v_rcp_f32 v6, v6
    v_mul_f32 v94, v94, v7
    v_mfma_f32_16x16x32_bf16 v[76:79], v[28:31], v[164:167], v[76:79]
    ds_read_b64_tr_b16 v[26:27], v1 offset:31936
    v_mul_f32 v95, v95, v6
    s_waitcnt lgkmcnt(4)
    v_mfma_f32_16x16x32_bf16 v[32:35], v[8:11], v[168:171], v[32:35]
    ds_read_b64_tr_b16 v[28:29], v1 offset:31200
    v_mul_f32 v7, s61, v96
    v_mul_f32 v6, s61, v97
    v_mfma_f32_16x16x32_bf16 v[36:39], v[8:11], v[172:175], v[36:39]
    ds_read_b64_tr_b16 v[30:31], v1 offset:31968
    v_exp_f32 v7, v7
    v_mfma_f32_16x16x32_bf16 v[40:43], v[12:15], v[168:171], v[40:43]
    ds_read_b64_tr_b16 v[8:9], v0 offset:0
    v_exp_f32 v6, v6
    v_add_f32 v7, 1.0, v7
    v_mfma_f32_16x16x32_bf16 v[44:47], v[12:15], v[172:175], v[44:47]
    ds_read_b64_tr_b16 v[10:11], v0 offset:768
    v_add_f32 v6, 1.0, v6
    v_mfma_f32_16x16x32_bf16 v[48:51], v[16:19], v[168:171], v[48:51]
    ds_read_b64_tr_b16 v[12:13], v0 offset:32
    v_rcp_f32 v7, v7
    v_mfma_f32_16x16x32_bf16 v[52:55], v[16:19], v[172:175], v[52:55]
    ds_read_b64_tr_b16 v[14:15], v0 offset:800
    v_rcp_f32 v6, v6
    s_waitcnt lgkmcnt(4)
    v_mfma_f32_16x16x32_bf16 v[56:59], v[20:23], v[168:171], v[56:59]
    ds_read_b64_tr_b16 v[16:17], v0 offset:64
    v_mul_f32 v96, v96, v7
    v_mul_f32 v97, v97, v6
    v_mfma_f32_16x16x32_bf16 v[60:63], v[20:23], v[172:175], v[60:63]
    ds_read_b64_tr_b16 v[18:19], v0 offset:832
    v_mul_f32 v7, s61, v98
    v_mul_f32 v6, s61, v99
    v_mfma_f32_16x16x32_bf16 v[64:67], v[24:27], v[168:171], v[64:67]
    ds_read_b64_tr_b16 v[20:21], v0 offset:96
    v_exp_f32 v7, v7
    v_mfma_f32_16x16x32_bf16 v[68:71], v[24:27], v[172:175], v[68:71]
    ds_read_b64_tr_b16 v[22:23], v0 offset:864
    v_exp_f32 v6, v6
    v_mfma_f32_16x16x32_bf16 v[72:75], v[28:31], v[168:171], v[72:75]
    ds_read_b64_tr_b16 v[24:25], v0 offset:128
    v_add_f32 v7, 1.0, v7
    v_add_f32 v6, 1.0, v6
    v_mfma_f32_16x16x32_bf16 v[76:79], v[28:31], v[172:175], v[76:79]
    ds_read_b64_tr_b16 v[26:27], v0 offset:896
    v_rcp_f32 v7, v7
    s_waitcnt lgkmcnt(4)
    v_mfma_f32_16x16x32_bf16 v[32:35], v[8:11], v[176:179], v[32:35]
    ds_read_b64_tr_b16 v[28:29], v0 offset:160
    v_rcp_f32 v6, v6
    v_mul_f32 v98, v98, v7
    v_mfma_f32_16x16x32_bf16 v[36:39], v[8:11], v[180:183], v[36:39]
    ds_read_b64_tr_b16 v[30:31], v0 offset:928
    v_mul_f32 v99, v99, v6
    v_mfma_f32_16x16x32_bf16 v[40:43], v[12:15], v[176:179], v[40:43]
    ds_read_b64_tr_b16 v[8:9], v0 offset:6208
    v_mul_f32 v7, s61, v100
    v_mul_f32 v6, s61, v101
    v_mfma_f32_16x16x32_bf16 v[44:47], v[12:15], v[180:183], v[44:47]
    ds_read_b64_tr_b16 v[10:11], v0 offset:6976
    v_exp_f32 v7, v7
    v_mfma_f32_16x16x32_bf16 v[48:51], v[16:19], v[176:179], v[48:51]
    ds_read_b64_tr_b16 v[12:13], v0 offset:6240
    v_exp_f32 v6, v6
    v_add_f32 v7, 1.0, v7
    v_mfma_f32_16x16x32_bf16 v[52:55], v[16:19], v[180:183], v[52:55]
    ds_read_b64_tr_b16 v[14:15], v0 offset:7008
    v_add_f32 v6, 1.0, v6
    s_waitcnt lgkmcnt(4)
    v_mfma_f32_16x16x32_bf16 v[56:59], v[20:23], v[176:179], v[56:59]
    ds_read_b64_tr_b16 v[16:17], v0 offset:6272
    v_rcp_f32 v7, v7
    v_mfma_f32_16x16x32_bf16 v[60:63], v[20:23], v[180:183], v[60:63]
    ds_read_b64_tr_b16 v[18:19], v0 offset:7040
    v_rcp_f32 v6, v6
    v_mfma_f32_16x16x32_bf16 v[64:67], v[24:27], v[176:179], v[64:67]
    ds_read_b64_tr_b16 v[20:21], v0 offset:6304
    v_mul_f32 v100, v100, v7
    v_mul_f32 v101, v101, v6
    v_mfma_f32_16x16x32_bf16 v[68:71], v[24:27], v[180:183], v[68:71]
    ds_read_b64_tr_b16 v[22:23], v0 offset:7072
    v_mul_f32 v7, s61, v102
    v_mul_f32 v6, s61, v103
    v_mfma_f32_16x16x32_bf16 v[72:75], v[28:31], v[176:179], v[72:75]
    ds_read_b64_tr_b16 v[24:25], v0 offset:6336
    v_exp_f32 v7, v7
    v_mfma_f32_16x16x32_bf16 v[76:79], v[28:31], v[180:183], v[76:79]
    ds_read_b64_tr_b16 v[26:27], v0 offset:7104
    v_exp_f32 v6, v6
    s_waitcnt lgkmcnt(4)
    v_mfma_f32_16x16x32_bf16 v[32:35], v[8:11], v[184:187], v[32:35]
    ds_read_b64_tr_b16 v[28:29], v0 offset:6368
    v_add_f32 v7, 1.0, v7
    v_add_f32 v6, 1.0, v6
    v_mfma_f32_16x16x32_bf16 v[36:39], v[8:11], v[188:191], v[36:39]
    ds_read_b64_tr_b16 v[30:31], v0 offset:7136
    v_rcp_f32 v7, v7
    v_mfma_f32_16x16x32_bf16 v[40:43], v[12:15], v[184:187], v[40:43]
    ds_read_b64_tr_b16 v[8:9], v0 offset:12416
    v_rcp_f32 v6, v6
    v_mul_f32 v102, v102, v7
    v_mfma_f32_16x16x32_bf16 v[44:47], v[12:15], v[188:191], v[44:47]
    ds_read_b64_tr_b16 v[10:11], v0 offset:13184
    v_mul_f32 v103, v103, v6
    v_mfma_f32_16x16x32_bf16 v[48:51], v[16:19], v[184:187], v[48:51]
    ds_read_b64_tr_b16 v[12:13], v0 offset:12448
    v_mul_f32 v7, s61, v104
    v_mul_f32 v6, s61, v105
    v_mfma_f32_16x16x32_bf16 v[52:55], v[16:19], v[188:191], v[52:55]
    ds_read_b64_tr_b16 v[14:15], v0 offset:13216
    v_exp_f32 v7, v7
    s_waitcnt lgkmcnt(4)
    v_mfma_f32_16x16x32_bf16 v[56:59], v[20:23], v[184:187], v[56:59]
    ds_read_b64_tr_b16 v[16:17], v0 offset:12480
    v_exp_f32 v6, v6
    v_add_f32 v7, 1.0, v7
    v_mfma_f32_16x16x32_bf16 v[60:63], v[20:23], v[188:191], v[60:63]
    ds_read_b64_tr_b16 v[18:19], v0 offset:13248
    v_add_f32 v6, 1.0, v6
    v_mfma_f32_16x16x32_bf16 v[64:67], v[24:27], v[184:187], v[64:67]
    ds_read_b64_tr_b16 v[20:21], v0 offset:12512
    v_rcp_f32 v7, v7
    v_mfma_f32_16x16x32_bf16 v[68:71], v[24:27], v[188:191], v[68:71]
    ds_read_b64_tr_b16 v[22:23], v0 offset:13280
    v_rcp_f32 v6, v6
    v_mfma_f32_16x16x32_bf16 v[72:75], v[28:31], v[184:187], v[72:75]
    ds_read_b64_tr_b16 v[24:25], v0 offset:12544
    v_mul_f32 v104, v104, v7
    v_mul_f32 v105, v105, v6
    v_mfma_f32_16x16x32_bf16 v[76:79], v[28:31], v[188:191], v[76:79]
    ds_read_b64_tr_b16 v[26:27], v0 offset:13312
    v_mul_f32 v7, s61, v106
    v_mul_f32 v6, s61, v107
    s_waitcnt lgkmcnt(4)
    v_mfma_f32_16x16x32_bf16 v[32:35], v[8:11], v[192:195], v[32:35]
    ds_read_b64_tr_b16 v[28:29], v0 offset:12576
    v_exp_f32 v7, v7
    v_mfma_f32_16x16x32_bf16 v[36:39], v[8:11], v[196:199], v[36:39]
    ds_read_b64_tr_b16 v[30:31], v0 offset:13344
    v_exp_f32 v6, v6
    v_mfma_f32_16x16x32_bf16 v[40:43], v[12:15], v[192:195], v[40:43]
    ds_read_b64_tr_b16 v[8:9], v0 offset:18624
    v_add_f32 v7, 1.0, v7
    v_add_f32 v6, 1.0, v6
    v_mfma_f32_16x16x32_bf16 v[44:47], v[12:15], v[196:199], v[44:47]
    ds_read_b64_tr_b16 v[10:11], v0 offset:19392
    v_rcp_f32 v7, v7
    v_mfma_f32_16x16x32_bf16 v[48:51], v[16:19], v[192:195], v[48:51]
    ds_read_b64_tr_b16 v[12:13], v0 offset:18656
    v_rcp_f32 v6, v6
    v_mul_f32 v106, v106, v7
    v_mfma_f32_16x16x32_bf16 v[52:55], v[16:19], v[196:199], v[52:55]
    ds_read_b64_tr_b16 v[14:15], v0 offset:19424
    v_mul_f32 v107, v107, v6
    s_waitcnt lgkmcnt(4)
    v_mfma_f32_16x16x32_bf16 v[56:59], v[20:23], v[192:195], v[56:59]
    ds_read_b64_tr_b16 v[16:17], v0 offset:18688
    v_mul_f32 v7, s61, v108
    v_mul_f32 v6, s61, v109
    v_mfma_f32_16x16x32_bf16 v[60:63], v[20:23], v[196:199], v[60:63]
    ds_read_b64_tr_b16 v[18:19], v0 offset:19456
    v_exp_f32 v7, v7
    v_mfma_f32_16x16x32_bf16 v[64:67], v[24:27], v[192:195], v[64:67]
    ds_read_b64_tr_b16 v[20:21], v0 offset:18720
    v_exp_f32 v6, v6
    v_add_f32 v7, 1.0, v7
    v_mfma_f32_16x16x32_bf16 v[68:71], v[24:27], v[196:199], v[68:71]
    ds_read_b64_tr_b16 v[22:23], v0 offset:19488
    v_add_f32 v6, 1.0, v6
    v_mfma_f32_16x16x32_bf16 v[72:75], v[28:31], v[192:195], v[72:75]
    ds_read_b64_tr_b16 v[24:25], v0 offset:18752
    v_rcp_f32 v7, v7
    v_mfma_f32_16x16x32_bf16 v[76:79], v[28:31], v[196:199], v[76:79]
    ds_read_b64_tr_b16 v[26:27], v0 offset:19520
    v_rcp_f32 v6, v6
    s_waitcnt lgkmcnt(4)
    v_mfma_f32_16x16x32_bf16 v[32:35], v[8:11], v[200:203], v[32:35]
    ds_read_b64_tr_b16 v[28:29], v0 offset:18784
    v_mul_f32 v108, v108, v7
    v_mul_f32 v109, v109, v6
    v_mfma_f32_16x16x32_bf16 v[36:39], v[8:11], v[204:207], v[36:39]
    ds_read_b64_tr_b16 v[30:31], v0 offset:19552
    v_mul_f32 v7, s61, v110
    v_mul_f32 v6, s61, v111
    v_mfma_f32_16x16x32_bf16 v[40:43], v[12:15], v[200:203], v[40:43]
    ds_read_b64_tr_b16 v[8:9], v1 offset:37248
    v_exp_f32 v7, v7
    v_mfma_f32_16x16x32_bf16 v[44:47], v[12:15], v[204:207], v[44:47]
    ds_read_b64_tr_b16 v[10:11], v1 offset:38016
    v_exp_f32 v6, v6
    v_mfma_f32_16x16x32_bf16 v[48:51], v[16:19], v[200:203], v[48:51]
    ds_read_b64_tr_b16 v[12:13], v1 offset:37280
    v_add_f32 v7, 1.0, v7
    v_add_f32 v6, 1.0, v6
    v_mfma_f32_16x16x32_bf16 v[52:55], v[16:19], v[204:207], v[52:55]
    ds_read_b64_tr_b16 v[14:15], v1 offset:38048
    v_rcp_f32 v7, v7
    s_waitcnt lgkmcnt(4)
    v_mfma_f32_16x16x32_bf16 v[56:59], v[20:23], v[200:203], v[56:59]
    ds_read_b64_tr_b16 v[16:17], v1 offset:37312
    v_rcp_f32 v6, v6
    v_mul_f32 v110, v110, v7
    v_mfma_f32_16x16x32_bf16 v[60:63], v[20:23], v[204:207], v[60:63]
    ds_read_b64_tr_b16 v[18:19], v1 offset:38080
    v_mul_f32 v111, v111, v6
    v_mfma_f32_16x16x32_bf16 v[64:67], v[24:27], v[200:203], v[64:67]
    ds_read_b64_tr_b16 v[20:21], v1 offset:37344
    v_mul_f32 v7, s61, v112
    v_mul_f32 v6, s61, v113
    v_mfma_f32_16x16x32_bf16 v[68:71], v[24:27], v[204:207], v[68:71]
    ds_read_b64_tr_b16 v[22:23], v1 offset:38112
    v_exp_f32 v7, v7
    v_mfma_f32_16x16x32_bf16 v[72:75], v[28:31], v[200:203], v[72:75]
    ds_read_b64_tr_b16 v[24:25], v1 offset:37376
    v_exp_f32 v6, v6
    v_add_f32 v7, 1.0, v7
    v_mfma_f32_16x16x32_bf16 v[76:79], v[28:31], v[204:207], v[76:79]
    ds_read_b64_tr_b16 v[26:27], v1 offset:38144
    v_add_f32 v6, 1.0, v6
    s_waitcnt lgkmcnt(4)
    v_mfma_f32_16x16x32_bf16 v[32:35], v[8:11], v[208:211], v[32:35]
    ds_read_b64_tr_b16 v[28:29], v1 offset:37408
    v_rcp_f32 v7, v7
    v_mfma_f32_16x16x32_bf16 v[36:39], v[8:11], v[212:215], v[36:39]
    ds_read_b64_tr_b16 v[30:31], v1 offset:38176
    v_rcp_f32 v6, v6
    v_mfma_f32_16x16x32_bf16 v[40:43], v[12:15], v[208:211], v[40:43]
    ds_read_b64_tr_b16 v[8:9], v1 offset:43456
    v_mul_f32 v112, v112, v7
    v_mul_f32 v113, v113, v6
    v_mfma_f32_16x16x32_bf16 v[44:47], v[12:15], v[212:215], v[44:47]
    ds_read_b64_tr_b16 v[10:11], v1 offset:44224
    v_mul_f32 v7, s61, v114
    v_mul_f32 v6, s61, v115
    v_mfma_f32_16x16x32_bf16 v[48:51], v[16:19], v[208:211], v[48:51]
    ds_read_b64_tr_b16 v[12:13], v1 offset:43488
    v_exp_f32 v7, v7
    v_mfma_f32_16x16x32_bf16 v[52:55], v[16:19], v[212:215], v[52:55]
    ds_read_b64_tr_b16 v[14:15], v1 offset:44256
    v_exp_f32 v6, v6
    s_waitcnt lgkmcnt(4)
    v_mfma_f32_16x16x32_bf16 v[56:59], v[20:23], v[208:211], v[56:59]
    ds_read_b64_tr_b16 v[16:17], v1 offset:43520
    v_add_f32 v7, 1.0, v7
    v_add_f32 v6, 1.0, v6
    v_mfma_f32_16x16x32_bf16 v[60:63], v[20:23], v[212:215], v[60:63]
    ds_read_b64_tr_b16 v[18:19], v1 offset:44288
    v_rcp_f32 v7, v7
    v_mfma_f32_16x16x32_bf16 v[64:67], v[24:27], v[208:211], v[64:67]
    ds_read_b64_tr_b16 v[20:21], v1 offset:43552
    v_rcp_f32 v6, v6
    v_mul_f32 v114, v114, v7
    v_mfma_f32_16x16x32_bf16 v[68:71], v[24:27], v[212:215], v[68:71]
    ds_read_b64_tr_b16 v[22:23], v1 offset:44320
    v_mul_f32 v115, v115, v6
    v_mfma_f32_16x16x32_bf16 v[72:75], v[28:31], v[208:211], v[72:75]
    ds_read_b64_tr_b16 v[24:25], v1 offset:43584
    v_mul_f32 v7, s61, v116
    v_mul_f32 v6, s61, v117
    v_mfma_f32_16x16x32_bf16 v[76:79], v[28:31], v[212:215], v[76:79]
    ds_read_b64_tr_b16 v[26:27], v1 offset:44352
    v_exp_f32 v7, v7
    s_waitcnt lgkmcnt(4)
    v_mfma_f32_16x16x32_bf16 v[32:35], v[8:11], v[216:219], v[32:35]
    ds_read_b64_tr_b16 v[28:29], v1 offset:43616
    v_exp_f32 v6, v6
    v_add_f32 v7, 1.0, v7
    v_mfma_f32_16x16x32_bf16 v[36:39], v[8:11], v[220:223], v[36:39]
    ds_read_b64_tr_b16 v[30:31], v1 offset:44384
    v_add_f32 v6, 1.0, v6
    v_mfma_f32_16x16x32_bf16 v[40:43], v[12:15], v[216:219], v[40:43]
    ds_read_b64_tr_b16 v[8:9], v2 offset:0
    v_rcp_f32 v7, v7
    v_mfma_f32_16x16x32_bf16 v[44:47], v[12:15], v[220:223], v[44:47]
    ds_read_b64_tr_b16 v[10:11], v2 offset:768
    v_rcp_f32 v6, v6
    v_mfma_f32_16x16x32_bf16 v[48:51], v[16:19], v[216:219], v[48:51]
    ds_read_b64_tr_b16 v[12:13], v2 offset:32
    v_mul_f32 v116, v116, v7
    v_mul_f32 v117, v117, v6
    v_mfma_f32_16x16x32_bf16 v[52:55], v[16:19], v[220:223], v[52:55]
    ds_read_b64_tr_b16 v[14:15], v2 offset:800
    v_mul_f32 v7, s61, v118
    v_mul_f32 v6, s61, v119
    s_waitcnt lgkmcnt(4)
    v_mfma_f32_16x16x32_bf16 v[56:59], v[20:23], v[216:219], v[56:59]
    ds_read_b64_tr_b16 v[16:17], v2 offset:64
    v_exp_f32 v7, v7
    v_mfma_f32_16x16x32_bf16 v[60:63], v[20:23], v[220:223], v[60:63]
    ds_read_b64_tr_b16 v[18:19], v2 offset:832
    v_exp_f32 v6, v6
    v_mfma_f32_16x16x32_bf16 v[64:67], v[24:27], v[216:219], v[64:67]
    ds_read_b64_tr_b16 v[20:21], v2 offset:96
    v_add_f32 v7, 1.0, v7
    v_add_f32 v6, 1.0, v6
    v_mfma_f32_16x16x32_bf16 v[68:71], v[24:27], v[220:223], v[68:71]
    ds_read_b64_tr_b16 v[22:23], v2 offset:864
    v_rcp_f32 v7, v7
    v_mfma_f32_16x16x32_bf16 v[72:75], v[28:31], v[216:219], v[72:75]
    ds_read_b64_tr_b16 v[24:25], v2 offset:128
    v_rcp_f32 v6, v6
    v_mul_f32 v118, v118, v7
    v_mfma_f32_16x16x32_bf16 v[76:79], v[28:31], v[220:223], v[76:79]
    ds_read_b64_tr_b16 v[26:27], v2 offset:896
    v_mul_f32 v119, v119, v6
    s_waitcnt lgkmcnt(4)
    v_mfma_f32_16x16x32_bf16 v[32:35], v[8:11], v[224:227], v[32:35]
    ds_read_b64_tr_b16 v[28:29], v2 offset:160
    v_mul_f32 v7, s61, v120
    v_mul_f32 v6, s61, v121
    v_mfma_f32_16x16x32_bf16 v[36:39], v[8:11], v[228:231], v[36:39]
    ds_read_b64_tr_b16 v[30:31], v2 offset:928
    v_exp_f32 v7, v7
    v_mfma_f32_16x16x32_bf16 v[40:43], v[12:15], v[224:227], v[40:43]
    ds_read_b64_tr_b16 v[8:9], v2 offset:6208
    v_exp_f32 v6, v6
    v_add_f32 v7, 1.0, v7
    v_mfma_f32_16x16x32_bf16 v[44:47], v[12:15], v[228:231], v[44:47]
    ds_read_b64_tr_b16 v[10:11], v2 offset:6976
    v_add_f32 v6, 1.0, v6
    v_mfma_f32_16x16x32_bf16 v[48:51], v[16:19], v[224:227], v[48:51]
    ds_read_b64_tr_b16 v[12:13], v2 offset:6240
    v_rcp_f32 v7, v7
    v_mfma_f32_16x16x32_bf16 v[52:55], v[16:19], v[228:231], v[52:55]
    ds_read_b64_tr_b16 v[14:15], v2 offset:7008
    v_rcp_f32 v6, v6
    s_waitcnt lgkmcnt(4)
    v_mfma_f32_16x16x32_bf16 v[56:59], v[20:23], v[224:227], v[56:59]
    ds_read_b64_tr_b16 v[16:17], v2 offset:6272
    v_mul_f32 v120, v120, v7
    v_mul_f32 v121, v121, v6
    v_mfma_f32_16x16x32_bf16 v[60:63], v[20:23], v[228:231], v[60:63]
    ds_read_b64_tr_b16 v[18:19], v2 offset:7040
    v_mul_f32 v7, s61, v122
    v_mul_f32 v6, s61, v123
    v_mfma_f32_16x16x32_bf16 v[64:67], v[24:27], v[224:227], v[64:67]
    ds_read_b64_tr_b16 v[20:21], v2 offset:6304
    v_exp_f32 v7, v7
    v_mfma_f32_16x16x32_bf16 v[68:71], v[24:27], v[228:231], v[68:71]
    ds_read_b64_tr_b16 v[22:23], v2 offset:7072
    v_exp_f32 v6, v6
    v_mfma_f32_16x16x32_bf16 v[72:75], v[28:31], v[224:227], v[72:75]
    ds_read_b64_tr_b16 v[24:25], v2 offset:6336
    v_add_f32 v7, 1.0, v7
    v_add_f32 v6, 1.0, v6
    v_mfma_f32_16x16x32_bf16 v[76:79], v[28:31], v[228:231], v[76:79]
    ds_read_b64_tr_b16 v[26:27], v2 offset:7104
    v_rcp_f32 v7, v7
    s_waitcnt lgkmcnt(4)
    v_mfma_f32_16x16x32_bf16 v[32:35], v[8:11], v[232:235], v[32:35]
    ds_read_b64_tr_b16 v[28:29], v2 offset:6368
    v_rcp_f32 v6, v6
    v_mul_f32 v122, v122, v7
    v_mfma_f32_16x16x32_bf16 v[36:39], v[8:11], v[236:239], v[36:39]
    ds_read_b64_tr_b16 v[30:31], v2 offset:7136
    v_mul_f32 v123, v123, v6
    v_mfma_f32_16x16x32_bf16 v[40:43], v[12:15], v[232:235], v[40:43]
    ds_read_b64_tr_b16 v[8:9], v2 offset:24832
    v_mul_f32 v7, s61, v124
    v_mul_f32 v6, s61, v125
    v_mfma_f32_16x16x32_bf16 v[44:47], v[12:15], v[236:239], v[44:47]
    ds_read_b64_tr_b16 v[10:11], v2 offset:25600
    v_exp_f32 v7, v7
    v_mfma_f32_16x16x32_bf16 v[48:51], v[16:19], v[232:235], v[48:51]
    ds_read_b64_tr_b16 v[12:13], v2 offset:24864
    v_exp_f32 v6, v6
    v_add_f32 v7, 1.0, v7
    v_mfma_f32_16x16x32_bf16 v[52:55], v[16:19], v[236:239], v[52:55]
    ds_read_b64_tr_b16 v[14:15], v2 offset:25632
    v_add_f32 v6, 1.0, v6
    s_waitcnt lgkmcnt(4)
    v_mfma_f32_16x16x32_bf16 v[56:59], v[20:23], v[232:235], v[56:59]
    ds_read_b64_tr_b16 v[16:17], v2 offset:24896
    v_rcp_f32 v7, v7
    v_mfma_f32_16x16x32_bf16 v[60:63], v[20:23], v[236:239], v[60:63]
    ds_read_b64_tr_b16 v[18:19], v2 offset:25664
    v_rcp_f32 v6, v6
    v_mfma_f32_16x16x32_bf16 v[64:67], v[24:27], v[232:235], v[64:67]
    ds_read_b64_tr_b16 v[20:21], v2 offset:24928
    v_mul_f32 v124, v124, v7
    v_mul_f32 v125, v125, v6
    v_mfma_f32_16x16x32_bf16 v[68:71], v[24:27], v[236:239], v[68:71]
    ds_read_b64_tr_b16 v[22:23], v2 offset:25696
    v_mul_f32 v7, s61, v126
    v_mul_f32 v6, s61, v127
    v_mfma_f32_16x16x32_bf16 v[72:75], v[28:31], v[232:235], v[72:75]
    ds_read_b64_tr_b16 v[24:25], v2 offset:24960
    v_exp_f32 v7, v7
    v_mfma_f32_16x16x32_bf16 v[76:79], v[28:31], v[236:239], v[76:79]
    ds_read_b64_tr_b16 v[26:27], v2 offset:25728
    v_exp_f32 v6, v6
    s_waitcnt lgkmcnt(4)
    v_mfma_f32_16x16x32_bf16 v[32:35], v[8:11], v[240:243], v[32:35]
    ds_read_b64_tr_b16 v[28:29], v2 offset:24992
    v_add_f32 v7, 1.0, v7
    v_add_f32 v6, 1.0, v6
    v_mfma_f32_16x16x32_bf16 v[36:39], v[8:11], v[244:247], v[36:39]
    ds_read_b64_tr_b16 v[30:31], v2 offset:25760
    v_rcp_f32 v7, v7
    v_mfma_f32_16x16x32_bf16 v[40:43], v[12:15], v[240:243], v[40:43]
    ds_read_b64_tr_b16 v[8:9], v2 offset:31040
    v_rcp_f32 v6, v6
    v_mul_f32 v126, v126, v7
    v_mfma_f32_16x16x32_bf16 v[44:47], v[12:15], v[244:247], v[44:47]
    ds_read_b64_tr_b16 v[10:11], v2 offset:31808
    v_mul_f32 v127, v127, v6
    v_mfma_f32_16x16x32_bf16 v[48:51], v[16:19], v[240:243], v[48:51]
    ds_read_b64_tr_b16 v[12:13], v2 offset:31072
    v_mfma_f32_16x16x32_bf16 v[52:55], v[16:19], v[244:247], v[52:55]
    ds_read_b64_tr_b16 v[14:15], v2 offset:31840
    s_waitcnt lgkmcnt(4)
    v_mfma_f32_16x16x32_bf16 v[56:59], v[20:23], v[240:243], v[56:59]
    ds_read_b64_tr_b16 v[16:17], v2 offset:31104
    v_mfma_f32_16x16x32_bf16 v[60:63], v[20:23], v[244:247], v[60:63]
    ds_read_b64_tr_b16 v[18:19], v2 offset:31872
    v_mfma_f32_16x16x32_bf16 v[64:67], v[24:27], v[240:243], v[64:67]
    ds_read_b64_tr_b16 v[20:21], v2 offset:31136
    v_mfma_f32_16x16x32_bf16 v[68:71], v[24:27], v[244:247], v[68:71]
    ds_read_b64_tr_b16 v[22:23], v2 offset:31904
    v_mfma_f32_16x16x32_bf16 v[72:75], v[28:31], v[240:243], v[72:75]
    ds_read_b64_tr_b16 v[24:25], v2 offset:31168
    v_mfma_f32_16x16x32_bf16 v[76:79], v[28:31], v[244:247], v[76:79]
    ds_read_b64_tr_b16 v[26:27], v2 offset:31936
    s_waitcnt lgkmcnt(4)
    v_mfma_f32_16x16x32_bf16 v[32:35], v[8:11], v[248:251], v[32:35]
    ds_read_b64_tr_b16 v[28:29], v2 offset:31200
    v_mfma_f32_16x16x32_bf16 v[36:39], v[8:11], v[252:255], v[36:39]
    ds_read_b64_tr_b16 v[30:31], v2 offset:31968
    v_mfma_f32_16x16x32_bf16 v[40:43], v[12:15], v[248:251], v[40:43]
    v_mfma_f32_16x16x32_bf16 v[44:47], v[12:15], v[252:255], v[44:47]
    v_mfma_f32_16x16x32_bf16 v[48:51], v[16:19], v[248:251], v[48:51]
    v_mfma_f32_16x16x32_bf16 v[52:55], v[16:19], v[252:255], v[52:55]
    s_waitcnt lgkmcnt(0)
    v_mfma_f32_16x16x32_bf16 v[56:59], v[20:23], v[248:251], v[56:59]
    v_mfma_f32_16x16x32_bf16 v[60:63], v[20:23], v[252:255], v[60:63]
    v_mfma_f32_16x16x32_bf16 v[64:67], v[24:27], v[248:251], v[64:67]
    v_mfma_f32_16x16x32_bf16 v[68:71], v[24:27], v[252:255], v[68:71]
    v_mfma_f32_16x16x32_bf16 v[72:75], v[28:31], v[248:251], v[72:75]
    v_mfma_f32_16x16x32_bf16 v[76:79], v[28:31], v[252:255], v[76:79]
    v_mbcnt_lo_u32_b32 v3, -1, 0
    v_mbcnt_hi_u32_b32 v3, -1, v3
    v_lshlrev_b32 v7, 4, v3
    s_cmp_eq_u32 s101, 3
    s_cselect_b32 s35, 16384, 0x40000000
    v_mul_f32 v80, v80, v32
    v_mul_f32 v81, v81, v33
    v_mul_f32 v82, v82, v34
    v_mul_f32 v83, v83, v35
    v_mul_f32 v84, v84, v36
    v_mul_f32 v85, v85, v37
    v_mul_f32 v86, v86, v38
    v_mul_f32 v87, v87, v39
    v_mul_f32 v88, v88, v40
    v_mul_f32 v89, v89, v41
    v_mul_f32 v90, v90, v42
    v_mul_f32 v91, v91, v43
    v_mul_f32 v92, v92, v44
    v_mul_f32 v93, v93, v45
    v_mul_f32 v94, v94, v46
    v_mul_f32 v95, v95, v47
    v_cvt_pk_bf16_f32 v156, v80, v81
    v_cvt_pk_bf16_f32 v157, v82, v83
    v_cvt_pk_bf16_f32 v158, v84, v85
    v_cvt_pk_bf16_f32 v159, v86, v87
    v_cvt_pk_bf16_f32 v160, v88, v89
    v_cvt_pk_bf16_f32 v161, v90, v91
    v_cvt_pk_bf16_f32 v162, v92, v93
    v_cvt_pk_bf16_f32 v163, v94, v95
    v_permlane16_swap_b32 v156, v158
    v_permlane16_swap_b32 v157, v159
    v_permlane16_swap_b32 v160, v162
    v_permlane16_swap_b32 v161, v163
    buffer_store_dwordx4 v[156:159], v7, s[40:43], s88 offen sc1
    s_add_u32 s88, s88, 16384
    buffer_store_dwordx4 v[160:163], v7, s[40:43], s88 offen sc1
    s_add_u32 s88, s88, 16384
    v_mul_f32 v96, v96, v48
    v_mul_f32 v97, v97, v49
    v_mul_f32 v98, v98, v50
    v_mul_f32 v99, v99, v51
    v_mul_f32 v100, v100, v52
    v_mul_f32 v101, v101, v53
    v_mul_f32 v102, v102, v54
    v_mul_f32 v103, v103, v55
    v_mul_f32 v104, v104, v56
    v_mul_f32 v105, v105, v57
    v_mul_f32 v106, v106, v58
    v_mul_f32 v107, v107, v59
    v_mul_f32 v108, v108, v60
    v_mul_f32 v109, v109, v61
    v_mul_f32 v110, v110, v62
    v_mul_f32 v111, v111, v63
    v_cvt_pk_bf16_f32 v164, v96, v97
    v_cvt_pk_bf16_f32 v165, v98, v99
    v_cvt_pk_bf16_f32 v166, v100, v101
    v_cvt_pk_bf16_f32 v167, v102, v103
    v_cvt_pk_bf16_f32 v168, v104, v105
    v_cvt_pk_bf16_f32 v169, v106, v107
    v_cvt_pk_bf16_f32 v170, v108, v109
    v_cvt_pk_bf16_f32 v171, v110, v111
    v_permlane16_swap_b32 v164, v166
    v_permlane16_swap_b32 v165, v167
    v_permlane16_swap_b32 v168, v170
    v_permlane16_swap_b32 v169, v171
    buffer_store_dwordx4 v[164:167], v7, s[40:43], s88 offen sc1
    s_add_u32 s88, s88, 16384
    buffer_store_dwordx4 v[168:171], v7, s[40:43], s88 offen sc1
    s_add_u32 s88, s88, s35
    v_mul_f32 v112, v112, v64
    v_mul_f32 v113, v113, v65
    v_mul_f32 v114, v114, v66
    v_mul_f32 v115, v115, v67
    v_mul_f32 v116, v116, v68
    v_mul_f32 v117, v117, v69
    v_mul_f32 v118, v118, v70
    v_mul_f32 v119, v119, v71
    v_mul_f32 v120, v120, v72
    v_mul_f32 v121, v121, v73
    v_mul_f32 v122, v122, v74
    v_mul_f32 v123, v123, v75
    v_mul_f32 v124, v124, v76
    v_mul_f32 v125, v125, v77
    v_mul_f32 v126, v126, v78
    v_mul_f32 v127, v127, v79
    v_cvt_pk_bf16_f32 v172, v112, v113
    v_cvt_pk_bf16_f32 v173, v114, v115
    v_cvt_pk_bf16_f32 v174, v116, v117
    v_cvt_pk_bf16_f32 v175, v118, v119
    v_cvt_pk_bf16_f32 v176, v120, v121
    v_cvt_pk_bf16_f32 v177, v122, v123
    v_cvt_pk_bf16_f32 v178, v124, v125
    v_cvt_pk_bf16_f32 v179, v126, v127
    v_permlane16_swap_b32 v172, v174
    v_permlane16_swap_b32 v173, v175
    v_permlane16_swap_b32 v176, v178
    v_permlane16_swap_b32 v177, v179
    buffer_store_dwordx4 v[172:175], v7, s[40:43], s88 offen sc1
    s_add_u32 s88, s88, 16384
    buffer_store_dwordx4 v[176:179], v7, s[40:43], s88 offen sc1
    s_add_u32 s88, s88, 16384
    v_mov_b32 v247, v3
    s_lshl_b32 s36, s27, 16
    s_add_u32 s44, s36, 2097152
    s_add_u32 s44, s44, s22
    s_addc_u32 s45, s23, 0
    s_and_b32 s45, s45, 0xffff
    s_mov_b32 s46, 65536
    s_mov_b32 s47, 0x20000
    s_add_u32 s48, s36, 4194304
    s_add_u32 s48, s48, s22
    s_addc_u32 s49, s23, 0
    s_and_b32 s49, s49, 0xffff
    s_mov_b32 s50, 65536
    s_mov_b32 s51, 0x20000
    s_lshr_b32 s33, s24, 2
    s_lshl_b32 s33, s33, 15
    s_add_u32 s32, s36, s33
    s_lshl_b32 s33, s28, 7
    s_add_u32 s32, s32, s33
    s_and_b32 s33, s24, 3
    s_lshl_b32 s33, s33, 5
    s_add_u32 s39, s32, s33
    s_min_u32 s32, s31, 2
    s_mul_i32 s33, s32, 25600
    s_cmp_eq_u32 s31, 3
    s_cselect_b32 s32, 7168, 0
    s_add_u32 s33, s33, s32
    s_lshl_b32 s99, s28, 3
    s_lshl_b32 s32, s63, 2
    s_add_u32 s99, s99, s32
    s_barrier
    v_lshlrev_b32 v245, 4, v247
    v_lshrrev_b32 v253, 5, v247
    v_and_b32 v254, 15, v247
    v_lshlrev_b32 v254, 4, v254
    v_lshl_add_u32 v246, v253, 8, v254
    v_and_b32 v254, 31, v247
    v_lshlrev_b32 v254, 10, v254
    v_lshl_add_u32 v248, v253, 4, v254
    v_and_b32 v253, 27, v247
    v_cmp_eq_u32 vcc, 16, v253
    v_mov_b32 v253, s62
    s_nop 0
    v_cndmask_b32 v124, 0, v253, vcc
    v_mov_b32 v125, v124
    v_mov_b32 v126, v124
    v_mov_b32 v127, v124
    v_mov_b32 v128, v124
    v_mov_b32 v129, v124
    v_mov_b32 v130, v124
    v_mov_b32 v131, v124
    v_mov_b32 v132, v124
    v_mov_b32 v133, v124
    v_mov_b32 v134, v124
    v_mov_b32 v135, v124
    v_mov_b32 v136, v124
    v_mov_b32 v137, v124
    v_mov_b32 v138, v124
    v_mov_b32 v139, v124
    v_mov_b32 v140, v124
    v_mov_b32 v141, v124
    v_mov_b32 v142, v124
    v_mov_b32 v143, v124
    v_mov_b32 v144, v124
    v_mov_b32 v145, v124
    v_mov_b32 v146, v124
    v_mov_b32 v147, v124
    s_add_u32 s32, s31, 0
    s_and_b32 s32, s32, 3
    s_add_u32 s32, s32, s99
    s_lshl_b32 s32, s32, 10
    s_add_u32 s32, s32, s36
    buffer_load_dwordx4 v[96:99], v245, s[40:43], s32 offen sc1
    buffer_load_dwordx4 v[112:115], v245, s[44:47], s33 offen offset:0 sc1
    s_add_u32 s32, s31, 1
    s_and_b32 s32, s32, 3
    s_add_u32 s32, s32, s99
    s_lshl_b32 s32, s32, 10
    s_add_u32 s32, s32, s36
    buffer_load_dwordx4 v[100:103], v245, s[40:43], s32 offen sc1
    s_add_u32 s32, s31, 2
    s_and_b32 s32, s32, 3
    s_add_u32 s32, s32, s99
    s_lshl_b32 s32, s32, 10
    s_add_u32 s32, s32, s36
    buffer_load_dwordx4 v[104:107], v245, s[40:43], s32 offen sc1
    s_add_u32 s32, s31, 3
    s_and_b32 s32, s32, 3
    s_add_u32 s32, s32, s99
    s_lshl_b32 s32, s32, 10
    s_add_u32 s32, s32, s36
    buffer_load_dwordx4 v[108:111], v245, s[40:43], s32 offen sc1
    s_mov_b64 exec, s[96:97]
    buffer_load_dwordx4 v[124:127], v246, s[48:51], s33 offen offset:0 sc1
    buffer_load_dwordx4 v[128:131], v246, s[48:51], s33 offen offset:512 sc1
    s_mov_b64 exec, -1
    buffer_load_dwordx4 v[116:119], v245, s[44:47], s33 offen offset:1024 sc1
    s_mov_b64 exec, s[96:97]
    buffer_load_dwordx4 v[132:135], v246, s[48:51], s33 offen offset:1024 sc1
    buffer_load_dwordx4 v[136:139], v246, s[48:51], s33 offen offset:1536 sc1
    s_mov_b64 exec, -1
    buffer_load_dwordx4 v[120:123], v245, s[44:47], s33 offen offset:2048 sc1
    s_mov_b64 exec, s[96:97]
    buffer_load_dwordx4 v[140:143], v246, s[48:51], s33 offen offset:2048 sc1
    buffer_load_dwordx4 v[144:147], v246, s[48:51], s33 offen offset:2560 sc1
    s_mov_b64 exec, -1
    v_mov_b32 v88, 0
    v_mov_b32 v89, 0
    v_mov_b32 v90, 0
    v_mov_b32 v91, 0
    v_mov_b32 v244, 0xdddddddd
    s_nop 0
    v_mfma_f32_32x32x16_bf16 v[0:15], v[88:91], v[88:91], 0
    v_mfma_f32_32x32x16_bf16 v[16:31], v[88:91], v[88:91], 0
    v_mfma_f32_32x32x16_bf16 v[32:47], v[88:91], v[88:91], 0
    v_mfma_f32_32x32x16_bf16 v[48:63], v[88:91], v[88:91], 0
    s_lshr_b32 s32, s27, 3
    s_mul_i32 s36, s32, 1409024
    s_and_b32 s32, s27, 7
    s_lshl_b32 s32, s32, 11
    s_add_u32 s36, s36, s32
    s_sub_u32 s35, 1409024, s32
    s_mov_b32 s52, s16
    s_and_b32 s53, s17, 0xffff
    s_mov_b32 s54, 1409024
    s_mov_b32 s55, 0x20000
    s_add_u32 s56, s36, 10485760
    s_add_u32 s56, s56, s22
    s_addc_u32 s57, s23, 0
    s_and_b32 s57, s57, 0xffff
    s_mov_b32 s58, s35
    s_mov_b32 s59, 0x20000
    v_lshrrev_b32 v251, 3, v247
    v_lshlrev_b32 v251, 10, v251
    v_and_b32 v252, 7, v247
    v_bfe_u32 v253, v247, 4, 1
    v_lshlrev_b32 v253, 2, v253
    v_xor_b32 v252, v252, v253
    v_lshl_add_u32 v249, v252, 4, v251
    v_add_u32 v250, 7168, v249
    v_lshrrev_b32 v252, 5, v247
    v_bfe_u32 v253, v247, 2, 2
    v_lshl_add_u32 v252, v252, 3, v253
    v_mul_u32_u24 v251, 128, v252
    v_bfe_u32 v252, v247, 4, 1
    v_lshl_add_u32 v251, v252, 5, v251
    v_and_b32 v252, 1, v247
    v_lshl_add_u32 v251, v252, 4, v251
    v_bfe_u32 v252, v247, 1, 1
    v_lshl_add_u32 v251, v252, 3, v251
    v_bfe_u32 v252, v247, 3, 1
    v_lshl_add_u32 v251, v252, 6, v251
    s_lshl_b32 s32, s28, 7
    v_add_u32 v249, s32, v249
    v_add_u32 v250, s32, v250
    s_lshl_b32 s37, s24, 13
    s_add_u32 s37, s37, 120832
    v_add_u32 v251, s37, v251
    v_xor_b32 v252, 64, v251
    s_lshl_b32 s38, s24, 14
    s_lshr_b32 s32, s27, 1
    s_lshl_b32 s32, s32, 16
    s_or_b32 s90, s38, s32
    s_and_b32 s91, s90, 0x3ffff
    s_and_b32 s92, s90, 0x1ffff
    s_lshl_b32 s32, s30, 6
    s_lshl_b32 s35, s26, 2
    s_add_u32 s32, s32, s35
    s_add_u32 s32, s32, 16318464
    s_mov_b32 s89, s32
    v_and_b32 v253, 31, v247
    s_lshl_b32 s32, s27, 7
    s_add_u32 s32, s32, 16318464
    v_lshl_add_u32 v253, v253, 2, s32
    s_lshl_b32 s38, s63, 2
    s_add_u32 s32, s38, s31
    s_mul_i32 s32, s32, 6912
    s_add_u32 s0, s32, 65536
    s_add_u32 s32, s31, 1
    s_and_b32 s32, s32, 3
    s_add_u32 s32, s32, s38
    s_mul_i32 s32, s32, 6912
    s_add_u32 s25, s32, 65536
    s_xor_b32 s32, s24, 1
    s_mul_i32 s32, s32, 6144
    s_add_u32 s95, s32, 0
    s_add_u32 s32, s31, 2
    s_and_b32 s32, s32, 3
    s_add_u32 s32, s32, s38
    s_mul_i32 s32, s32, 6912
    s_add_u32 s26, s32, 67840
    s_xor_b32 s32, s24, 2
    s_mul_i32 s32, s32, 6144
    s_add_u32 s100, s32, 2048
    s_add_u32 s32, s31, 3
    s_and_b32 s32, s32, 3
    s_add_u32 s32, s32, s38
    s_mul_i32 s32, s32, 6912
    s_add_u32 s29, s32, 70144
    s_xor_b32 s32, s24, 3
    s_mul_i32 s32, s32, 6144
    s_add_u32 s101, s32, 4096
    s_add_u32 s32, s99, s31
    s_lshl_b32 s32, s32, 5
    s_add_u32 s32, s32, s27
    s_lshl_b32 s32, s32, 10
    s_add_u32 s1, s32, 6291456
    s_lshl_b32 s32, s27, 1
    s_lshr_b32 s38, s24, 2
    s_add_u32 s32, s32, s38
    s_lshl_b32 s32, s32, 2
    s_and_b32 s38, s24, 3
    s_add_u32 s32, s32, s38
    s_lshl_b32 s32, s32, 13
    s_add_u32 s3, s32, 6291456
    s_add_u32 s10, s32, 6295552
    s_lshl_b32 s30, s38, 5
    s_lshl_b32 s34, s38, 14
    s_lshl_b32 s32, s24, 14
    s_add_u32 s11, s32, 65536
    s_lshl_b32 s32, s24, 11
    s_add_u32 s93, s32, 65536
    s_mul_i32 s32, s24, 6144
    s_add_u32 s94, s32, 0
    s_mov_b32 s4, s4
    s_and_b32 s5, s5, 0xffff
    s_mov_b32 s6, 2097152
    s_mov_b32 s7, 0x20000
    s_mov_b32 s12, s18
    s_and_b32 s13, s19, 0xffff
    s_mov_b32 s14, 2097152
    s_mov_b32 s15, 0x20000
    s_waitcnt vmcnt(6)
    v_mfma_f32_32x32x16_bf16 v[64:79], v[112:115], v[96:99], 0
    v_mov_b32 v254, 0
    v_mov_b32 v255, 1
    s_mov_b64 exec, 1
    buffer_store_dword v255, v254, s[40:43], s89 offen sc1
    s_mov_b64 exec, -1
    s_nop 6
    v_exp_f32 v64, v64
    v_exp_f32 v65, v65
    v_exp_f32 v66, v66
    v_exp_f32 v67, v67
    v_exp_f32 v68, v68
    v_mfma_f32_32x32x16_bf16 v[80:95], v[112:115], v[100:103], 0
    v_exp_f32 v69, v69
    v_exp_f32 v70, v70
    v_exp_f32 v71, v71
    v_exp_f32 v72, v72
    v_exp_f32 v73, v73
    v_smfmac_f32_32x32x32_bf16 v[0:15], v[124:127], v[64:71], v244
    v_exp_f32 v74, v74
    v_exp_f32 v75, v75
    v_exp_f32 v76, v76
    v_exp_f32 v77, v77
    v_exp_f32 v78, v78
    v_exp_f32 v79, v79
    v_exp_f32 v80, v80
    v_exp_f32 v81, v81
    v_smfmac_f32_32x32x32_bf16 v[0:15], v[128:131], v[72:79], v244
    v_exp_f32 v82, v82
    v_exp_f32 v83, v83
    v_exp_f32 v84, v84
    v_mfma_f32_32x32x16_bf16 v[64:79], v[112:115], v[104:107], 0
    v_exp_f32 v85, v85
    v_exp_f32 v86, v86
    v_exp_f32 v87, v87
    v_exp_f32 v88, v88
    v_exp_f32 v89, v89
    v_smfmac_f32_32x32x32_bf16 v[16:31], v[124:127], v[80:87], v244
    v_exp_f32 v90, v90
    v_exp_f32 v91, v91
    v_exp_f32 v92, v92
    v_exp_f32 v93, v93
    v_exp_f32 v94, v94
    v_exp_f32 v95, v95
    v_exp_f32 v64, v64
    v_exp_f32 v65, v65
    v_smfmac_f32_32x32x32_bf16 v[16:31], v[128:131], v[88:95], v244
    v_exp_f32 v66, v66
    v_exp_f32 v67, v67
    v_exp_f32 v68, v68
    v_mfma_f32_32x32x16_bf16 v[80:95], v[112:115], v[108:111], 0
    v_exp_f32 v69, v69
    v_exp_f32 v70, v70
    v_exp_f32 v71, v71
    v_exp_f32 v72, v72
    v_exp_f32 v73, v73
    v_smfmac_f32_32x32x32_bf16 v[32:47], v[124:127], v[64:71], v244
    v_exp_f32 v74, v74
    v_exp_f32 v75, v75
    v_exp_f32 v76, v76
    v_exp_f32 v77, v77
    v_exp_f32 v78, v78
    v_exp_f32 v79, v79
    v_exp_f32 v80, v80
    v_exp_f32 v81, v81
    v_smfmac_f32_32x32x32_bf16 v[32:47], v[128:131], v[72:79], v244
    v_exp_f32 v82, v82
    v_exp_f32 v83, v83
    v_exp_f32 v84, v84
    s_waitcnt vmcnt(4)
    v_mfma_f32_32x32x16_bf16 v[64:79], v[116:119], v[96:99], 0
    buffer_load_dwordx4 v[112:115], v245, s[44:47], s33 offen offset:3072 sc1
    v_exp_f32 v85, v85
    v_exp_f32 v86, v86
    v_exp_f32 v87, v87
    v_exp_f32 v88, v88
    v_exp_f32 v89, v89
    v_smfmac_f32_32x32x32_bf16 v[48:63], v[124:127], v[80:87], v244
    v_exp_f32 v90, v90
    v_exp_f32 v91, v91
    v_exp_f32 v92, v92
    v_exp_f32 v93, v93
    v_exp_f32 v94, v94
    v_exp_f32 v95, v95
    v_exp_f32 v64, v64
    v_exp_f32 v65, v65
    v_smfmac_f32_32x32x32_bf16 v[48:63], v[128:131], v[88:95], v244
    s_mov_b64 exec, s[96:97]
    buffer_load_dwordx4 v[124:127], v246, s[48:51], s33 offen offset:3072 sc1
    buffer_load_dwordx4 v[128:131], v246, s[48:51], s33 offen offset:3584 sc1
    s_mov_b64 exec, -1
    v_exp_f32 v66, v66
    v_exp_f32 v67, v67
    v_exp_f32 v68, v68
    v_mfma_f32_32x32x16_bf16 v[80:95], v[116:119], v[100:103], 0
    v_exp_f32 v69, v69
    v_exp_f32 v70, v70
    v_exp_f32 v71, v71
    v_exp_f32 v72, v72
    v_exp_f32 v73, v73
    v_smfmac_f32_32x32x32_bf16 v[0:15], v[132:135], v[64:71], v244
    v_exp_f32 v74, v74
    v_exp_f32 v75, v75
    v_exp_f32 v76, v76
    v_exp_f32 v77, v77
    v_exp_f32 v78, v78
    v_exp_f32 v79, v79
    v_exp_f32 v80, v80
    v_exp_f32 v81, v81
    v_smfmac_f32_32x32x32_bf16 v[0:15], v[136:139], v[72:79], v244
    v_exp_f32 v82, v82
    v_exp_f32 v83, v83
    v_exp_f32 v84, v84
    v_mfma_f32_32x32x16_bf16 v[64:79], v[116:119], v[104:107], 0
    v_exp_f32 v85, v85
    v_exp_f32 v86, v86
    v_exp_f32 v87, v87
    v_exp_f32 v88, v88
    v_exp_f32 v89, v89
    v_smfmac_f32_32x32x32_bf16 v[16:31], v[132:135], v[80:87], v244
    v_exp_f32 v90, v90
    v_exp_f32 v91, v91
    v_exp_f32 v92, v92
    v_exp_f32 v93, v93
    v_exp_f32 v94, v94
    v_exp_f32 v95, v95
    v_exp_f32 v64, v64
    v_exp_f32 v65, v65
    v_smfmac_f32_32x32x32_bf16 v[16:31], v[136:139], v[88:95], v244
    v_exp_f32 v66, v66
    v_exp_f32 v67, v67
    v_exp_f32 v68, v68
    v_mfma_f32_32x32x16_bf16 v[80:95], v[116:119], v[108:111], 0
    v_exp_f32 v69, v69
    v_exp_f32 v70, v70
    v_exp_f32 v71, v71
    v_exp_f32 v72, v72
    v_exp_f32 v73, v73
    v_smfmac_f32_32x32x32_bf16 v[32:47], v[132:135], v[64:71], v244
    v_exp_f32 v74, v74
    v_exp_f32 v75, v75
    v_exp_f32 v76, v76
    v_exp_f32 v77, v77
    v_exp_f32 v78, v78
    v_exp_f32 v79, v79
    v_exp_f32 v80, v80
    v_exp_f32 v81, v81
    v_smfmac_f32_32x32x32_bf16 v[32:47], v[136:139], v[72:79], v244
    v_exp_f32 v82, v82
    v_exp_f32 v83, v83
    v_exp_f32 v84, v84
    s_waitcnt vmcnt(4)
    v_mfma_f32_32x32x16_bf16 v[64:79], v[120:123], v[96:99], 0
    s_add_u32 s33, s33, 4096
    buffer_load_dwordx4 v[116:119], v245, s[44:47], s33 offen offset:0 sc1
    v_exp_f32 v85, v85
    v_exp_f32 v86, v86
    v_exp_f32 v87, v87
    v_exp_f32 v88, v88
    v_exp_f32 v89, v89
    v_smfmac_f32_32x32x32_bf16 v[48:63], v[132:135], v[80:87], v244
    v_exp_f32 v90, v90
    v_exp_f32 v91, v91
    v_exp_f32 v92, v92
    v_exp_f32 v93, v93
    v_exp_f32 v94, v94
    v_exp_f32 v95, v95
    v_exp_f32 v64, v64
    v_exp_f32 v65, v65
    v_smfmac_f32_32x32x32_bf16 v[48:63], v[136:139], v[88:95], v244
    s_mov_b64 exec, s[96:97]
    buffer_load_dwordx4 v[132:135], v246, s[48:51], s33 offen offset:0 sc1
    buffer_load_dwordx4 v[136:139], v246, s[48:51], s33 offen offset:512 sc1
    s_mov_b64 exec, -1
    s_mov_b32 s98, 60000
PK_p2:
    buffer_load_dword v254, v253, s[40:43], 0 offen sc1
    s_waitcnt vmcnt(0)
    v_cmp_eq_u32 vcc, 1, v254
    s_sub_u32 s98, s98, 1
    s_cmp_eq_u64 vcc, -1
    s_cbranch_scc1 PK_p2_ok
    s_cmp_lg_u32 s98, 0
    s_cbranch_scc1 PK_p2
PK_p2_ok:
    s_xor_b32 s38, s90, 0
    s_add_u32 m0, s37, 0
    buffer_load_dwordx4 v[156:159], v245, s[56:59], s38 offen sc1
    buffer_load_dwordx4 v249, s[52:55], s38 offen lds
    buffer_load_dwordx4 v250, s[52:55], s38 offen offset:1024 lds
    buffer_load_dwordx4 v[160:163], v245, s[56:59], s38 offen offset:1024 sc1
    s_xor_b32 s38, s90, 65536
    s_add_u32 m0, s37, 2048
    buffer_load_dwordx4 v[164:167], v245, s[56:59], s38 offen sc1
    buffer_load_dwordx4 v249, s[52:55], s38 offen lds
    buffer_load_dwordx4 v250, s[52:55], s38 offen offset:1024 lds
    buffer_load_dwordx4 v[168:171], v245, s[56:59], s38 offen offset:1024 sc1
    v_exp_f32 v66, v66
    v_exp_f32 v67, v67
    v_exp_f32 v68, v68
    v_mfma_f32_32x32x16_bf16 v[80:95], v[120:123], v[100:103], 0
    v_exp_f32 v69, v69
    v_exp_f32 v70, v70
    v_exp_f32 v71, v71
    v_exp_f32 v72, v72
    v_exp_f32 v73, v73
    v_smfmac_f32_32x32x32_bf16 v[0:15], v[140:143], v[64:71], v244
    v_exp_f32 v74, v74
    v_exp_f32 v75, v75
    v_exp_f32 v76, v76
    v_exp_f32 v77, v77
    v_exp_f32 v78, v78
    v_exp_f32 v79, v79
    v_exp_f32 v80, v80
    v_exp_f32 v81, v81
    v_smfmac_f32_32x32x32_bf16 v[0:15], v[144:147], v[72:79], v244
    v_exp_f32 v82, v82
    v_exp_f32 v83, v83
    v_exp_f32 v84, v84
    v_mfma_f32_32x32x16_bf16 v[64:79], v[120:123], v[104:107], 0
    v_exp_f32 v85, v85
    v_exp_f32 v86, v86
    v_exp_f32 v87, v87
    v_exp_f32 v88, v88
    v_exp_f32 v89, v89
    v_smfmac_f32_32x32x32_bf16 v[16:31], v[140:143], v[80:87], v244
    v_exp_f32 v90, v90
    v_exp_f32 v91, v91
    v_exp_f32 v92, v92
    v_exp_f32 v93, v93
    v_exp_f32 v94, v94
    v_exp_f32 v95, v95
    v_exp_f32 v64, v64
    v_exp_f32 v65, v65
    v_smfmac_f32_32x32x32_bf16 v[16:31], v[144:147], v[88:95], v244
    v_exp_f32 v66, v66
    v_exp_f32 v67, v67
    v_exp_f32 v68, v68
    v_mfma_f32_32x32x16_bf16 v[80:95], v[120:123], v[108:111], 0
    v_exp_f32 v69, v69
    v_exp_f32 v70, v70
    v_exp_f32 v71, v71
    v_exp_f32 v72, v72
    v_exp_f32 v73, v73
    v_smfmac_f32_32x32x32_bf16 v[32:47], v[140:143], v[64:71], v244
    v_exp_f32 v74, v74
    v_exp_f32 v75, v75
    v_exp_f32 v76, v76
    v_exp_f32 v77, v77
    v_exp_f32 v78, v78
    v_exp_f32 v79, v79
    v_exp_f32 v80, v80
    v_exp_f32 v81, v81
    v_smfmac_f32_32x32x32_bf16 v[32:47], v[144:147], v[72:79], v244
    v_exp_f32 v82, v82
    v_exp_f32 v83, v83
    v_exp_f32 v84, v84
    s_waitcnt vmcnt(4)
    v_mfma_f32_32x32x16_bf16 v[64:79], v[112:115], v[96:99], 0
    buffer_load_dwordx4 v[120:123], v245, s[44:47], s33 offen offset:1024 sc1
    ds_read_b64_tr_b16 v[148:149], v251 offset:0
    ds_read_b64_tr_b16 v[150:151], v251 offset:512
    ds_read_b64_tr_b16 v[152:153], v252 offset:0
    ds_read_b64_tr_b16 v[154:155], v252 offset:512
    v_exp_f32 v85, v85
    v_exp_f32 v86, v86
    v_exp_f32 v87, v87
    v_exp_f32 v88, v88
    v_exp_f32 v89, v89
    v_smfmac_f32_32x32x32_bf16 v[48:63], v[140:143], v[80:87], v244
    v_exp_f32 v90, v90
    v_exp_f32 v91, v91
    v_exp_f32 v92, v92
    v_exp_f32 v93, v93
    v_exp_f32 v94, v94
    v_exp_f32 v95, v95
    v_exp_f32 v64, v64
    v_exp_f32 v65, v65
    v_smfmac_f32_32x32x32_bf16 v[48:63], v[144:147], v[88:95], v244
    s_mov_b64 exec, s[96:97]
    buffer_load_dwordx4 v[140:143], v246, s[48:51], s33 offen offset:1024 sc1
    buffer_load_dwordx4 v[144:147], v246, s[48:51], s33 offen offset:1536 sc1
    s_mov_b64 exec, -1
    v_exp_f32 v66, v66
    v_exp_f32 v67, v67
    v_exp_f32 v68, v68
    v_mfma_f32_32x32x16_bf16 v[80:95], v[112:115], v[100:103], 0
    s_xor_b32 s38, s90, 131072
    s_add_u32 m0, s37, 4096
    buffer_load_dwordx4 v[172:175], v245, s[56:59], s38 offen sc1
    buffer_load_dwordx4 v249, s[52:55], s38 offen lds
    buffer_load_dwordx4 v250, s[52:55], s38 offen offset:1024 lds
    buffer_load_dwordx4 v[176:179], v245, s[56:59], s38 offen offset:1024 sc1
    v_exp_f32 v69, v69
    v_exp_f32 v70, v70
    v_exp_f32 v71, v71
    v_exp_f32 v72, v72
    v_exp_f32 v73, v73
    v_smfmac_f32_32x32x32_bf16 v[0:15], v[124:127], v[64:71], v244
    s_waitcnt lgkmcnt(0)
    v_exp_f32 v74, v74
    v_exp_f32 v75, v75
    v_exp_f32 v76, v76
    v_mfma_f32_32x32x16_bf16 v[180:195], v[148:151], v[156:159], 0
    v_exp_f32 v77, v77
    v_exp_f32 v78, v78
    v_exp_f32 v79, v79
    v_exp_f32 v80, v80
    v_exp_f32 v81, v81
    v_smfmac_f32_32x32x32_bf16 v[0:15], v[128:131], v[72:79], v244
    v_exp_f32 v82, v82
    v_exp_f32 v83, v83
    v_exp_f32 v84, v84
    v_mfma_f32_32x32x16_bf16 v[64:79], v[112:115], v[104:107], 0
    v_exp_f32 v85, v85
    v_exp_f32 v86, v86
    v_exp_f32 v87, v87
    v_exp_f32 v88, v88
    v_exp_f32 v89, v89
    v_smfmac_f32_32x32x32_bf16 v[16:31], v[124:127], v[80:87], v244
    v_exp_f32 v90, v90
    v_exp_f32 v91, v91
    v_exp_f32 v92, v92
    v_mfma_f32_32x32x16_bf16 v[196:211], v[152:155], v[156:159], 0
    v_exp_f32 v93, v93
    v_exp_f32 v94, v94
    v_exp_f32 v95, v95
    v_exp_f32 v64, v64
    v_exp_f32 v65, v65
    v_smfmac_f32_32x32x32_bf16 v[16:31], v[128:131], v[88:95], v244
    v_exp_f32 v66, v66
    v_exp_f32 v67, v67
    v_exp_f32 v68, v68
    v_mfma_f32_32x32x16_bf16 v[80:95], v[112:115], v[108:111], 0
    v_exp_f32 v69, v69
    v_exp_f32 v70, v70
    v_exp_f32 v71, v71
    v_exp_f32 v72, v72
    v_exp_f32 v73, v73
    v_smfmac_f32_32x32x32_bf16 v[32:47], v[124:127], v[64:71], v244
    v_exp_f32 v74, v74
    v_exp_f32 v75, v75
    v_exp_f32 v76, v76
    v_mfma_f32_32x32x16_bf16 v[212:227], v[148:151], v[160:163], 0
    v_exp_f32 v77, v77
    v_exp_f32 v78, v78
    v_exp_f32 v79, v79
    v_exp_f32 v80, v80
    v_exp_f32 v81, v81
    v_smfmac_f32_32x32x32_bf16 v[32:47], v[128:131], v[72:79], v244
    v_exp_f32 v82, v82
    v_exp_f32 v83, v83
    v_exp_f32 v84, v84
    s_waitcnt vmcnt(7)
    v_mfma_f32_32x32x16_bf16 v[64:79], v[116:119], v[96:99], 0
    buffer_load_dwordx4 v[112:115], v245, s[44:47], s33 offen offset:2048 sc1
    v_exp_f32 v85, v85
    v_exp_f32 v86, v86
    v_exp_f32 v87, v87
    v_exp_f32 v88, v88
    v_exp_f32 v89, v89
    v_smfmac_f32_32x32x32_bf16 v[48:63], v[124:127], v[80:87], v244
    v_exp_f32 v90, v90
    v_exp_f32 v91, v91
    v_exp_f32 v92, v92
    v_mfma_f32_32x32x16_bf16 v[228:243], v[152:155], v[160:163], 0
    ds_read_b64_tr_b16 v[148:149], v251 offset:2048
    ds_read_b64_tr_b16 v[150:151], v251 offset:2560
    ds_read_b64_tr_b16 v[152:153], v252 offset:2048
    ds_read_b64_tr_b16 v[154:155], v252 offset:2560
    v_exp_f32 v93, v93
    v_exp_f32 v94, v94
    v_exp_f32 v95, v95
    v_exp_f32 v64, v64
    v_exp_f32 v65, v65
    v_smfmac_f32_32x32x32_bf16 v[48:63], v[128:131], v[88:95], v244
    s_mov_b64 exec, s[96:97]
    buffer_load_dwordx4 v[124:127], v246, s[48:51], s33 offen offset:2048 sc1
    buffer_load_dwordx4 v[128:131], v246, s[48:51], s33 offen offset:2560 sc1
    s_mov_b64 exec, -1
    v_exp_f32 v66, v66
    v_exp_f32 v67, v67
    v_exp_f32 v68, v68
    v_mfma_f32_32x32x16_bf16 v[80:95], v[116:119], v[100:103], 0
    s_xor_b32 s38, s90, 196608
    s_add_u32 m0, s37, 0
    buffer_load_dwordx4 v[156:159], v245, s[56:59], s38 offen sc1
    buffer_load_dwordx4 v249, s[52:55], s38 offen lds
    buffer_load_dwordx4 v250, s[52:55], s38 offen offset:1024 lds
    buffer_load_dwordx4 v[160:163], v245, s[56:59], s38 offen offset:1024 sc1
    v_exp_f32 v69, v69
    v_exp_f32 v70, v70
    v_exp_f32 v71, v71
    v_exp_f32 v72, v72
    v_exp_f32 v73, v73
    v_smfmac_f32_32x32x32_bf16 v[0:15], v[132:135], v[64:71], v244
    s_waitcnt lgkmcnt(0)
    v_exp_f32 v74, v74
    v_exp_f32 v75, v75
    v_exp_f32 v76, v76
    v_mfma_f32_32x32x16_bf16 v[180:195], v[148:151], v[164:167], v[180:195]
    v_exp_f32 v77, v77
    v_exp_f32 v78, v78
    v_exp_f32 v79, v79
    v_exp_f32 v80, v80
    v_exp_f32 v81, v81
    v_smfmac_f32_32x32x32_bf16 v[0:15], v[136:139], v[72:79], v244
    v_exp_f32 v82, v82
    v_exp_f32 v83, v83
    v_exp_f32 v84, v84
    v_mfma_f32_32x32x16_bf16 v[64:79], v[116:119], v[104:107], 0
    v_exp_f32 v85, v85
    v_exp_f32 v86, v86
    v_exp_f32 v87, v87
    v_exp_f32 v88, v88
    v_exp_f32 v89, v89
    v_smfmac_f32_32x32x32_bf16 v[16:31], v[132:135], v[80:87], v244
    v_exp_f32 v90, v90
    v_exp_f32 v91, v91
    v_exp_f32 v92, v92
    v_mfma_f32_32x32x16_bf16 v[196:211], v[152:155], v[164:167], v[196:211]
    v_exp_f32 v93, v93
    v_exp_f32 v94, v94
    v_exp_f32 v95, v95
    v_exp_f32 v64, v64
    v_exp_f32 v65, v65
    v_smfmac_f32_32x32x32_bf16 v[16:31], v[136:139], v[88:95], v244
    v_exp_f32 v66, v66
    v_exp_f32 v67, v67
    v_exp_f32 v68, v68
    v_mfma_f32_32x32x16_bf16 v[80:95], v[116:119], v[108:111], 0
    v_exp_f32 v69, v69
    v_exp_f32 v70, v70
    v_exp_f32 v71, v71
    v_exp_f32 v72, v72
    v_exp_f32 v73, v73
    v_smfmac_f32_32x32x32_bf16 v[32:47], v[132:135], v[64:71], v244
    v_exp_f32 v74, v74
    v_exp_f32 v75, v75
    v_exp_f32 v76, v76
    v_mfma_f32_32x32x16_bf16 v[212:227], v[148:151], v[168:171], v[212:227]
    v_exp_f32 v77, v77
    v_exp_f32 v78, v78
    v_exp_f32 v79, v79
    v_exp_f32 v80, v80
    v_exp_f32 v81, v81
    v_smfmac_f32_32x32x32_bf16 v[32:47], v[136:139], v[72:79], v244
    v_exp_f32 v82, v82
    v_exp_f32 v83, v83
    v_exp_f32 v84, v84
    s_waitcnt vmcnt(7)
    v_mfma_f32_32x32x16_bf16 v[64:79], v[120:123], v[96:99], 0
    buffer_load_dwordx4 v[116:119], v245, s[44:47], s33 offen offset:3072 sc1
    v_exp_f32 v85, v85
    v_exp_f32 v86, v86
    v_exp_f32 v87, v87
    v_exp_f32 v88, v88
    v_exp_f32 v89, v89
    v_smfmac_f32_32x32x32_bf16 v[48:63], v[132:135], v[80:87], v244
    v_exp_f32 v90, v90
    v_exp_f32 v91, v91
    v_exp_f32 v92, v92
    v_mfma_f32_32x32x16_bf16 v[228:243], v[152:155], v[168:171], v[228:243]
    ds_read_b64_tr_b16 v[148:149], v251 offset:4096
    ds_read_b64_tr_b16 v[150:151], v251 offset:4608
    ds_read_b64_tr_b16 v[152:153], v252 offset:4096
    ds_read_b64_tr_b16 v[154:155], v252 offset:4608
    v_exp_f32 v93, v93
    v_exp_f32 v94, v94
    v_exp_f32 v95, v95
    v_exp_f32 v64, v64
    v_exp_f32 v65, v65
    v_smfmac_f32_32x32x32_bf16 v[48:63], v[136:139], v[88:95], v244
    s_mov_b64 exec, s[96:97]
    buffer_load_dwordx4 v[132:135], v246, s[48:51], s33 offen offset:3072 sc1
    buffer_load_dwordx4 v[136:139], v246, s[48:51], s33 offen offset:3584 sc1
    s_mov_b64 exec, -1
    v_exp_f32 v66, v66
    v_exp_f32 v67, v67
    v_exp_f32 v68, v68
    v_mfma_f32_32x32x16_bf16 v[80:95], v[120:123], v[100:103], 0
    s_xor_b32 s38, s90, 262144
    s_add_u32 m0, s37, 2048
    buffer_load_dwordx4 v[164:167], v245, s[56:59], s38 offen sc1
    buffer_load_dwordx4 v249, s[52:55], s38 offen lds
    buffer_load_dwordx4 v250, s[52:55], s38 offen offset:1024 lds
    buffer_load_dwordx4 v[168:171], v245, s[56:59], s38 offen offset:1024 sc1
    v_exp_f32 v69, v69
    v_exp_f32 v70, v70
    v_exp_f32 v71, v71
    v_exp_f32 v72, v72
    v_exp_f32 v73, v73
    v_smfmac_f32_32x32x32_bf16 v[0:15], v[140:143], v[64:71], v244
    s_waitcnt lgkmcnt(0)
    v_exp_f32 v74, v74
    v_exp_f32 v75, v75
    v_exp_f32 v76, v76
    v_mfma_f32_32x32x16_bf16 v[180:195], v[148:151], v[172:175], v[180:195]
    v_exp_f32 v77, v77
    v_exp_f32 v78, v78
    v_exp_f32 v79, v79
    v_exp_f32 v80, v80
    v_exp_f32 v81, v81
    v_smfmac_f32_32x32x32_bf16 v[0:15], v[144:147], v[72:79], v244
    v_exp_f32 v82, v82
    v_exp_f32 v83, v83
    v_exp_f32 v84, v84
    v_mfma_f32_32x32x16_bf16 v[64:79], v[120:123], v[104:107], 0
    v_exp_f32 v85, v85
    v_exp_f32 v86, v86
    v_exp_f32 v87, v87
    v_exp_f32 v88, v88
    v_exp_f32 v89, v89
    v_smfmac_f32_32x32x32_bf16 v[16:31], v[140:143], v[80:87], v244
    v_exp_f32 v90, v90
    v_exp_f32 v91, v91
    v_exp_f32 v92, v92
    v_mfma_f32_32x32x16_bf16 v[196:211], v[152:155], v[172:175], v[196:211]
    v_exp_f32 v93, v93
    v_exp_f32 v94, v94
    v_exp_f32 v95, v95
    v_exp_f32 v64, v64
    v_exp_f32 v65, v65
    v_smfmac_f32_32x32x32_bf16 v[16:31], v[144:147], v[88:95], v244
    v_exp_f32 v66, v66
    v_exp_f32 v67, v67
    v_exp_f32 v68, v68
    v_mfma_f32_32x32x16_bf16 v[80:95], v[120:123], v[108:111], 0
    v_exp_f32 v69, v69
    v_exp_f32 v70, v70
    v_exp_f32 v71, v71
    v_exp_f32 v72, v72
    v_exp_f32 v73, v73
    v_smfmac_f32_32x32x32_bf16 v[32:47], v[140:143], v[64:71], v244
    v_exp_f32 v74, v74
    v_exp_f32 v75, v75
    v_exp_f32 v76, v76
    v_mfma_f32_32x32x16_bf16 v[212:227], v[148:151], v[176:179], v[212:227]
    v_exp_f32 v77, v77
    v_exp_f32 v78, v78
    v_exp_f32 v79, v79
    v_exp_f32 v80, v80
    v_exp_f32 v81, v81
    v_smfmac_f32_32x32x32_bf16 v[32:47], v[144:147], v[72:79], v244
    v_exp_f32 v82, v82
    v_exp_f32 v83, v83
    v_exp_f32 v84, v84
    s_waitcnt vmcnt(7)
    v_mfma_f32_32x32x16_bf16 v[64:79], v[112:115], v[96:99], 0
    s_add_u32 s33, s33, 4096
    buffer_load_dwordx4 v[120:123], v245, s[44:47], s33 offen offset:0 sc1
    v_exp_f32 v85, v85
    v_exp_f32 v86, v86
    v_exp_f32 v87, v87
    v_exp_f32 v88, v88
    v_exp_f32 v89, v89
    v_smfmac_f32_32x32x32_bf16 v[48:63], v[140:143], v[80:87], v244
    v_exp_f32 v90, v90
    v_exp_f32 v91, v91
    v_exp_f32 v92, v92
    v_mfma_f32_32x32x16_bf16 v[228:243], v[152:155], v[176:179], v[228:243]
    ds_read_b64_tr_b16 v[148:149], v251 offset:0
    ds_read_b64_tr_b16 v[150:151], v251 offset:512
    ds_read_b64_tr_b16 v[152:153], v252 offset:0
    ds_read_b64_tr_b16 v[154:155], v252 offset:512
    v_exp_f32 v93, v93
    v_exp_f32 v94, v94
    v_exp_f32 v95, v95
    v_exp_f32 v64, v64
    v_exp_f32 v65, v65
    v_smfmac_f32_32x32x32_bf16 v[48:63], v[144:147], v[88:95], v244
    s_mov_b64 exec, s[96:97]
    buffer_load_dwordx4 v[140:143], v246, s[48:51], s33 offen offset:0 sc1
    buffer_load_dwordx4 v[144:147], v246, s[48:51], s33 offen offset:512 sc1
    s_mov_b64 exec, -1
    v_exp_f32 v66, v66
    v_exp_f32 v67, v67
    v_exp_f32 v68, v68
    v_mfma_f32_32x32x16_bf16 v[80:95], v[112:115], v[100:103], 0
    s_xor_b32 s38, s90, 327680
    s_add_u32 m0, s37, 4096
    buffer_load_dwordx4 v[172:175], v245, s[56:59], s38 offen sc1
    buffer_load_dwordx4 v249, s[52:55], s38 offen lds
    buffer_load_dwordx4 v250, s[52:55], s38 offen offset:1024 lds
    buffer_load_dwordx4 v[176:179], v245, s[56:59], s38 offen offset:1024 sc1
    v_exp_f32 v69, v69
    v_exp_f32 v70, v70
    v_exp_f32 v71, v71
    v_exp_f32 v72, v72
    v_exp_f32 v73, v73
    v_smfmac_f32_32x32x32_bf16 v[0:15], v[124:127], v[64:71], v244
    s_waitcnt lgkmcnt(0)
    v_exp_f32 v74, v74
    v_exp_f32 v75, v75
    v_exp_f32 v76, v76
    v_mfma_f32_32x32x16_bf16 v[180:195], v[148:151], v[156:159], v[180:195]
    v_exp_f32 v77, v77
    v_exp_f32 v78, v78
    v_exp_f32 v79, v79
    v_exp_f32 v80, v80
    v_exp_f32 v81, v81
    v_smfmac_f32_32x32x32_bf16 v[0:15], v[128:131], v[72:79], v244
    v_exp_f32 v82, v82
    v_exp_f32 v83, v83
    v_exp_f32 v84, v84
    v_mfma_f32_32x32x16_bf16 v[64:79], v[112:115], v[104:107], 0
    v_exp_f32 v85, v85
    v_exp_f32 v86, v86
    v_exp_f32 v87, v87
    v_exp_f32 v88, v88
    v_exp_f32 v89, v89
    v_smfmac_f32_32x32x32_bf16 v[16:31], v[124:127], v[80:87], v244
    v_exp_f32 v90, v90
    v_exp_f32 v91, v91
    v_exp_f32 v92, v92
    v_mfma_f32_32x32x16_bf16 v[196:211], v[152:155], v[156:159], v[196:211]
    v_exp_f32 v93, v93
    v_exp_f32 v94, v94
    v_exp_f32 v95, v95
    v_exp_f32 v64, v64
    v_exp_f32 v65, v65
    v_smfmac_f32_32x32x32_bf16 v[16:31], v[128:131], v[88:95], v244
    v_exp_f32 v66, v66
    v_exp_f32 v67, v67
    v_exp_f32 v68, v68
    v_mfma_f32_32x32x16_bf16 v[80:95], v[112:115], v[108:111], 0
    v_exp_f32 v69, v69
    v_exp_f32 v70, v70
    v_exp_f32 v71, v71
    v_exp_f32 v72, v72
    v_exp_f32 v73, v73
    v_smfmac_f32_32x32x32_bf16 v[32:47], v[124:127], v[64:71], v244
    v_exp_f32 v74, v74
    v_exp_f32 v75, v75
    v_exp_f32 v76, v76
    v_mfma_f32_32x32x16_bf16 v[212:227], v[148:151], v[160:163], v[212:227]
    v_exp_f32 v77, v77
    v_exp_f32 v78, v78
    v_exp_f32 v79, v79
    v_exp_f32 v80, v80
    v_exp_f32 v81, v81
    v_smfmac_f32_32x32x32_bf16 v[32:47], v[128:131], v[72:79], v244
    v_exp_f32 v82, v82
    v_exp_f32 v83, v83
    v_exp_f32 v84, v84
    s_waitcnt vmcnt(7)
    v_mfma_f32_32x32x16_bf16 v[64:79], v[116:119], v[96:99], 0
    buffer_load_dwordx4 v[112:115], v245, s[44:47], s33 offen offset:1024 sc1
    v_exp_f32 v85, v85
    v_exp_f32 v86, v86
    v_exp_f32 v87, v87
    v_exp_f32 v88, v88
    v_exp_f32 v89, v89
    v_smfmac_f32_32x32x32_bf16 v[48:63], v[124:127], v[80:87], v244
    v_exp_f32 v90, v90
    v_exp_f32 v91, v91
    v_exp_f32 v92, v92
    v_mfma_f32_32x32x16_bf16 v[228:243], v[152:155], v[160:163], v[228:243]
    ds_read_b64_tr_b16 v[148:149], v251 offset:2048
    ds_read_b64_tr_b16 v[150:151], v251 offset:2560
    ds_read_b64_tr_b16 v[152:153], v252 offset:2048
    ds_read_b64_tr_b16 v[154:155], v252 offset:2560
    v_exp_f32 v93, v93
    v_exp_f32 v94, v94
    v_exp_f32 v95, v95
    v_exp_f32 v64, v64
    v_exp_f32 v65, v65
    v_smfmac_f32_32x32x32_bf16 v[48:63], v[128:131], v[88:95], v244
    s_mov_b64 exec, s[96:97]
    buffer_load_dwordx4 v[124:127], v246, s[48:51], s33 offen offset:1024 sc1
    buffer_load_dwordx4 v[128:131], v246, s[48:51], s33 offen offset:1536 sc1
    s_mov_b64 exec, -1
    v_exp_f32 v66, v66
    v_exp_f32 v67, v67
    v_exp_f32 v68, v68
    v_mfma_f32_32x32x16_bf16 v[80:95], v[116:119], v[100:103], 0
    s_xor_b32 s38, s90, 393216
    s_add_u32 m0, s37, 0
    buffer_load_dwordx4 v[156:159], v245, s[56:59], s38 offen sc1
    buffer_load_dwordx4 v249, s[52:55], s38 offen lds
    buffer_load_dwordx4 v250, s[52:55], s38 offen offset:1024 lds
    buffer_load_dwordx4 v[160:163], v245, s[56:59], s38 offen offset:1024 sc1
    v_exp_f32 v69, v69
    v_exp_f32 v70, v70
    v_exp_f32 v71, v71
    v_exp_f32 v72, v72
    v_exp_f32 v73, v73
    v_smfmac_f32_32x32x32_bf16 v[0:15], v[132:135], v[64:71], v244
    s_waitcnt lgkmcnt(0)
    v_exp_f32 v74, v74
    v_exp_f32 v75, v75
    v_exp_f32 v76, v76
    v_mfma_f32_32x32x16_bf16 v[180:195], v[148:151], v[164:167], v[180:195]
    v_exp_f32 v77, v77
    v_exp_f32 v78, v78
    v_exp_f32 v79, v79
    v_exp_f32 v80, v80
    v_exp_f32 v81, v81
    v_smfmac_f32_32x32x32_bf16 v[0:15], v[136:139], v[72:79], v244
    v_exp_f32 v82, v82
    v_exp_f32 v83, v83
    v_exp_f32 v84, v84
    v_mfma_f32_32x32x16_bf16 v[64:79], v[116:119], v[104:107], 0
    v_exp_f32 v85, v85
    v_exp_f32 v86, v86
    v_exp_f32 v87, v87
    v_exp_f32 v88, v88
    v_exp_f32 v89, v89
    v_smfmac_f32_32x32x32_bf16 v[16:31], v[132:135], v[80:87], v244
    v_exp_f32 v90, v90
    v_exp_f32 v91, v91
    v_exp_f32 v92, v92
    v_mfma_f32_32x32x16_bf16 v[196:211], v[152:155], v[164:167], v[196:211]
    v_exp_f32 v93, v93
    v_exp_f32 v94, v94
    v_exp_f32 v95, v95
    v_exp_f32 v64, v64
    v_exp_f32 v65, v65
    v_smfmac_f32_32x32x32_bf16 v[16:31], v[136:139], v[88:95], v244
    v_exp_f32 v66, v66
    v_exp_f32 v67, v67
    v_exp_f32 v68, v68
    v_mfma_f32_32x32x16_bf16 v[80:95], v[116:119], v[108:111], 0
    v_exp_f32 v69, v69
    v_exp_f32 v70, v70
    v_exp_f32 v71, v71
    v_exp_f32 v72, v72
    v_exp_f32 v73, v73
    v_smfmac_f32_32x32x32_bf16 v[32:47], v[132:135], v[64:71], v244
    v_exp_f32 v74, v74
    v_exp_f32 v75, v75
    v_exp_f32 v76, v76
    v_mfma_f32_32x32x16_bf16 v[212:227], v[148:151], v[168:171], v[212:227]
    v_exp_f32 v77, v77
    v_exp_f32 v78, v78
    v_exp_f32 v79, v79
    v_exp_f32 v80, v80
    v_exp_f32 v81, v81
    v_smfmac_f32_32x32x32_bf16 v[32:47], v[136:139], v[72:79], v244
    v_exp_f32 v82, v82
    v_exp_f32 v83, v83
    v_exp_f32 v84, v84
    s_waitcnt vmcnt(7)
    v_mfma_f32_32x32x16_bf16 v[64:79], v[120:123], v[96:99], 0
    buffer_load_dwordx4 v[116:119], v245, s[44:47], s33 offen offset:2048 sc1
    v_exp_f32 v85, v85
    v_exp_f32 v86, v86
    v_exp_f32 v87, v87
    v_exp_f32 v88, v88
    v_exp_f32 v89, v89
    v_smfmac_f32_32x32x32_bf16 v[48:63], v[132:135], v[80:87], v244
    v_exp_f32 v90, v90
    v_exp_f32 v91, v91
    v_exp_f32 v92, v92
    v_mfma_f32_32x32x16_bf16 v[228:243], v[152:155], v[168:171], v[228:243]
    ds_read_b64_tr_b16 v[148:149], v251 offset:4096
    ds_read_b64_tr_b16 v[150:151], v251 offset:4608
    ds_read_b64_tr_b16 v[152:153], v252 offset:4096
    ds_read_b64_tr_b16 v[154:155], v252 offset:4608
    v_exp_f32 v93, v93
    v_exp_f32 v94, v94
    v_exp_f32 v95, v95
    v_exp_f32 v64, v64
    v_exp_f32 v65, v65
    v_smfmac_f32_32x32x32_bf16 v[48:63], v[136:139], v[88:95], v244
    s_mov_b64 exec, s[96:97]
    buffer_load_dwordx4 v[132:135], v246, s[48:51], s33 offen offset:2048 sc1
    buffer_load_dwordx4 v[136:139], v246, s[48:51], s33 offen offset:2560 sc1
    s_mov_b64 exec, -1
    v_exp_f32 v66, v66
    v_exp_f32 v67, v67
    v_exp_f32 v68, v68
    v_mfma_f32_32x32x16_bf16 v[80:95], v[120:123], v[100:103], 0
    s_xor_b32 s38, s90, 458752
    s_add_u32 m0, s37, 2048
    buffer_load_dwordx4 v[164:167], v245, s[56:59], s38 offen sc1
    buffer_load_dwordx4 v249, s[52:55], s38 offen lds
    buffer_load_dwordx4 v250, s[52:55], s38 offen offset:1024 lds
    buffer_load_dwordx4 v[168:171], v245, s[56:59], s38 offen offset:1024 sc1
    v_exp_f32 v69, v69
    v_exp_f32 v70, v70
    v_exp_f32 v71, v71
    v_exp_f32 v72, v72
    v_exp_f32 v73, v73
    v_smfmac_f32_32x32x32_bf16 v[0:15], v[140:143], v[64:71], v244
    s_waitcnt lgkmcnt(0)
    v_exp_f32 v74, v74
    v_exp_f32 v75, v75
    v_exp_f32 v76, v76
    v_mfma_f32_32x32x16_bf16 v[180:195], v[148:151], v[172:175], v[180:195]
    v_exp_f32 v77, v77
    v_exp_f32 v78, v78
    v_exp_f32 v79, v79
    v_exp_f32 v80, v80
    v_exp_f32 v81, v81
    v_smfmac_f32_32x32x32_bf16 v[0:15], v[144:147], v[72:79], v244
    v_exp_f32 v82, v82
    v_exp_f32 v83, v83
    v_exp_f32 v84, v84
    v_mfma_f32_32x32x16_bf16 v[64:79], v[120:123], v[104:107], 0
    v_exp_f32 v85, v85
    v_exp_f32 v86, v86
    v_exp_f32 v87, v87
    v_exp_f32 v88, v88
    v_exp_f32 v89, v89
    v_smfmac_f32_32x32x32_bf16 v[16:31], v[140:143], v[80:87], v244
    v_exp_f32 v90, v90
    v_exp_f32 v91, v91
    v_exp_f32 v92, v92
    v_mfma_f32_32x32x16_bf16 v[196:211], v[152:155], v[172:175], v[196:211]
    v_exp_f32 v93, v93
    v_exp_f32 v94, v94
    v_exp_f32 v95, v95
    v_exp_f32 v64, v64
    v_exp_f32 v65, v65
    v_smfmac_f32_32x32x32_bf16 v[16:31], v[144:147], v[88:95], v244
    v_exp_f32 v66, v66
    v_exp_f32 v67, v67
    v_exp_f32 v68, v68
    v_mfma_f32_32x32x16_bf16 v[80:95], v[120:123], v[108:111], 0
    v_exp_f32 v69, v69
    v_exp_f32 v70, v70
    v_exp_f32 v71, v71
    v_exp_f32 v72, v72
    v_exp_f32 v73, v73
    v_smfmac_f32_32x32x32_bf16 v[32:47], v[140:143], v[64:71], v244
    v_exp_f32 v74, v74
    v_exp_f32 v75, v75
    v_exp_f32 v76, v76
    v_mfma_f32_32x32x16_bf16 v[212:227], v[148:151], v[176:179], v[212:227]
    v_exp_f32 v77, v77
    v_exp_f32 v78, v78
    v_exp_f32 v79, v79
    v_exp_f32 v80, v80
    v_exp_f32 v81, v81
    v_smfmac_f32_32x32x32_bf16 v[32:47], v[144:147], v[72:79], v244
    v_exp_f32 v82, v82
    v_exp_f32 v83, v83
    v_exp_f32 v84, v84
    s_waitcnt vmcnt(7)
    v_mfma_f32_32x32x16_bf16 v[64:79], v[112:115], v[96:99], 0
    buffer_load_dwordx4 v[120:123], v245, s[44:47], s33 offen offset:3072 sc1
    v_exp_f32 v85, v85
    v_exp_f32 v86, v86
    v_exp_f32 v87, v87
    v_exp_f32 v88, v88
    v_exp_f32 v89, v89
    v_smfmac_f32_32x32x32_bf16 v[48:63], v[140:143], v[80:87], v244
    v_exp_f32 v90, v90
    v_exp_f32 v91, v91
    v_exp_f32 v92, v92
    v_mfma_f32_32x32x16_bf16 v[228:243], v[152:155], v[176:179], v[228:243]
    ds_read_b64_tr_b16 v[148:149], v251 offset:0
    ds_read_b64_tr_b16 v[150:151], v251 offset:512
    ds_read_b64_tr_b16 v[152:153], v252 offset:0
    ds_read_b64_tr_b16 v[154:155], v252 offset:512
    v_exp_f32 v93, v93
    v_exp_f32 v94, v94
    v_exp_f32 v95, v95
    v_exp_f32 v64, v64
    v_exp_f32 v65, v65
    v_smfmac_f32_32x32x32_bf16 v[48:63], v[144:147], v[88:95], v244
    s_mov_b64 exec, s[96:97]
    buffer_load_dwordx4 v[140:143], v246, s[48:51], s33 offen offset:3072 sc1
    buffer_load_dwordx4 v[144:147], v246, s[48:51], s33 offen offset:3584 sc1
    s_mov_b64 exec, -1
    v_exp_f32 v66, v66
    v_exp_f32 v67, v67
    v_exp_f32 v68, v68
    v_mfma_f32_32x32x16_bf16 v[80:95], v[112:115], v[100:103], 0
    s_xor_b32 s38, s90, 524288
    s_add_u32 m0, s37, 4096
    buffer_load_dwordx4 v[172:175], v245, s[56:59], s38 offen sc1
    buffer_load_dwordx4 v249, s[52:55], s38 offen lds
    buffer_load_dwordx4 v250, s[52:55], s38 offen offset:1024 lds
    buffer_load_dwordx4 v[176:179], v245, s[56:59], s38 offen offset:1024 sc1
    v_exp_f32 v69, v69
    v_exp_f32 v70, v70
    v_exp_f32 v71, v71
    v_exp_f32 v72, v72
    v_exp_f32 v73, v73
    v_smfmac_f32_32x32x32_bf16 v[0:15], v[124:127], v[64:71], v244
    s_waitcnt lgkmcnt(0)
    v_exp_f32 v74, v74
    v_exp_f32 v75, v75
    v_exp_f32 v76, v76
    v_mfma_f32_32x32x16_bf16 v[180:195], v[148:151], v[156:159], v[180:195]
    v_exp_f32 v77, v77
    v_exp_f32 v78, v78
    v_exp_f32 v79, v79
    v_exp_f32 v80, v80
    v_exp_f32 v81, v81
    v_smfmac_f32_32x32x32_bf16 v[0:15], v[128:131], v[72:79], v244
    v_exp_f32 v82, v82
    v_exp_f32 v83, v83
    v_exp_f32 v84, v84
    v_mfma_f32_32x32x16_bf16 v[64:79], v[112:115], v[104:107], 0
    v_exp_f32 v85, v85
    v_exp_f32 v86, v86
    v_exp_f32 v87, v87
    v_exp_f32 v88, v88
    v_exp_f32 v89, v89
    v_smfmac_f32_32x32x32_bf16 v[16:31], v[124:127], v[80:87], v244
    v_exp_f32 v90, v90
    v_exp_f32 v91, v91
    v_exp_f32 v92, v92
    v_mfma_f32_32x32x16_bf16 v[196:211], v[152:155], v[156:159], v[196:211]
    v_exp_f32 v93, v93
    v_exp_f32 v94, v94
    v_exp_f32 v95, v95
    v_exp_f32 v64, v64
    v_exp_f32 v65, v65
    v_smfmac_f32_32x32x32_bf16 v[16:31], v[128:131], v[88:95], v244
    v_exp_f32 v66, v66
    v_exp_f32 v67, v67
    v_exp_f32 v68, v68
    v_mfma_f32_32x32x16_bf16 v[80:95], v[112:115], v[108:111], 0
    v_exp_f32 v69, v69
    v_exp_f32 v70, v70
    v_exp_f32 v71, v71
    v_exp_f32 v72, v72
    v_exp_f32 v73, v73
    v_smfmac_f32_32x32x32_bf16 v[32:47], v[124:127], v[64:71], v244
    v_exp_f32 v74, v74
    v_exp_f32 v75, v75
    v_exp_f32 v76, v76
    v_mfma_f32_32x32x16_bf16 v[212:227], v[148:151], v[160:163], v[212:227]
    v_exp_f32 v77, v77
    v_exp_f32 v78, v78
    v_exp_f32 v79, v79
    v_exp_f32 v80, v80
    v_exp_f32 v81, v81
    v_smfmac_f32_32x32x32_bf16 v[32:47], v[128:131], v[72:79], v244
    v_exp_f32 v82, v82
    v_exp_f32 v83, v83
    v_exp_f32 v84, v84
    s_waitcnt vmcnt(7)
    v_mfma_f32_32x32x16_bf16 v[64:79], v[116:119], v[96:99], 0
    s_add_u32 s33, s33, 4096
    buffer_load_dwordx4 v[112:115], v245, s[44:47], s33 offen offset:0 sc1
    v_exp_f32 v85, v85
    v_exp_f32 v86, v86
    v_exp_f32 v87, v87
    v_exp_f32 v88, v88
    v_exp_f32 v89, v89
    v_smfmac_f32_32x32x32_bf16 v[48:63], v[124:127], v[80:87], v244
    v_exp_f32 v90, v90
    v_exp_f32 v91, v91
    v_exp_f32 v92, v92
    v_mfma_f32_32x32x16_bf16 v[228:243], v[152:155], v[160:163], v[228:243]
    ds_read_b64_tr_b16 v[148:149], v251 offset:2048
    ds_read_b64_tr_b16 v[150:151], v251 offset:2560
    ds_read_b64_tr_b16 v[152:153], v252 offset:2048
    ds_read_b64_tr_b16 v[154:155], v252 offset:2560
    v_exp_f32 v93, v93
    v_exp_f32 v94, v94
    v_exp_f32 v95, v95
    v_exp_f32 v64, v64
    v_exp_f32 v65, v65
    v_smfmac_f32_32x32x32_bf16 v[48:63], v[128:131], v[88:95], v244
    s_mov_b64 exec, s[96:97]
    buffer_load_dwordx4 v[124:127], v246, s[48:51], s33 offen offset:0 sc1
    buffer_load_dwordx4 v[128:131], v246, s[48:51], s33 offen offset:512 sc1
    s_mov_b64 exec, -1
    v_exp_f32 v66, v66
    v_exp_f32 v67, v67
    v_exp_f32 v68, v68
    v_mfma_f32_32x32x16_bf16 v[80:95], v[116:119], v[100:103], 0
    s_xor_b32 s38, s90, 589824
    s_add_u32 m0, s37, 0
    buffer_load_dwordx4 v[156:159], v245, s[56:59], s38 offen sc1
    buffer_load_dwordx4 v249, s[52:55], s38 offen lds
    buffer_load_dwordx4 v250, s[52:55], s38 offen offset:1024 lds
    buffer_load_dwordx4 v[160:163], v245, s[56:59], s38 offen offset:1024 sc1
    v_exp_f32 v69, v69
    v_exp_f32 v70, v70
    v_exp_f32 v71, v71
    v_exp_f32 v72, v72
    v_exp_f32 v73, v73
    v_smfmac_f32_32x32x32_bf16 v[0:15], v[132:135], v[64:71], v244
    s_waitcnt lgkmcnt(0)
    v_exp_f32 v74, v74
    v_exp_f32 v75, v75
    v_exp_f32 v76, v76
    v_mfma_f32_32x32x16_bf16 v[180:195], v[148:151], v[164:167], v[180:195]
    v_exp_f32 v77, v77
    v_exp_f32 v78, v78
    v_exp_f32 v79, v79
    v_exp_f32 v80, v80
    v_exp_f32 v81, v81
    v_smfmac_f32_32x32x32_bf16 v[0:15], v[136:139], v[72:79], v244
    v_exp_f32 v82, v82
    v_exp_f32 v83, v83
    v_exp_f32 v84, v84
    v_mfma_f32_32x32x16_bf16 v[64:79], v[116:119], v[104:107], 0
    v_exp_f32 v85, v85
    v_exp_f32 v86, v86
    v_exp_f32 v87, v87
    v_exp_f32 v88, v88
    v_exp_f32 v89, v89
    v_smfmac_f32_32x32x32_bf16 v[16:31], v[132:135], v[80:87], v244
    v_exp_f32 v90, v90
    v_exp_f32 v91, v91
    v_exp_f32 v92, v92
    v_mfma_f32_32x32x16_bf16 v[196:211], v[152:155], v[164:167], v[196:211]
    v_exp_f32 v93, v93
    v_exp_f32 v94, v94
    v_exp_f32 v95, v95
    v_exp_f32 v64, v64
    v_exp_f32 v65, v65
    v_smfmac_f32_32x32x32_bf16 v[16:31], v[136:139], v[88:95], v244
    v_exp_f32 v66, v66
    v_exp_f32 v67, v67
    v_exp_f32 v68, v68
    v_mfma_f32_32x32x16_bf16 v[80:95], v[116:119], v[108:111], 0
    v_exp_f32 v69, v69
    v_exp_f32 v70, v70
    v_exp_f32 v71, v71
    v_exp_f32 v72, v72
    v_exp_f32 v73, v73
    v_smfmac_f32_32x32x32_bf16 v[32:47], v[132:135], v[64:71], v244
    v_exp_f32 v74, v74
    v_exp_f32 v75, v75
    v_exp_f32 v76, v76
    v_mfma_f32_32x32x16_bf16 v[212:227], v[148:151], v[168:171], v[212:227]
    v_exp_f32 v77, v77
    v_exp_f32 v78, v78
    v_exp_f32 v79, v79
    v_exp_f32 v80, v80
    v_exp_f32 v81, v81
    v_smfmac_f32_32x32x32_bf16 v[32:47], v[136:139], v[72:79], v244
    v_exp_f32 v82, v82
    v_exp_f32 v83, v83
    v_exp_f32 v84, v84
    s_waitcnt vmcnt(7)
    v_mfma_f32_32x32x16_bf16 v[64:79], v[120:123], v[96:99], 0
    buffer_load_dwordx4 v[116:119], v245, s[44:47], s33 offen offset:1024 sc1
    v_exp_f32 v85, v85
    v_exp_f32 v86, v86
    v_exp_f32 v87, v87
    v_exp_f32 v88, v88
    v_exp_f32 v89, v89
    v_smfmac_f32_32x32x32_bf16 v[48:63], v[132:135], v[80:87], v244
    v_exp_f32 v90, v90
    v_exp_f32 v91, v91
    v_exp_f32 v92, v92
    v_mfma_f32_32x32x16_bf16 v[228:243], v[152:155], v[168:171], v[228:243]
    ds_read_b64_tr_b16 v[148:149], v251 offset:4096
    ds_read_b64_tr_b16 v[150:151], v251 offset:4608
    ds_read_b64_tr_b16 v[152:153], v252 offset:4096
    ds_read_b64_tr_b16 v[154:155], v252 offset:4608
    v_exp_f32 v93, v93
    v_exp_f32 v94, v94
    v_exp_f32 v95, v95
    v_exp_f32 v64, v64
    v_exp_f32 v65, v65
    v_smfmac_f32_32x32x32_bf16 v[48:63], v[136:139], v[88:95], v244
    s_mov_b64 exec, s[96:97]
    buffer_load_dwordx4 v[132:135], v246, s[48:51], s33 offen offset:1024 sc1
    buffer_load_dwordx4 v[136:139], v246, s[48:51], s33 offen offset:1536 sc1
    s_mov_b64 exec, -1
    v_exp_f32 v66, v66
    v_exp_f32 v67, v67
    v_exp_f32 v68, v68
    v_mfma_f32_32x32x16_bf16 v[80:95], v[120:123], v[100:103], 0
    s_xor_b32 s38, s90, 655360
    s_add_u32 m0, s37, 2048
    buffer_load_dwordx4 v[164:167], v245, s[56:59], s38 offen sc1
    buffer_load_dwordx4 v249, s[52:55], s38 offen lds
    buffer_load_dwordx4 v250, s[52:55], s38 offen offset:1024 lds
    buffer_load_dwordx4 v[168:171], v245, s[56:59], s38 offen offset:1024 sc1
    v_exp_f32 v69, v69
    v_exp_f32 v70, v70
    v_exp_f32 v71, v71
    v_exp_f32 v72, v72
    v_exp_f32 v73, v73
    v_smfmac_f32_32x32x32_bf16 v[0:15], v[140:143], v[64:71], v244
    s_waitcnt lgkmcnt(0)
    v_exp_f32 v74, v74
    v_exp_f32 v75, v75
    v_exp_f32 v76, v76
    v_mfma_f32_32x32x16_bf16 v[180:195], v[148:151], v[172:175], v[180:195]
    v_exp_f32 v77, v77
    v_exp_f32 v78, v78
    v_exp_f32 v79, v79
    v_exp_f32 v80, v80
    v_exp_f32 v81, v81
    v_smfmac_f32_32x32x32_bf16 v[0:15], v[144:147], v[72:79], v244
    v_exp_f32 v82, v82
    v_exp_f32 v83, v83
    v_exp_f32 v84, v84
    v_mfma_f32_32x32x16_bf16 v[64:79], v[120:123], v[104:107], 0
    v_exp_f32 v85, v85
    v_exp_f32 v86, v86
    v_exp_f32 v87, v87
    v_exp_f32 v88, v88
    v_exp_f32 v89, v89
    v_smfmac_f32_32x32x32_bf16 v[16:31], v[140:143], v[80:87], v244
    v_exp_f32 v90, v90
    v_exp_f32 v91, v91
    v_exp_f32 v92, v92
    v_mfma_f32_32x32x16_bf16 v[196:211], v[152:155], v[172:175], v[196:211]
    v_exp_f32 v93, v93
    v_exp_f32 v94, v94
    v_exp_f32 v95, v95
    v_exp_f32 v64, v64
    v_exp_f32 v65, v65
    v_smfmac_f32_32x32x32_bf16 v[16:31], v[144:147], v[88:95], v244
    v_exp_f32 v66, v66
    v_exp_f32 v67, v67
    v_exp_f32 v68, v68
    v_mfma_f32_32x32x16_bf16 v[80:95], v[120:123], v[108:111], 0
    v_exp_f32 v69, v69
    v_exp_f32 v70, v70
    v_exp_f32 v71, v71
    v_exp_f32 v72, v72
    v_exp_f32 v73, v73
    v_smfmac_f32_32x32x32_bf16 v[32:47], v[140:143], v[64:71], v244
    v_exp_f32 v74, v74
    v_exp_f32 v75, v75
    v_exp_f32 v76, v76
    v_mfma_f32_32x32x16_bf16 v[212:227], v[148:151], v[176:179], v[212:227]
    v_exp_f32 v77, v77
    v_exp_f32 v78, v78
    v_exp_f32 v79, v79
    v_exp_f32 v80, v80
    v_exp_f32 v81, v81
    v_smfmac_f32_32x32x32_bf16 v[32:47], v[144:147], v[72:79], v244
    v_exp_f32 v82, v82
    v_exp_f32 v83, v83
    v_exp_f32 v84, v84
    s_waitcnt vmcnt(7)
    v_mfma_f32_32x32x16_bf16 v[64:79], v[112:115], v[96:99], 0
    buffer_load_dwordx4 v[120:123], v245, s[44:47], s33 offen offset:2048 sc1
    v_exp_f32 v85, v85
    v_exp_f32 v86, v86
    v_exp_f32 v87, v87
    v_exp_f32 v88, v88
    v_exp_f32 v89, v89
    v_smfmac_f32_32x32x32_bf16 v[48:63], v[140:143], v[80:87], v244
    v_exp_f32 v90, v90
    v_exp_f32 v91, v91
    v_exp_f32 v92, v92
    v_mfma_f32_32x32x16_bf16 v[228:243], v[152:155], v[176:179], v[228:243]
    ds_read_b64_tr_b16 v[148:149], v251 offset:0
    ds_read_b64_tr_b16 v[150:151], v251 offset:512
    ds_read_b64_tr_b16 v[152:153], v252 offset:0
    ds_read_b64_tr_b16 v[154:155], v252 offset:512
    v_exp_f32 v93, v93
    v_exp_f32 v94, v94
    v_exp_f32 v95, v95
    v_exp_f32 v64, v64
    v_exp_f32 v65, v65
    v_smfmac_f32_32x32x32_bf16 v[48:63], v[144:147], v[88:95], v244
    s_mov_b64 exec, s[96:97]
    buffer_load_dwordx4 v[140:143], v246, s[48:51], s33 offen offset:2048 sc1
    buffer_load_dwordx4 v[144:147], v246, s[48:51], s33 offen offset:2560 sc1
    s_mov_b64 exec, -1
    v_exp_f32 v66, v66
    v_exp_f32 v67, v67
    v_exp_f32 v68, v68
    v_mfma_f32_32x32x16_bf16 v[80:95], v[112:115], v[100:103], 0
    s_xor_b32 s38, s90, 720896
    s_add_u32 m0, s37, 4096
    buffer_load_dwordx4 v[172:175], v245, s[56:59], s38 offen sc1
    buffer_load_dwordx4 v249, s[52:55], s38 offen lds
    buffer_load_dwordx4 v250, s[52:55], s38 offen offset:1024 lds
    buffer_load_dwordx4 v[176:179], v245, s[56:59], s38 offen offset:1024 sc1
    v_exp_f32 v69, v69
    v_exp_f32 v70, v70
    v_exp_f32 v71, v71
    v_exp_f32 v72, v72
    v_exp_f32 v73, v73
    v_smfmac_f32_32x32x32_bf16 v[0:15], v[124:127], v[64:71], v244
    s_waitcnt lgkmcnt(0)
    v_exp_f32 v74, v74
    v_exp_f32 v75, v75
    v_exp_f32 v76, v76
    v_mfma_f32_32x32x16_bf16 v[180:195], v[148:151], v[156:159], v[180:195]
    v_exp_f32 v77, v77
    v_exp_f32 v78, v78
    v_exp_f32 v79, v79
    v_exp_f32 v80, v80
    v_exp_f32 v81, v81
    v_smfmac_f32_32x32x32_bf16 v[0:15], v[128:131], v[72:79], v244
    v_exp_f32 v82, v82
    v_exp_f32 v83, v83
    v_exp_f32 v84, v84
    v_mfma_f32_32x32x16_bf16 v[64:79], v[112:115], v[104:107], 0
    v_exp_f32 v85, v85
    v_exp_f32 v86, v86
    v_exp_f32 v87, v87
    v_exp_f32 v88, v88
    v_exp_f32 v89, v89
    v_smfmac_f32_32x32x32_bf16 v[16:31], v[124:127], v[80:87], v244
    v_exp_f32 v90, v90
    v_exp_f32 v91, v91
    v_exp_f32 v92, v92
    v_mfma_f32_32x32x16_bf16 v[196:211], v[152:155], v[156:159], v[196:211]
    v_exp_f32 v93, v93
    v_exp_f32 v94, v94
    v_exp_f32 v95, v95
    v_exp_f32 v64, v64
    v_exp_f32 v65, v65
    v_smfmac_f32_32x32x32_bf16 v[16:31], v[128:131], v[88:95], v244
    v_exp_f32 v66, v66
    v_exp_f32 v67, v67
    v_exp_f32 v68, v68
    v_mfma_f32_32x32x16_bf16 v[80:95], v[112:115], v[108:111], 0
    v_exp_f32 v69, v69
    v_exp_f32 v70, v70
    v_exp_f32 v71, v71
    v_exp_f32 v72, v72
    v_exp_f32 v73, v73
    v_smfmac_f32_32x32x32_bf16 v[32:47], v[124:127], v[64:71], v244
    v_exp_f32 v74, v74
    v_exp_f32 v75, v75
    v_exp_f32 v76, v76
    v_mfma_f32_32x32x16_bf16 v[212:227], v[148:151], v[160:163], v[212:227]
    v_exp_f32 v77, v77
    v_exp_f32 v78, v78
    v_exp_f32 v79, v79
    v_exp_f32 v80, v80
    v_exp_f32 v81, v81
    v_smfmac_f32_32x32x32_bf16 v[32:47], v[128:131], v[72:79], v244
    v_exp_f32 v82, v82
    v_exp_f32 v83, v83
    v_exp_f32 v84, v84
    s_waitcnt vmcnt(7)
    v_mfma_f32_32x32x16_bf16 v[64:79], v[116:119], v[96:99], 0
    buffer_load_dwordx4 v[112:115], v245, s[44:47], s33 offen offset:3072 sc1
    v_exp_f32 v85, v85
    v_exp_f32 v86, v86
    v_exp_f32 v87, v87
    v_exp_f32 v88, v88
    v_exp_f32 v89, v89
    v_smfmac_f32_32x32x32_bf16 v[48:63], v[124:127], v[80:87], v244
    v_exp_f32 v90, v90
    v_exp_f32 v91, v91
    v_exp_f32 v92, v92
    v_mfma_f32_32x32x16_bf16 v[228:243], v[152:155], v[160:163], v[228:243]
    ds_read_b64_tr_b16 v[148:149], v251 offset:2048
    ds_read_b64_tr_b16 v[150:151], v251 offset:2560
    ds_read_b64_tr_b16 v[152:153], v252 offset:2048
    ds_read_b64_tr_b16 v[154:155], v252 offset:2560
    v_exp_f32 v93, v93
    v_exp_f32 v94, v94
    v_exp_f32 v95, v95
    v_exp_f32 v64, v64
    v_exp_f32 v65, v65
    v_smfmac_f32_32x32x32_bf16 v[48:63], v[128:131], v[88:95], v244
    s_mov_b64 exec, s[96:97]
    buffer_load_dwordx4 v[124:127], v246, s[48:51], s33 offen offset:3072 sc1
    buffer_load_dwordx4 v[128:131], v246, s[48:51], s33 offen offset:3584 sc1
    s_mov_b64 exec, -1
    v_exp_f32 v66, v66
    v_exp_f32 v67, v67
    v_exp_f32 v68, v68
    v_mfma_f32_32x32x16_bf16 v[80:95], v[116:119], v[100:103], 0
    s_xor_b32 s38, s90, 786432
    s_add_u32 m0, s37, 0
    buffer_load_dwordx4 v[156:159], v245, s[56:59], s38 offen sc1
    buffer_load_dwordx4 v249, s[52:55], s38 offen lds
    buffer_load_dwordx4 v250, s[52:55], s38 offen offset:1024 lds
    buffer_load_dwordx4 v[160:163], v245, s[56:59], s38 offen offset:1024 sc1
    v_exp_f32 v69, v69
    v_exp_f32 v70, v70
    v_exp_f32 v71, v71
    v_exp_f32 v72, v72
    v_exp_f32 v73, v73
    v_smfmac_f32_32x32x32_bf16 v[0:15], v[132:135], v[64:71], v244
    s_waitcnt lgkmcnt(0)
    v_exp_f32 v74, v74
    v_exp_f32 v75, v75
    v_exp_f32 v76, v76
    v_mfma_f32_32x32x16_bf16 v[180:195], v[148:151], v[164:167], v[180:195]
    v_exp_f32 v77, v77
    v_exp_f32 v78, v78
    v_exp_f32 v79, v79
    v_exp_f32 v80, v80
    v_exp_f32 v81, v81
    v_smfmac_f32_32x32x32_bf16 v[0:15], v[136:139], v[72:79], v244
    v_exp_f32 v82, v82
    v_exp_f32 v83, v83
    v_exp_f32 v84, v84
    v_mfma_f32_32x32x16_bf16 v[64:79], v[116:119], v[104:107], 0
    v_exp_f32 v85, v85
    v_exp_f32 v86, v86
    v_exp_f32 v87, v87
    v_exp_f32 v88, v88
    v_exp_f32 v89, v89
    v_smfmac_f32_32x32x32_bf16 v[16:31], v[132:135], v[80:87], v244
    v_exp_f32 v90, v90
    v_exp_f32 v91, v91
    v_exp_f32 v92, v92
    v_mfma_f32_32x32x16_bf16 v[196:211], v[152:155], v[164:167], v[196:211]
    v_exp_f32 v93, v93
    v_exp_f32 v94, v94
    v_exp_f32 v95, v95
    v_exp_f32 v64, v64
    v_exp_f32 v65, v65
    v_smfmac_f32_32x32x32_bf16 v[16:31], v[136:139], v[88:95], v244
    v_exp_f32 v66, v66
    v_exp_f32 v67, v67
    v_exp_f32 v68, v68
    v_mfma_f32_32x32x16_bf16 v[80:95], v[116:119], v[108:111], 0
    v_exp_f32 v69, v69
    v_exp_f32 v70, v70
    v_exp_f32 v71, v71
    v_exp_f32 v72, v72
    v_exp_f32 v73, v73
    v_smfmac_f32_32x32x32_bf16 v[32:47], v[132:135], v[64:71], v244
    v_exp_f32 v74, v74
    v_exp_f32 v75, v75
    v_exp_f32 v76, v76
    v_mfma_f32_32x32x16_bf16 v[212:227], v[148:151], v[168:171], v[212:227]
    v_exp_f32 v77, v77
    v_exp_f32 v78, v78
    v_exp_f32 v79, v79
    v_exp_f32 v80, v80
    v_exp_f32 v81, v81
    v_smfmac_f32_32x32x32_bf16 v[32:47], v[136:139], v[72:79], v244
    v_exp_f32 v82, v82
    v_exp_f32 v83, v83
    v_exp_f32 v84, v84
    s_waitcnt vmcnt(7)
    v_mfma_f32_32x32x16_bf16 v[64:79], v[120:123], v[96:99], 0
    s_add_u32 s33, s33, 4096
    buffer_load_dwordx4 v[116:119], v245, s[44:47], s33 offen offset:0 sc1
    v_exp_f32 v85, v85
    v_exp_f32 v86, v86
    v_exp_f32 v87, v87
    v_exp_f32 v88, v88
    v_exp_f32 v89, v89
    v_smfmac_f32_32x32x32_bf16 v[48:63], v[132:135], v[80:87], v244
    v_exp_f32 v90, v90
    v_exp_f32 v91, v91
    v_exp_f32 v92, v92
    v_mfma_f32_32x32x16_bf16 v[228:243], v[152:155], v[168:171], v[228:243]
    ds_read_b64_tr_b16 v[148:149], v251 offset:4096
    ds_read_b64_tr_b16 v[150:151], v251 offset:4608
    ds_read_b64_tr_b16 v[152:153], v252 offset:4096
    ds_read_b64_tr_b16 v[154:155], v252 offset:4608
    v_exp_f32 v93, v93
    v_exp_f32 v94, v94
    v_exp_f32 v95, v95
    v_exp_f32 v64, v64
    v_exp_f32 v65, v65
    v_smfmac_f32_32x32x32_bf16 v[48:63], v[136:139], v[88:95], v244
    s_mov_b64 exec, s[96:97]
    buffer_load_dwordx4 v[132:135], v246, s[48:51], s33 offen offset:0 sc1
    buffer_load_dwordx4 v[136:139], v246, s[48:51], s33 offen offset:512 sc1
    s_mov_b64 exec, -1
    v_exp_f32 v66, v66
    v_exp_f32 v67, v67
    v_exp_f32 v68, v68
    v_mfma_f32_32x32x16_bf16 v[80:95], v[120:123], v[100:103], 0
    s_xor_b32 s38, s90, 851968
    s_add_u32 m0, s37, 2048
    buffer_load_dwordx4 v[164:167], v245, s[56:59], s38 offen sc1
    buffer_load_dwordx4 v249, s[52:55], s38 offen lds
    buffer_load_dwordx4 v250, s[52:55], s38 offen offset:1024 lds
    buffer_load_dwordx4 v[168:171], v245, s[56:59], s38 offen offset:1024 sc1
    v_exp_f32 v69, v69
    v_exp_f32 v70, v70
    v_exp_f32 v71, v71
    v_exp_f32 v72, v72
    v_exp_f32 v73, v73
    v_smfmac_f32_32x32x32_bf16 v[0:15], v[140:143], v[64:71], v244
    s_waitcnt lgkmcnt(0)
    v_exp_f32 v74, v74
    v_exp_f32 v75, v75
    v_exp_f32 v76, v76
    v_mfma_f32_32x32x16_bf16 v[180:195], v[148:151], v[172:175], v[180:195]
    v_exp_f32 v77, v77
    v_exp_f32 v78, v78
    v_exp_f32 v79, v79
    v_exp_f32 v80, v80
    v_exp_f32 v81, v81
    v_smfmac_f32_32x32x32_bf16 v[0:15], v[144:147], v[72:79], v244
    v_exp_f32 v82, v82
    v_exp_f32 v83, v83
    v_exp_f32 v84, v84
    v_mfma_f32_32x32x16_bf16 v[64:79], v[120:123], v[104:107], 0
    v_exp_f32 v85, v85
    v_exp_f32 v86, v86
    v_exp_f32 v87, v87
    v_exp_f32 v88, v88
    v_exp_f32 v89, v89
    v_smfmac_f32_32x32x32_bf16 v[16:31], v[140:143], v[80:87], v244
    v_exp_f32 v90, v90
    v_exp_f32 v91, v91
    v_exp_f32 v92, v92
    v_mfma_f32_32x32x16_bf16 v[196:211], v[152:155], v[172:175], v[196:211]
    v_exp_f32 v93, v93
    v_exp_f32 v94, v94
    v_exp_f32 v95, v95
    v_exp_f32 v64, v64
    v_exp_f32 v65, v65
    v_smfmac_f32_32x32x32_bf16 v[16:31], v[144:147], v[88:95], v244
    v_exp_f32 v66, v66
    v_exp_f32 v67, v67
    v_exp_f32 v68, v68
    v_mfma_f32_32x32x16_bf16 v[80:95], v[120:123], v[108:111], 0
    v_exp_f32 v69, v69
    v_exp_f32 v70, v70
    v_exp_f32 v71, v71
    v_exp_f32 v72, v72
    v_exp_f32 v73, v73
    v_smfmac_f32_32x32x32_bf16 v[32:47], v[140:143], v[64:71], v244
    v_exp_f32 v74, v74
    v_exp_f32 v75, v75
    v_exp_f32 v76, v76
    v_mfma_f32_32x32x16_bf16 v[212:227], v[148:151], v[176:179], v[212:227]
    v_exp_f32 v77, v77
    v_exp_f32 v78, v78
    v_exp_f32 v79, v79
    v_exp_f32 v80, v80
    v_exp_f32 v81, v81
    v_smfmac_f32_32x32x32_bf16 v[32:47], v[144:147], v[72:79], v244
    v_exp_f32 v82, v82
    v_exp_f32 v83, v83
    v_exp_f32 v84, v84
    s_waitcnt vmcnt(7)
    v_mfma_f32_32x32x16_bf16 v[64:79], v[112:115], v[96:99], 0
    buffer_load_dwordx4 v[120:123], v245, s[44:47], s33 offen offset:1024 sc1
    v_exp_f32 v85, v85
    v_exp_f32 v86, v86
    v_exp_f32 v87, v87
    v_exp_f32 v88, v88
    v_exp_f32 v89, v89
    v_smfmac_f32_32x32x32_bf16 v[48:63], v[140:143], v[80:87], v244
    v_exp_f32 v90, v90
    v_exp_f32 v91, v91
    v_exp_f32 v92, v92
    v_mfma_f32_32x32x16_bf16 v[228:243], v[152:155], v[176:179], v[228:243]
    ds_read_b64_tr_b16 v[148:149], v251 offset:0
    ds_read_b64_tr_b16 v[150:151], v251 offset:512
    ds_read_b64_tr_b16 v[152:153], v252 offset:0
    ds_read_b64_tr_b16 v[154:155], v252 offset:512
    v_exp_f32 v93, v93
    v_exp_f32 v94, v94
    v_exp_f32 v95, v95
    v_exp_f32 v64, v64
    v_exp_f32 v65, v65
    v_smfmac_f32_32x32x32_bf16 v[48:63], v[144:147], v[88:95], v244
    s_mov_b64 exec, s[96:97]
    buffer_load_dwordx4 v[140:143], v246, s[48:51], s33 offen offset:1024 sc1
    buffer_load_dwordx4 v[144:147], v246, s[48:51], s33 offen offset:1536 sc1
    s_mov_b64 exec, -1
    v_exp_f32 v66, v66
    v_exp_f32 v67, v67
    v_exp_f32 v68, v68
    v_mfma_f32_32x32x16_bf16 v[80:95], v[112:115], v[100:103], 0
    s_xor_b32 s38, s90, 917504
    s_add_u32 m0, s37, 4096
    buffer_load_dwordx4 v[172:175], v245, s[56:59], s38 offen sc1
    buffer_load_dwordx4 v249, s[52:55], s38 offen lds
    buffer_load_dwordx4 v250, s[52:55], s38 offen offset:1024 lds
    buffer_load_dwordx4 v[176:179], v245, s[56:59], s38 offen offset:1024 sc1
    v_exp_f32 v69, v69
    v_exp_f32 v70, v70
    v_exp_f32 v71, v71
    v_exp_f32 v72, v72
    v_exp_f32 v73, v73
    v_smfmac_f32_32x32x32_bf16 v[0:15], v[124:127], v[64:71], v244
    s_waitcnt lgkmcnt(0)
    v_exp_f32 v74, v74
    v_exp_f32 v75, v75
    v_exp_f32 v76, v76
    v_mfma_f32_32x32x16_bf16 v[180:195], v[148:151], v[156:159], v[180:195]
    v_exp_f32 v77, v77
    v_exp_f32 v78, v78
    v_exp_f32 v79, v79
    v_exp_f32 v80, v80
    v_exp_f32 v81, v81
    v_smfmac_f32_32x32x32_bf16 v[0:15], v[128:131], v[72:79], v244
    v_exp_f32 v82, v82
    v_exp_f32 v83, v83
    v_exp_f32 v84, v84
    v_mfma_f32_32x32x16_bf16 v[64:79], v[112:115], v[104:107], 0
    v_exp_f32 v85, v85
    v_exp_f32 v86, v86
    v_exp_f32 v87, v87
    v_exp_f32 v88, v88
    v_exp_f32 v89, v89
    v_smfmac_f32_32x32x32_bf16 v[16:31], v[124:127], v[80:87], v244
    v_exp_f32 v90, v90
    v_exp_f32 v91, v91
    v_exp_f32 v92, v92
    v_mfma_f32_32x32x16_bf16 v[196:211], v[152:155], v[156:159], v[196:211]
    v_exp_f32 v93, v93
    v_exp_f32 v94, v94
    v_exp_f32 v95, v95
    v_exp_f32 v64, v64
    v_exp_f32 v65, v65
    v_smfmac_f32_32x32x32_bf16 v[16:31], v[128:131], v[88:95], v244
    v_exp_f32 v66, v66
    v_exp_f32 v67, v67
    v_exp_f32 v68, v68
    v_mfma_f32_32x32x16_bf16 v[80:95], v[112:115], v[108:111], 0
    v_exp_f32 v69, v69
    v_exp_f32 v70, v70
    v_exp_f32 v71, v71
    v_exp_f32 v72, v72
    v_exp_f32 v73, v73
    v_smfmac_f32_32x32x32_bf16 v[32:47], v[124:127], v[64:71], v244
    v_exp_f32 v74, v74
    v_exp_f32 v75, v75
    v_exp_f32 v76, v76
    v_mfma_f32_32x32x16_bf16 v[212:227], v[148:151], v[160:163], v[212:227]
    v_exp_f32 v77, v77
    v_exp_f32 v78, v78
    v_exp_f32 v79, v79
    v_exp_f32 v80, v80
    v_exp_f32 v81, v81
    v_smfmac_f32_32x32x32_bf16 v[32:47], v[128:131], v[72:79], v244
    v_exp_f32 v82, v82
    v_exp_f32 v83, v83
    v_exp_f32 v84, v84
    s_waitcnt vmcnt(7)
    v_mfma_f32_32x32x16_bf16 v[64:79], v[116:119], v[96:99], 0
    buffer_load_dwordx4 v[112:115], v245, s[44:47], s33 offen offset:2048 sc1
    v_exp_f32 v85, v85
    v_exp_f32 v86, v86
    v_exp_f32 v87, v87
    v_exp_f32 v88, v88
    v_exp_f32 v89, v89
    v_smfmac_f32_32x32x32_bf16 v[48:63], v[124:127], v[80:87], v244
    v_exp_f32 v90, v90
    v_exp_f32 v91, v91
    v_exp_f32 v92, v92
    v_mfma_f32_32x32x16_bf16 v[228:243], v[152:155], v[160:163], v[228:243]
    ds_read_b64_tr_b16 v[148:149], v251 offset:2048
    ds_read_b64_tr_b16 v[150:151], v251 offset:2560
    ds_read_b64_tr_b16 v[152:153], v252 offset:2048
    ds_read_b64_tr_b16 v[154:155], v252 offset:2560
    v_exp_f32 v93, v93
    v_exp_f32 v94, v94
    v_exp_f32 v95, v95
    v_exp_f32 v64, v64
    v_exp_f32 v65, v65
    v_smfmac_f32_32x32x32_bf16 v[48:63], v[128:131], v[88:95], v244
    s_mov_b64 exec, s[96:97]
    buffer_load_dwordx4 v[124:127], v246, s[48:51], s33 offen offset:2048 sc1
    buffer_load_dwordx4 v[128:131], v246, s[48:51], s33 offen offset:2560 sc1
    s_mov_b64 exec, -1
    v_exp_f32 v66, v66
    v_exp_f32 v67, v67
    v_exp_f32 v68, v68
    v_mfma_f32_32x32x16_bf16 v[80:95], v[116:119], v[100:103], 0
    s_xor_b32 s38, s90, 983040
    s_add_u32 m0, s37, 0
    buffer_load_dwordx4 v[156:159], v245, s[56:59], s38 offen sc1
    buffer_load_dwordx4 v249, s[52:55], s38 offen lds
    buffer_load_dwordx4 v250, s[52:55], s38 offen offset:1024 lds
    buffer_load_dwordx4 v[160:163], v245, s[56:59], s38 offen offset:1024 sc1
    v_exp_f32 v69, v69
    v_exp_f32 v70, v70
    v_exp_f32 v71, v71
    v_exp_f32 v72, v72
    v_exp_f32 v73, v73
    v_smfmac_f32_32x32x32_bf16 v[0:15], v[132:135], v[64:71], v244
    s_waitcnt lgkmcnt(0)
    v_exp_f32 v74, v74
    v_exp_f32 v75, v75
    v_exp_f32 v76, v76
    v_mfma_f32_32x32x16_bf16 v[180:195], v[148:151], v[164:167], v[180:195]
    v_exp_f32 v77, v77
    v_exp_f32 v78, v78
    v_exp_f32 v79, v79
    v_exp_f32 v80, v80
    v_exp_f32 v81, v81
    v_smfmac_f32_32x32x32_bf16 v[0:15], v[136:139], v[72:79], v244
    v_exp_f32 v82, v82
    v_exp_f32 v83, v83
    v_exp_f32 v84, v84
    v_mfma_f32_32x32x16_bf16 v[64:79], v[116:119], v[104:107], 0
    v_exp_f32 v85, v85
    v_exp_f32 v86, v86
    v_exp_f32 v87, v87
    v_exp_f32 v88, v88
    v_exp_f32 v89, v89
    v_smfmac_f32_32x32x32_bf16 v[16:31], v[132:135], v[80:87], v244
    v_exp_f32 v90, v90
    v_exp_f32 v91, v91
    v_exp_f32 v92, v92
    v_mfma_f32_32x32x16_bf16 v[196:211], v[152:155], v[164:167], v[196:211]
    v_exp_f32 v93, v93
    v_exp_f32 v94, v94
    v_exp_f32 v95, v95
    v_exp_f32 v64, v64
    v_exp_f32 v65, v65
    v_smfmac_f32_32x32x32_bf16 v[16:31], v[136:139], v[88:95], v244
    v_exp_f32 v66, v66
    v_exp_f32 v67, v67
    v_exp_f32 v68, v68
    v_mfma_f32_32x32x16_bf16 v[80:95], v[116:119], v[108:111], 0
    v_exp_f32 v69, v69
    v_exp_f32 v70, v70
    v_exp_f32 v71, v71
    v_exp_f32 v72, v72
    v_exp_f32 v73, v73
    v_smfmac_f32_32x32x32_bf16 v[32:47], v[132:135], v[64:71], v244
    v_exp_f32 v74, v74
    v_exp_f32 v75, v75
    v_exp_f32 v76, v76
    v_mfma_f32_32x32x16_bf16 v[212:227], v[148:151], v[168:171], v[212:227]
    v_exp_f32 v77, v77
    v_exp_f32 v78, v78
    v_exp_f32 v79, v79
    v_exp_f32 v80, v80
    v_exp_f32 v81, v81
    v_smfmac_f32_32x32x32_bf16 v[32:47], v[136:139], v[72:79], v244
    v_exp_f32 v82, v82
    v_exp_f32 v83, v83
    v_exp_f32 v84, v84
    s_waitcnt vmcnt(7)
    v_mfma_f32_32x32x16_bf16 v[64:79], v[120:123], v[96:99], 0
    buffer_load_dwordx4 v[116:119], v245, s[44:47], s33 offen offset:3072 sc1
    v_exp_f32 v85, v85
    v_exp_f32 v86, v86
    v_exp_f32 v87, v87
    v_exp_f32 v88, v88
    v_exp_f32 v89, v89
    v_smfmac_f32_32x32x32_bf16 v[48:63], v[132:135], v[80:87], v244
    v_exp_f32 v90, v90
    v_exp_f32 v91, v91
    v_exp_f32 v92, v92
    v_mfma_f32_32x32x16_bf16 v[228:243], v[152:155], v[168:171], v[228:243]
    ds_read_b64_tr_b16 v[148:149], v251 offset:4096
    ds_read_b64_tr_b16 v[150:151], v251 offset:4608
    ds_read_b64_tr_b16 v[152:153], v252 offset:4096
    ds_read_b64_tr_b16 v[154:155], v252 offset:4608
    v_exp_f32 v93, v93
    v_exp_f32 v94, v94
    v_exp_f32 v95, v95
    v_exp_f32 v64, v64
    v_exp_f32 v65, v65
    v_smfmac_f32_32x32x32_bf16 v[48:63], v[136:139], v[88:95], v244
    s_mov_b64 exec, s[96:97]
    buffer_load_dwordx4 v[132:135], v246, s[48:51], s33 offen offset:3072 sc1
    buffer_load_dwordx4 v[136:139], v246, s[48:51], s33 offen offset:3584 sc1
    s_mov_b64 exec, -1
    v_exp_f32 v66, v66
    v_exp_f32 v67, v67
    v_exp_f32 v68, v68
    v_mfma_f32_32x32x16_bf16 v[80:95], v[120:123], v[100:103], 0
    s_xor_b32 s38, s91, 1048576
    s_add_u32 m0, s37, 2048
    buffer_load_dwordx4 v[164:167], v245, s[56:59], s38 offen sc1
    buffer_load_dwordx4 v249, s[52:55], s38 offen lds
    buffer_load_dwordx4 v250, s[52:55], s38 offen offset:1024 lds
    buffer_load_dwordx4 v[168:171], v245, s[56:59], s38 offen offset:1024 sc1
    v_exp_f32 v69, v69
    v_exp_f32 v70, v70
    v_exp_f32 v71, v71
    v_exp_f32 v72, v72
    v_exp_f32 v73, v73
    v_smfmac_f32_32x32x32_bf16 v[0:15], v[140:143], v[64:71], v244
    s_waitcnt lgkmcnt(0)
    v_exp_f32 v74, v74
    v_exp_f32 v75, v75
    v_exp_f32 v76, v76
    v_mfma_f32_32x32x16_bf16 v[180:195], v[148:151], v[172:175], v[180:195]
    v_exp_f32 v77, v77
    v_exp_f32 v78, v78
    v_exp_f32 v79, v79
    v_exp_f32 v80, v80
    v_exp_f32 v81, v81
    v_smfmac_f32_32x32x32_bf16 v[0:15], v[144:147], v[72:79], v244
    v_exp_f32 v82, v82
    v_exp_f32 v83, v83
    v_exp_f32 v84, v84
    v_mfma_f32_32x32x16_bf16 v[64:79], v[120:123], v[104:107], 0
    v_exp_f32 v85, v85
    v_exp_f32 v86, v86
    v_exp_f32 v87, v87
    v_exp_f32 v88, v88
    v_exp_f32 v89, v89
    v_smfmac_f32_32x32x32_bf16 v[16:31], v[140:143], v[80:87], v244
    v_exp_f32 v90, v90
    v_exp_f32 v91, v91
    v_exp_f32 v92, v92
    v_mfma_f32_32x32x16_bf16 v[196:211], v[152:155], v[172:175], v[196:211]
    v_exp_f32 v93, v93
    v_exp_f32 v94, v94
    v_exp_f32 v95, v95
    v_exp_f32 v64, v64
    v_exp_f32 v65, v65
    v_smfmac_f32_32x32x32_bf16 v[16:31], v[144:147], v[88:95], v244
    v_exp_f32 v66, v66
    v_exp_f32 v67, v67
    v_exp_f32 v68, v68
    v_mfma_f32_32x32x16_bf16 v[80:95], v[120:123], v[108:111], 0
    v_exp_f32 v69, v69
    v_exp_f32 v70, v70
    v_exp_f32 v71, v71
    v_exp_f32 v72, v72
    v_exp_f32 v73, v73
    v_smfmac_f32_32x32x32_bf16 v[32:47], v[140:143], v[64:71], v244
    v_exp_f32 v74, v74
    v_exp_f32 v75, v75
    v_exp_f32 v76, v76
    v_mfma_f32_32x32x16_bf16 v[212:227], v[148:151], v[176:179], v[212:227]
    v_exp_f32 v77, v77
    v_exp_f32 v78, v78
    v_exp_f32 v79, v79
    v_exp_f32 v80, v80
    v_exp_f32 v81, v81
    v_smfmac_f32_32x32x32_bf16 v[32:47], v[144:147], v[72:79], v244
    v_exp_f32 v82, v82
    v_exp_f32 v83, v83
    v_exp_f32 v84, v84
    s_waitcnt vmcnt(7)
    v_mfma_f32_32x32x16_bf16 v[64:79], v[112:115], v[96:99], 0
    s_add_u32 s33, s33, 4096
    buffer_load_dwordx4 v[120:123], v245, s[44:47], s33 offen offset:0 sc1
    v_exp_f32 v85, v85
    v_exp_f32 v86, v86
    v_exp_f32 v87, v87
    v_exp_f32 v88, v88
    v_exp_f32 v89, v89
    v_smfmac_f32_32x32x32_bf16 v[48:63], v[140:143], v[80:87], v244
    v_exp_f32 v90, v90
    v_exp_f32 v91, v91
    v_exp_f32 v92, v92
    v_mfma_f32_32x32x16_bf16 v[228:243], v[152:155], v[176:179], v[228:243]
    ds_read_b64_tr_b16 v[148:149], v251 offset:0
    ds_read_b64_tr_b16 v[150:151], v251 offset:512
    ds_read_b64_tr_b16 v[152:153], v252 offset:0
    ds_read_b64_tr_b16 v[154:155], v252 offset:512
    v_exp_f32 v93, v93
    v_exp_f32 v94, v94
    v_exp_f32 v95, v95
    v_exp_f32 v64, v64
    v_exp_f32 v65, v65
    v_smfmac_f32_32x32x32_bf16 v[48:63], v[144:147], v[88:95], v244
    s_mov_b64 exec, s[96:97]
    buffer_load_dwordx4 v[140:143], v246, s[48:51], s33 offen offset:0 sc1
    buffer_load_dwordx4 v[144:147], v246, s[48:51], s33 offen offset:512 sc1
    s_mov_b64 exec, -1
    v_exp_f32 v66, v66
    v_exp_f32 v67, v67
    v_exp_f32 v68, v68
    v_mfma_f32_32x32x16_bf16 v[80:95], v[112:115], v[100:103], 0
    s_xor_b32 s38, s91, 1114112
    s_add_u32 m0, s37, 4096
    buffer_load_dwordx4 v[172:175], v245, s[56:59], s38 offen sc1
    buffer_load_dwordx4 v249, s[52:55], s38 offen lds
    buffer_load_dwordx4 v250, s[52:55], s38 offen offset:1024 lds
    buffer_load_dwordx4 v[176:179], v245, s[56:59], s38 offen offset:1024 sc1
    v_exp_f32 v69, v69
    v_exp_f32 v70, v70
    v_exp_f32 v71, v71
    v_exp_f32 v72, v72
    v_exp_f32 v73, v73
    v_smfmac_f32_32x32x32_bf16 v[0:15], v[124:127], v[64:71], v244
    s_waitcnt lgkmcnt(0)
    v_exp_f32 v74, v74
    v_exp_f32 v75, v75
    v_exp_f32 v76, v76
    v_mfma_f32_32x32x16_bf16 v[180:195], v[148:151], v[156:159], v[180:195]
    v_exp_f32 v77, v77
    v_exp_f32 v78, v78
    v_exp_f32 v79, v79
    v_exp_f32 v80, v80
    v_exp_f32 v81, v81
    v_smfmac_f32_32x32x32_bf16 v[0:15], v[128:131], v[72:79], v244
    v_exp_f32 v82, v82
    v_exp_f32 v83, v83
    v_exp_f32 v84, v84
    v_mfma_f32_32x32x16_bf16 v[64:79], v[112:115], v[104:107], 0
    v_exp_f32 v85, v85
    v_exp_f32 v86, v86
    v_exp_f32 v87, v87
    v_exp_f32 v88, v88
    v_exp_f32 v89, v89
    v_smfmac_f32_32x32x32_bf16 v[16:31], v[124:127], v[80:87], v244
    v_exp_f32 v90, v90
    v_exp_f32 v91, v91
    v_exp_f32 v92, v92
    v_mfma_f32_32x32x16_bf16 v[196:211], v[152:155], v[156:159], v[196:211]
    v_exp_f32 v93, v93
    v_exp_f32 v94, v94
    v_exp_f32 v95, v95
    v_exp_f32 v64, v64
    v_exp_f32 v65, v65
    v_smfmac_f32_32x32x32_bf16 v[16:31], v[128:131], v[88:95], v244
    v_exp_f32 v66, v66
    v_exp_f32 v67, v67
    v_exp_f32 v68, v68
    v_mfma_f32_32x32x16_bf16 v[80:95], v[112:115], v[108:111], 0
    v_exp_f32 v69, v69
    v_exp_f32 v70, v70
    v_exp_f32 v71, v71
    v_exp_f32 v72, v72
    v_exp_f32 v73, v73
    v_smfmac_f32_32x32x32_bf16 v[32:47], v[124:127], v[64:71], v244
    v_exp_f32 v74, v74
    v_exp_f32 v75, v75
    v_exp_f32 v76, v76
    v_mfma_f32_32x32x16_bf16 v[212:227], v[148:151], v[160:163], v[212:227]
    v_exp_f32 v77, v77
    v_exp_f32 v78, v78
    v_exp_f32 v79, v79
    v_exp_f32 v80, v80
    v_exp_f32 v81, v81
    v_smfmac_f32_32x32x32_bf16 v[32:47], v[128:131], v[72:79], v244
    v_exp_f32 v82, v82
    v_exp_f32 v83, v83
    v_exp_f32 v84, v84
    s_waitcnt vmcnt(7)
    v_mfma_f32_32x32x16_bf16 v[64:79], v[116:119], v[96:99], 0
    buffer_load_dwordx4 v[112:115], v245, s[44:47], s33 offen offset:1024 sc1
    v_exp_f32 v85, v85
    v_exp_f32 v86, v86
    v_exp_f32 v87, v87
    v_exp_f32 v88, v88
    v_exp_f32 v89, v89
    v_smfmac_f32_32x32x32_bf16 v[48:63], v[124:127], v[80:87], v244
    v_exp_f32 v90, v90
    v_exp_f32 v91, v91
    v_exp_f32 v92, v92
    v_mfma_f32_32x32x16_bf16 v[228:243], v[152:155], v[160:163], v[228:243]
    ds_read_b64_tr_b16 v[148:149], v251 offset:2048
    ds_read_b64_tr_b16 v[150:151], v251 offset:2560
    ds_read_b64_tr_b16 v[152:153], v252 offset:2048
    ds_read_b64_tr_b16 v[154:155], v252 offset:2560
    v_exp_f32 v93, v93
    v_exp_f32 v94, v94
    v_exp_f32 v95, v95
    v_exp_f32 v64, v64
    v_exp_f32 v65, v65
    v_smfmac_f32_32x32x32_bf16 v[48:63], v[128:131], v[88:95], v244
    s_mov_b64 exec, s[96:97]
    buffer_load_dwordx4 v[124:127], v246, s[48:51], s33 offen offset:1024 sc1
    buffer_load_dwordx4 v[128:131], v246, s[48:51], s33 offen offset:1536 sc1
    s_mov_b64 exec, -1
    v_exp_f32 v66, v66
    v_exp_f32 v67, v67
    v_exp_f32 v68, v68
    v_mfma_f32_32x32x16_bf16 v[80:95], v[116:119], v[100:103], 0
    s_xor_b32 s38, s91, 1179648
    s_add_u32 m0, s37, 0
    buffer_load_dwordx4 v[156:159], v245, s[56:59], s38 offen sc1
    buffer_load_dwordx4 v249, s[52:55], s38 offen lds
    buffer_load_dwordx4 v250, s[52:55], s38 offen offset:1024 lds
    buffer_load_dwordx4 v[160:163], v245, s[56:59], s38 offen offset:1024 sc1
    v_exp_f32 v69, v69
    v_exp_f32 v70, v70
    v_exp_f32 v71, v71
    v_exp_f32 v72, v72
    v_exp_f32 v73, v73
    v_smfmac_f32_32x32x32_bf16 v[0:15], v[132:135], v[64:71], v244
    s_waitcnt lgkmcnt(0)
    v_exp_f32 v74, v74
    v_exp_f32 v75, v75
    v_exp_f32 v76, v76
    v_mfma_f32_32x32x16_bf16 v[180:195], v[148:151], v[164:167], v[180:195]
    v_exp_f32 v77, v77
    v_exp_f32 v78, v78
    v_exp_f32 v79, v79
    v_exp_f32 v80, v80
    v_exp_f32 v81, v81
    v_smfmac_f32_32x32x32_bf16 v[0:15], v[136:139], v[72:79], v244
    v_exp_f32 v82, v82
    v_exp_f32 v83, v83
    v_exp_f32 v84, v84
    v_mfma_f32_32x32x16_bf16 v[64:79], v[116:119], v[104:107], 0
    v_exp_f32 v85, v85
    v_exp_f32 v86, v86
    v_exp_f32 v87, v87
    v_exp_f32 v88, v88
    v_exp_f32 v89, v89
    v_smfmac_f32_32x32x32_bf16 v[16:31], v[132:135], v[80:87], v244
    v_exp_f32 v90, v90
    v_exp_f32 v91, v91
    v_exp_f32 v92, v92
    v_mfma_f32_32x32x16_bf16 v[196:211], v[152:155], v[164:167], v[196:211]
    v_exp_f32 v93, v93
    v_exp_f32 v94, v94
    v_exp_f32 v95, v95
    v_exp_f32 v64, v64
    v_exp_f32 v65, v65
    v_smfmac_f32_32x32x32_bf16 v[16:31], v[136:139], v[88:95], v244
    v_exp_f32 v66, v66
    v_exp_f32 v67, v67
    v_exp_f32 v68, v68
    v_mfma_f32_32x32x16_bf16 v[80:95], v[116:119], v[108:111], 0
    v_exp_f32 v69, v69
    v_exp_f32 v70, v70
    v_exp_f32 v71, v71
    v_exp_f32 v72, v72
    v_exp_f32 v73, v73
    v_smfmac_f32_32x32x32_bf16 v[32:47], v[132:135], v[64:71], v244
    v_exp_f32 v74, v74
    v_exp_f32 v75, v75
    v_exp_f32 v76, v76
    v_mfma_f32_32x32x16_bf16 v[212:227], v[148:151], v[168:171], v[212:227]
    v_exp_f32 v77, v77
    v_exp_f32 v78, v78
    v_exp_f32 v79, v79
    v_exp_f32 v80, v80
    v_exp_f32 v81, v81
    v_smfmac_f32_32x32x32_bf16 v[32:47], v[136:139], v[72:79], v244
    v_exp_f32 v82, v82
    v_exp_f32 v83, v83
    v_exp_f32 v84, v84
    s_waitcnt vmcnt(7)
    v_mfma_f32_32x32x16_bf16 v[64:79], v[120:123], v[96:99], 0
    buffer_load_dwordx4 v[116:119], v245, s[44:47], s33 offen offset:2048 sc1
    v_exp_f32 v85, v85
    v_exp_f32 v86, v86
    v_exp_f32 v87, v87
    v_exp_f32 v88, v88
    v_exp_f32 v89, v89
    v_smfmac_f32_32x32x32_bf16 v[48:63], v[132:135], v[80:87], v244
    v_exp_f32 v90, v90
    v_exp_f32 v91, v91
    v_exp_f32 v92, v92
    v_mfma_f32_32x32x16_bf16 v[228:243], v[152:155], v[168:171], v[228:243]
    ds_read_b64_tr_b16 v[148:149], v251 offset:4096
    ds_read_b64_tr_b16 v[150:151], v251 offset:4608
    ds_read_b64_tr_b16 v[152:153], v252 offset:4096
    ds_read_b64_tr_b16 v[154:155], v252 offset:4608
    v_exp_f32 v93, v93
    v_exp_f32 v94, v94
    v_exp_f32 v95, v95
    v_exp_f32 v64, v64
    v_exp_f32 v65, v65
    v_smfmac_f32_32x32x32_bf16 v[48:63], v[136:139], v[88:95], v244
    s_mov_b64 exec, s[96:97]
    buffer_load_dwordx4 v[132:135], v246, s[48:51], s33 offen offset:2048 sc1
    buffer_load_dwordx4 v[136:139], v246, s[48:51], s33 offen offset:2560 sc1
    s_mov_b64 exec, -1
    v_exp_f32 v66, v66
    v_exp_f32 v67, v67
    v_exp_f32 v68, v68
    v_mfma_f32_32x32x16_bf16 v[80:95], v[120:123], v[100:103], 0
    s_xor_b32 s38, s91, 1245184
    s_add_u32 m0, s37, 2048
    buffer_load_dwordx4 v[164:167], v245, s[56:59], s38 offen sc1
    buffer_load_dwordx4 v249, s[52:55], s38 offen lds
    buffer_load_dwordx4 v250, s[52:55], s38 offen offset:1024 lds
    buffer_load_dwordx4 v[168:171], v245, s[56:59], s38 offen offset:1024 sc1
    v_exp_f32 v69, v69
    v_exp_f32 v70, v70
    v_exp_f32 v71, v71
    v_exp_f32 v72, v72
    v_exp_f32 v73, v73
    v_smfmac_f32_32x32x32_bf16 v[0:15], v[140:143], v[64:71], v244
    s_waitcnt lgkmcnt(0)
    v_exp_f32 v74, v74
    v_exp_f32 v75, v75
    v_exp_f32 v76, v76
    v_mfma_f32_32x32x16_bf16 v[180:195], v[148:151], v[172:175], v[180:195]
    v_exp_f32 v77, v77
    v_exp_f32 v78, v78
    v_exp_f32 v79, v79
    v_exp_f32 v80, v80
    v_exp_f32 v81, v81
    v_smfmac_f32_32x32x32_bf16 v[0:15], v[144:147], v[72:79], v244
    v_exp_f32 v82, v82
    v_exp_f32 v83, v83
    v_exp_f32 v84, v84
    v_mfma_f32_32x32x16_bf16 v[64:79], v[120:123], v[104:107], 0
    v_exp_f32 v85, v85
    v_exp_f32 v86, v86
    v_exp_f32 v87, v87
    v_exp_f32 v88, v88
    v_exp_f32 v89, v89
    v_smfmac_f32_32x32x32_bf16 v[16:31], v[140:143], v[80:87], v244
    v_exp_f32 v90, v90
    v_exp_f32 v91, v91
    v_exp_f32 v92, v92
    v_mfma_f32_32x32x16_bf16 v[196:211], v[152:155], v[172:175], v[196:211]
    v_exp_f32 v93, v93
    v_exp_f32 v94, v94
    v_exp_f32 v95, v95
    v_exp_f32 v64, v64
    v_exp_f32 v65, v65
    v_smfmac_f32_32x32x32_bf16 v[16:31], v[144:147], v[88:95], v244
    v_exp_f32 v66, v66
    v_exp_f32 v67, v67
    v_exp_f32 v68, v68
    v_mfma_f32_32x32x16_bf16 v[80:95], v[120:123], v[108:111], 0
    v_exp_f32 v69, v69
    v_exp_f32 v70, v70
    v_exp_f32 v71, v71
    v_exp_f32 v72, v72
    v_exp_f32 v73, v73
    v_smfmac_f32_32x32x32_bf16 v[32:47], v[140:143], v[64:71], v244
    v_exp_f32 v74, v74
    v_exp_f32 v75, v75
    v_exp_f32 v76, v76
    v_mfma_f32_32x32x16_bf16 v[212:227], v[148:151], v[176:179], v[212:227]
    v_exp_f32 v77, v77
    v_exp_f32 v78, v78
    v_exp_f32 v79, v79
    v_exp_f32 v80, v80
    v_exp_f32 v81, v81
    v_smfmac_f32_32x32x32_bf16 v[32:47], v[144:147], v[72:79], v244
    v_exp_f32 v82, v82
    v_exp_f32 v83, v83
    v_exp_f32 v84, v84
    s_waitcnt vmcnt(7)
    v_mfma_f32_32x32x16_bf16 v[64:79], v[112:115], v[96:99], 0
    buffer_load_dwordx4 v[120:123], v245, s[44:47], s33 offen offset:3072 sc1
    v_exp_f32 v85, v85
    v_exp_f32 v86, v86
    v_exp_f32 v87, v87
    v_exp_f32 v88, v88
    v_exp_f32 v89, v89
    v_smfmac_f32_32x32x32_bf16 v[48:63], v[140:143], v[80:87], v244
    v_exp_f32 v90, v90
    v_exp_f32 v91, v91
    v_exp_f32 v92, v92
    v_mfma_f32_32x32x16_bf16 v[228:243], v[152:155], v[176:179], v[228:243]
    ds_read_b64_tr_b16 v[148:149], v251 offset:0
    ds_read_b64_tr_b16 v[150:151], v251 offset:512
    ds_read_b64_tr_b16 v[152:153], v252 offset:0
    ds_read_b64_tr_b16 v[154:155], v252 offset:512
    v_exp_f32 v93, v93
    v_exp_f32 v94, v94
    v_exp_f32 v95, v95
    v_exp_f32 v64, v64
    v_exp_f32 v65, v65
    v_smfmac_f32_32x32x32_bf16 v[48:63], v[144:147], v[88:95], v244
    s_mov_b64 exec, s[96:97]
    buffer_load_dwordx4 v[140:143], v246, s[48:51], s33 offen offset:3072 sc1
    buffer_load_dwordx4 v[144:147], v246, s[48:51], s33 offen offset:3584 sc1
    s_mov_b64 exec, -1
    v_exp_f32 v66, v66
    v_exp_f32 v67, v67
    v_exp_f32 v68, v68
    v_mfma_f32_32x32x16_bf16 v[80:95], v[112:115], v[100:103], 0
    s_xor_b32 s38, s92, 1310720
    s_add_u32 m0, s37, 4096
    buffer_load_dwordx4 v[172:175], v245, s[56:59], s38 offen sc1
    buffer_load_dwordx4 v249, s[52:55], s38 offen lds
    buffer_load_dwordx4 v250, s[52:55], s38 offen offset:1024 lds
    buffer_load_dwordx4 v[176:179], v245, s[56:59], s38 offen offset:1024 sc1
    v_exp_f32 v69, v69
    v_exp_f32 v70, v70
    v_exp_f32 v71, v71
    v_exp_f32 v72, v72
    v_exp_f32 v73, v73
    v_smfmac_f32_32x32x32_bf16 v[0:15], v[124:127], v[64:71], v244
    s_waitcnt lgkmcnt(0)
    v_exp_f32 v74, v74
    v_exp_f32 v75, v75
    v_exp_f32 v76, v76
    v_mfma_f32_32x32x16_bf16 v[180:195], v[148:151], v[156:159], v[180:195]
    v_exp_f32 v77, v77
    v_exp_f32 v78, v78
    v_exp_f32 v79, v79
    v_exp_f32 v80, v80
    v_exp_f32 v81, v81
    v_smfmac_f32_32x32x32_bf16 v[0:15], v[128:131], v[72:79], v244
    v_exp_f32 v82, v82
    v_exp_f32 v83, v83
    v_exp_f32 v84, v84
    v_mfma_f32_32x32x16_bf16 v[64:79], v[112:115], v[104:107], 0
    v_exp_f32 v85, v85
    v_exp_f32 v86, v86
    v_exp_f32 v87, v87
    v_exp_f32 v88, v88
    v_exp_f32 v89, v89
    v_smfmac_f32_32x32x32_bf16 v[16:31], v[124:127], v[80:87], v244
    v_exp_f32 v90, v90
    v_exp_f32 v91, v91
    v_exp_f32 v92, v92
    v_mfma_f32_32x32x16_bf16 v[196:211], v[152:155], v[156:159], v[196:211]
    v_exp_f32 v93, v93
    v_exp_f32 v94, v94
    v_exp_f32 v95, v95
    v_exp_f32 v64, v64
    v_exp_f32 v65, v65
    v_smfmac_f32_32x32x32_bf16 v[16:31], v[128:131], v[88:95], v244
    v_exp_f32 v66, v66
    v_exp_f32 v67, v67
    v_exp_f32 v68, v68
    v_mfma_f32_32x32x16_bf16 v[80:95], v[112:115], v[108:111], 0
    v_exp_f32 v69, v69
    v_exp_f32 v70, v70
    v_exp_f32 v71, v71
    v_exp_f32 v72, v72
    v_exp_f32 v73, v73
    v_smfmac_f32_32x32x32_bf16 v[32:47], v[124:127], v[64:71], v244
    v_exp_f32 v74, v74
    v_exp_f32 v75, v75
    v_exp_f32 v76, v76
    v_mfma_f32_32x32x16_bf16 v[212:227], v[148:151], v[160:163], v[212:227]
    v_exp_f32 v77, v77
    v_exp_f32 v78, v78
    v_exp_f32 v79, v79
    v_exp_f32 v80, v80
    v_exp_f32 v81, v81
    v_smfmac_f32_32x32x32_bf16 v[32:47], v[128:131], v[72:79], v244
    v_exp_f32 v82, v82
    v_exp_f32 v83, v83
    v_exp_f32 v84, v84
    s_waitcnt vmcnt(7)
    v_mfma_f32_32x32x16_bf16 v[64:79], v[116:119], v[96:99], 0
    s_add_u32 s33, s33, 4096
    buffer_load_dwordx4 v[112:115], v245, s[44:47], s33 offen offset:0 sc1
    v_exp_f32 v85, v85
    v_exp_f32 v86, v86
    v_exp_f32 v87, v87
    v_exp_f32 v88, v88
    v_exp_f32 v89, v89
    v_smfmac_f32_32x32x32_bf16 v[48:63], v[124:127], v[80:87], v244
    v_exp_f32 v90, v90
    v_exp_f32 v91, v91
    v_exp_f32 v92, v92
    v_mfma_f32_32x32x16_bf16 v[228:243], v[152:155], v[160:163], v[228:243]
    ds_read_b64_tr_b16 v[148:149], v251 offset:2048
    ds_read_b64_tr_b16 v[150:151], v251 offset:2560
    ds_read_b64_tr_b16 v[152:153], v252 offset:2048
    ds_read_b64_tr_b16 v[154:155], v252 offset:2560
    v_exp_f32 v93, v93
    v_exp_f32 v94, v94
    v_exp_f32 v95, v95
    v_exp_f32 v64, v64
    v_exp_f32 v65, v65
    v_smfmac_f32_32x32x32_bf16 v[48:63], v[128:131], v[88:95], v244
    s_mov_b64 exec, s[96:97]
    buffer_load_dwordx4 v[124:127], v246, s[48:51], s33 offen offset:0 sc1
    buffer_load_dwordx4 v[128:131], v246, s[48:51], s33 offen offset:512 sc1
    s_mov_b64 exec, -1
    v_exp_f32 v66, v66
    v_exp_f32 v67, v67
    v_exp_f32 v68, v68
    v_mfma_f32_32x32x16_bf16 v[80:95], v[116:119], v[100:103], 0
    s_xor_b32 s38, s92, 1376256
    s_add_u32 m0, s37, 0
    buffer_load_dwordx4 v[156:159], v245, s[56:59], s38 offen sc1
    buffer_load_dwordx4 v249, s[52:55], s38 offen lds
    buffer_load_dwordx4 v250, s[52:55], s38 offen offset:1024 lds
    buffer_load_dwordx4 v[160:163], v245, s[56:59], s38 offen offset:1024 sc1
    v_exp_f32 v69, v69
    v_exp_f32 v70, v70
    v_exp_f32 v71, v71
    v_exp_f32 v72, v72
    v_exp_f32 v73, v73
    v_smfmac_f32_32x32x32_bf16 v[0:15], v[132:135], v[64:71], v244
    s_waitcnt lgkmcnt(0)
    v_exp_f32 v74, v74
    v_exp_f32 v75, v75
    v_exp_f32 v76, v76
    v_mfma_f32_32x32x16_bf16 v[180:195], v[148:151], v[164:167], v[180:195]
    v_exp_f32 v77, v77
    v_exp_f32 v78, v78
    v_exp_f32 v79, v79
    v_exp_f32 v80, v80
    v_exp_f32 v81, v81
    v_smfmac_f32_32x32x32_bf16 v[0:15], v[136:139], v[72:79], v244
    v_exp_f32 v82, v82
    v_exp_f32 v83, v83
    v_exp_f32 v84, v84
    v_mfma_f32_32x32x16_bf16 v[64:79], v[116:119], v[104:107], 0
    v_exp_f32 v85, v85
    v_exp_f32 v86, v86
    v_exp_f32 v87, v87
    v_exp_f32 v88, v88
    v_exp_f32 v89, v89
    v_smfmac_f32_32x32x32_bf16 v[16:31], v[132:135], v[80:87], v244
    v_exp_f32 v90, v90
    v_exp_f32 v91, v91
    v_exp_f32 v92, v92
    v_mfma_f32_32x32x16_bf16 v[196:211], v[152:155], v[164:167], v[196:211]
    v_exp_f32 v93, v93
    v_exp_f32 v94, v94
    v_exp_f32 v95, v95
    v_exp_f32 v64, v64
    v_exp_f32 v65, v65
    v_smfmac_f32_32x32x32_bf16 v[16:31], v[136:139], v[88:95], v244
    v_exp_f32 v66, v66
    v_exp_f32 v67, v67
    v_exp_f32 v68, v68
    v_mfma_f32_32x32x16_bf16 v[80:95], v[116:119], v[108:111], 0
    v_exp_f32 v69, v69
    v_exp_f32 v70, v70
    v_exp_f32 v71, v71
    v_exp_f32 v72, v72
    v_exp_f32 v73, v73
    v_smfmac_f32_32x32x32_bf16 v[32:47], v[132:135], v[64:71], v244
    v_exp_f32 v74, v74
    v_exp_f32 v75, v75
    v_exp_f32 v76, v76
    v_mfma_f32_32x32x16_bf16 v[212:227], v[148:151], v[168:171], v[212:227]
    v_exp_f32 v77, v77
    v_exp_f32 v78, v78
    v_exp_f32 v79, v79
    v_exp_f32 v80, v80
    v_exp_f32 v81, v81
    v_smfmac_f32_32x32x32_bf16 v[32:47], v[136:139], v[72:79], v244
    v_exp_f32 v82, v82
    v_exp_f32 v83, v83
    v_exp_f32 v84, v84
    s_waitcnt vmcnt(7)
    v_mfma_f32_32x32x16_bf16 v[64:79], v[120:123], v[96:99], 0
    v_exp_f32 v85, v85
    v_exp_f32 v86, v86
    v_exp_f32 v87, v87
    v_exp_f32 v88, v88
    v_exp_f32 v89, v89
    v_smfmac_f32_32x32x32_bf16 v[48:63], v[132:135], v[80:87], v244
    v_exp_f32 v90, v90
    v_exp_f32 v91, v91
    v_exp_f32 v92, v92
    v_mfma_f32_32x32x16_bf16 v[228:243], v[152:155], v[168:171], v[228:243]
    ds_read_b64_tr_b16 v[148:149], v251 offset:4096
    ds_read_b64_tr_b16 v[150:151], v251 offset:4608
    ds_read_b64_tr_b16 v[152:153], v252 offset:4096
    ds_read_b64_tr_b16 v[154:155], v252 offset:4608
    v_exp_f32 v93, v93
    v_exp_f32 v94, v94
    v_exp_f32 v95, v95
    v_exp_f32 v64, v64
    v_exp_f32 v65, v65
    v_smfmac_f32_32x32x32_bf16 v[48:63], v[136:139], v[88:95], v244
    v_exp_f32 v66, v66
    v_exp_f32 v67, v67
    v_exp_f32 v68, v68
    v_mfma_f32_32x32x16_bf16 v[80:95], v[120:123], v[100:103], 0
    v_exp_f32 v69, v69
    v_exp_f32 v70, v70
    v_exp_f32 v71, v71
    v_exp_f32 v72, v72
    v_exp_f32 v73, v73
    v_smfmac_f32_32x32x32_bf16 v[0:15], v[140:143], v[64:71], v244
    s_waitcnt lgkmcnt(0)
    v_exp_f32 v74, v74
    v_exp_f32 v75, v75
    v_exp_f32 v76, v76
    v_mfma_f32_32x32x16_bf16 v[180:195], v[148:151], v[172:175], v[180:195]
    v_exp_f32 v77, v77
    v_exp_f32 v78, v78
    v_exp_f32 v79, v79
    v_exp_f32 v80, v80
    v_exp_f32 v81, v81
    v_smfmac_f32_32x32x32_bf16 v[0:15], v[144:147], v[72:79], v244
    v_exp_f32 v82, v82
    v_exp_f32 v83, v83
    v_exp_f32 v84, v84
    v_mfma_f32_32x32x16_bf16 v[64:79], v[120:123], v[104:107], 0
    v_exp_f32 v85, v85
    v_exp_f32 v86, v86
    v_exp_f32 v87, v87
    v_exp_f32 v88, v88
    v_exp_f32 v89, v89
    v_smfmac_f32_32x32x32_bf16 v[16:31], v[140:143], v[80:87], v244
    v_exp_f32 v90, v90
    v_exp_f32 v91, v91
    v_exp_f32 v92, v92
    v_mfma_f32_32x32x16_bf16 v[196:211], v[152:155], v[172:175], v[196:211]
    v_exp_f32 v93, v93
    v_exp_f32 v94, v94
    v_exp_f32 v95, v95
    v_exp_f32 v64, v64
    v_exp_f32 v65, v65
    v_smfmac_f32_32x32x32_bf16 v[16:31], v[144:147], v[88:95], v244
    v_exp_f32 v66, v66
    v_exp_f32 v67, v67
    v_exp_f32 v68, v68
    v_mfma_f32_32x32x16_bf16 v[80:95], v[120:123], v[108:111], 0
    v_exp_f32 v69, v69
    v_exp_f32 v70, v70
    v_exp_f32 v71, v71
    v_exp_f32 v72, v72
    v_exp_f32 v73, v73
    v_smfmac_f32_32x32x32_bf16 v[32:47], v[140:143], v[64:71], v244
    v_exp_f32 v74, v74
    v_exp_f32 v75, v75
    v_exp_f32 v76, v76
    v_mfma_f32_32x32x16_bf16 v[212:227], v[148:151], v[176:179], v[212:227]
    v_exp_f32 v77, v77
    v_exp_f32 v78, v78
    v_exp_f32 v79, v79
    v_exp_f32 v80, v80
    v_exp_f32 v81, v81
    v_smfmac_f32_32x32x32_bf16 v[32:47], v[144:147], v[72:79], v244
    v_exp_f32 v82, v82
    v_exp_f32 v83, v83
    v_exp_f32 v84, v84
    s_waitcnt vmcnt(0)
    v_mfma_f32_32x32x16_bf16 v[64:79], v[112:115], v[96:99], 0
    v_exp_f32 v85, v85
    v_exp_f32 v86, v86
    v_exp_f32 v87, v87
    v_exp_f32 v88, v88
    v_exp_f32 v89, v89
    v_smfmac_f32_32x32x32_bf16 v[48:63], v[140:143], v[80:87], v244
    v_exp_f32 v90, v90
    v_exp_f32 v91, v91
    v_exp_f32 v92, v92
    v_mfma_f32_32x32x16_bf16 v[228:243], v[152:155], v[176:179], v[228:243]
    ds_read_b64_tr_b16 v[148:149], v251 offset:0
    ds_read_b64_tr_b16 v[150:151], v251 offset:512
    ds_read_b64_tr_b16 v[152:153], v252 offset:0
    ds_read_b64_tr_b16 v[154:155], v252 offset:512
    v_exp_f32 v93, v93
    v_exp_f32 v94, v94
    v_exp_f32 v95, v95
    v_exp_f32 v64, v64
    v_exp_f32 v65, v65
    v_smfmac_f32_32x32x32_bf16 v[48:63], v[144:147], v[88:95], v244
    v_exp_f32 v66, v66
    v_exp_f32 v67, v67
    v_exp_f32 v68, v68
    v_mfma_f32_32x32x16_bf16 v[80:95], v[112:115], v[100:103], 0
    v_exp_f32 v69, v69
    v_exp_f32 v70, v70
    v_exp_f32 v71, v71
    v_exp_f32 v72, v72
    v_exp_f32 v73, v73
    v_smfmac_f32_32x32x32_bf16 v[0:15], v[124:127], v[64:71], v244
    s_waitcnt lgkmcnt(0)
    v_exp_f32 v74, v74
    v_exp_f32 v75, v75
    v_exp_f32 v76, v76
    v_mfma_f32_32x32x16_bf16 v[180:195], v[148:151], v[156:159], v[180:195]
    v_exp_f32 v77, v77
    v_exp_f32 v78, v78
    v_exp_f32 v79, v79
    v_exp_f32 v80, v80
    v_exp_f32 v81, v81
    v_smfmac_f32_32x32x32_bf16 v[0:15], v[128:131], v[72:79], v244
    v_exp_f32 v82, v82
    v_exp_f32 v83, v83
    v_exp_f32 v84, v84
    v_mfma_f32_32x32x16_bf16 v[64:79], v[112:115], v[104:107], 0
    v_exp_f32 v85, v85
    v_exp_f32 v86, v86
    v_exp_f32 v87, v87
    v_exp_f32 v88, v88
    v_exp_f32 v89, v89
    v_smfmac_f32_32x32x32_bf16 v[16:31], v[124:127], v[80:87], v244
    v_exp_f32 v90, v90
    v_exp_f32 v91, v91
    v_exp_f32 v92, v92
    v_mfma_f32_32x32x16_bf16 v[196:211], v[152:155], v[156:159], v[196:211]
    v_exp_f32 v93, v93
    v_exp_f32 v94, v94
    v_exp_f32 v95, v95
    v_exp_f32 v64, v64
    v_exp_f32 v65, v65
    v_smfmac_f32_32x32x32_bf16 v[16:31], v[128:131], v[88:95], v244
    v_exp_f32 v66, v66
    v_exp_f32 v67, v67
    v_exp_f32 v68, v68
    v_mfma_f32_32x32x16_bf16 v[80:95], v[112:115], v[108:111], 0
    v_exp_f32 v69, v69
    v_exp_f32 v70, v70
    v_exp_f32 v71, v71
    v_exp_f32 v72, v72
    v_exp_f32 v73, v73
    v_smfmac_f32_32x32x32_bf16 v[32:47], v[124:127], v[64:71], v244
    v_exp_f32 v74, v74
    v_exp_f32 v75, v75
    v_exp_f32 v76, v76
    v_mfma_f32_32x32x16_bf16 v[212:227], v[148:151], v[160:163], v[212:227]
    v_exp_f32 v77, v77
    v_exp_f32 v78, v78
    v_exp_f32 v79, v79
    v_exp_f32 v80, v80
    v_exp_f32 v81, v81
    v_smfmac_f32_32x32x32_bf16 v[32:47], v[128:131], v[72:79], v244
    v_exp_f32 v82, v82
    v_exp_f32 v83, v83
    v_exp_f32 v84, v84
    v_exp_f32 v85, v85
    v_exp_f32 v86, v86
    v_exp_f32 v87, v87
    v_exp_f32 v88, v88
    v_exp_f32 v89, v89
    v_smfmac_f32_32x32x32_bf16 v[48:63], v[124:127], v[80:87], v244
    v_exp_f32 v90, v90
    v_exp_f32 v91, v91
    v_exp_f32 v92, v92
    v_mfma_f32_32x32x16_bf16 v[228:243], v[152:155], v[160:163], v[228:243]
    v_exp_f32 v93, v93
    v_exp_f32 v94, v94
    v_exp_f32 v95, v95
    s_nop 1
    v_smfmac_f32_32x32x32_bf16 v[48:63], v[128:131], v[88:95], v244
    s_branch PK_join
PK_alt:
    s_waitcnt lgkmcnt(4)
    v_mfma_f32_16x16x32_bf16 v[80:83], v[8:11], v[128:131], 0
    ds_read_b64_tr_b16 v[28:29], v1 offset:37408
    v_mbcnt_lo_u32_b32 v7, -1, 0
    v_mbcnt_hi_u32_b32 v7, -1, v7
    v_mfma_f32_16x16x32_bf16 v[84:87], v[8:11], v[132:135], 0
    ds_read_b64_tr_b16 v[30:31], v1 offset:38176
    v_lshlrev_b32 v3, 4, v7
    v_mul_f32 v32, s90, v32
    v_mfma_f32_16x16x32_bf16 v[88:91], v[12:15], v[128:131], 0
    ds_read_b64_tr_b16 v[8:9], v1 offset:43456
    v_mul_f32 v33, s90, v33
    v_mul_f32 v34, s90, v34
    v_mfma_f32_16x16x32_bf16 v[92:95], v[12:15], v[132:135], 0
    ds_read_b64_tr_b16 v[10:11], v1 offset:44224
    v_mul_f32 v35, s90, v35
    v_mul_f32 v36, s90, v36
    v_mfma_f32_16x16x32_bf16 v[96:99], v[16:19], v[128:131], 0
    ds_read_b64_tr_b16 v[12:13], v1 offset:43488
    v_mul_f32 v37, s90, v37
    v_mul_f32 v38, s90, v38
    v_mfma_f32_16x16x32_bf16 v[100:103], v[16:19], v[132:135], 0
    ds_read_b64_tr_b16 v[14:15], v1 offset:44256
    v_mul_f32 v39, s90, v39
    v_mul_f32 v40, s90, v40
    s_waitcnt lgkmcnt(4)
    v_mfma_f32_16x16x32_bf16 v[104:107], v[20:23], v[128:131], 0
    ds_read_b64_tr_b16 v[16:17], v1 offset:43520
    v_mul_f32 v41, s90, v41
    v_mul_f32 v42, s90, v42
    v_mfma_f32_16x16x32_bf16 v[108:111], v[20:23], v[132:135], 0
    ds_read_b64_tr_b16 v[18:19], v1 offset:44288
    v_mul_f32 v43, s90, v43
    v_mul_f32 v44, s90, v44
    v_mfma_f32_16x16x32_bf16 v[112:115], v[24:27], v[128:131], 0
    ds_read_b64_tr_b16 v[20:21], v1 offset:43552
    v_mul_f32 v45, s90, v45
    v_mul_f32 v46, s90, v46
    v_mfma_f32_16x16x32_bf16 v[116:119], v[24:27], v[132:135], 0
    ds_read_b64_tr_b16 v[22:23], v1 offset:44320
    v_mul_f32 v47, s90, v47
    v_cvt_pk_bf16_f32 v32, v32, v33
    v_mfma_f32_16x16x32_bf16 v[120:123], v[28:31], v[128:131], 0
    ds_read_b64_tr_b16 v[24:25], v1 offset:43584
    v_cvt_pk_bf16_f32 v33, v34, v35
    v_cvt_pk_bf16_f32 v34, v36, v37
    v_mfma_f32_16x16x32_bf16 v[124:127], v[28:31], v[132:135], 0
    ds_read_b64_tr_b16 v[26:27], v1 offset:44352
    v_cvt_pk_bf16_f32 v35, v38, v39
    v_cvt_pk_bf16_f32 v40, v40, v41
    s_waitcnt lgkmcnt(4)
    v_mfma_f32_16x16x32_bf16 v[80:83], v[8:11], v[136:139], v[80:83]
    ds_read_b64_tr_b16 v[28:29], v1 offset:43616
    v_cvt_pk_bf16_f32 v41, v42, v43
    v_cvt_pk_bf16_f32 v42, v44, v45
    v_mfma_f32_16x16x32_bf16 v[84:87], v[8:11], v[140:143], v[84:87]
    ds_read_b64_tr_b16 v[30:31], v1 offset:44384
    v_cvt_pk_bf16_f32 v43, v46, v47
    v_permlane16_swap_b32 v32, v34
    v_mfma_f32_16x16x32_bf16 v[88:91], v[12:15], v[136:139], v[88:91]
    ds_read_b64_tr_b16 v[8:9], v2 offset:0
    v_permlane16_swap_b32 v33, v35
    v_permlane16_swap_b32 v40, v42
    v_mfma_f32_16x16x32_bf16 v[92:95], v[12:15], v[140:143], v[92:95]
    ds_read_b64_tr_b16 v[10:11], v2 offset:768
    v_permlane16_swap_b32 v41, v43
    v_mul_f32 v48, s91, v48
    v_mfma_f32_16x16x32_bf16 v[96:99], v[16:19], v[136:139], v[96:99]
    ds_read_b64_tr_b16 v[12:13], v2 offset:32
    v_mul_f32 v49, s91, v49
    v_mul_f32 v50, s91, v50
    v_mfma_f32_16x16x32_bf16 v[100:103], v[16:19], v[140:143], v[100:103]
    ds_read_b64_tr_b16 v[14:15], v2 offset:800
    v_mul_f32 v51, s91, v51
    v_mul_f32 v52, s91, v52
    s_waitcnt lgkmcnt(4)
    v_mfma_f32_16x16x32_bf16 v[104:107], v[20:23], v[136:139], v[104:107]
    ds_read_b64_tr_b16 v[16:17], v2 offset:64
    v_mul_f32 v53, s91, v53
    v_mul_f32 v54, s91, v54
    v_mfma_f32_16x16x32_bf16 v[108:111], v[20:23], v[140:143], v[108:111]
    ds_read_b64_tr_b16 v[18:19], v2 offset:832
    v_mul_f32 v55, s91, v55
    v_mul_f32 v56, s91, v56
    v_mfma_f32_16x16x32_bf16 v[112:115], v[24:27], v[136:139], v[112:115]
    ds_read_b64_tr_b16 v[20:21], v2 offset:96
    v_mul_f32 v57, s91, v57
    v_mul_f32 v58, s91, v58
    v_mfma_f32_16x16x32_bf16 v[116:119], v[24:27], v[140:143], v[116:119]
    ds_read_b64_tr_b16 v[22:23], v2 offset:864
    v_mul_f32 v59, s91, v59
    v_mul_f32 v60, s91, v60
    v_mfma_f32_16x16x32_bf16 v[120:123], v[28:31], v[136:139], v[120:123]
    ds_read_b64_tr_b16 v[24:25], v2 offset:128
    v_mul_f32 v61, s91, v61
    v_mul_f32 v62, s91, v62
    v_mfma_f32_16x16x32_bf16 v[124:127], v[28:31], v[140:143], v[124:127]
    ds_read_b64_tr_b16 v[26:27], v2 offset:896
    v_mul_f32 v63, s91, v63
    v_cvt_pk_bf16_f32 v48, v48, v49
    s_waitcnt lgkmcnt(4)
    v_mfma_f32_16x16x32_bf16 v[80:83], v[8:11], v[144:147], v[80:83]
    ds_read_b64_tr_b16 v[28:29], v2 offset:160
    buffer_store_dwordx4 v[32:35], v3, s[40:43], s93 offen sc1
    s_add_u32 s93, s93, 0x10000
    v_cvt_pk_bf16_f32 v49, v50, v51
    v_mfma_f32_16x16x32_bf16 v[84:87], v[8:11], v[148:151], v[84:87]
    ds_read_b64_tr_b16 v[30:31], v2 offset:928
    v_cvt_pk_bf16_f32 v50, v52, v53
    v_mfma_f32_16x16x32_bf16 v[88:91], v[12:15], v[144:147], v[88:91]
    ds_read_b64_tr_b16 v[8:9], v2 offset:6208
    v_cvt_pk_bf16_f32 v51, v54, v55
    v_cvt_pk_bf16_f32 v56, v56, v57
    v_mfma_f32_16x16x32_bf16 v[92:95], v[12:15], v[148:151], v[92:95]
    ds_read_b64_tr_b16 v[10:11], v2 offset:6976
    v_cvt_pk_bf16_f32 v57, v58, v59
    v_cvt_pk_bf16_f32 v58, v60, v61
    v_mfma_f32_16x16x32_bf16 v[96:99], v[16:19], v[144:147], v[96:99]
    ds_read_b64_tr_b16 v[12:13], v2 offset:6240
    v_cvt_pk_bf16_f32 v59, v62, v63
    v_permlane16_swap_b32 v48, v50
    v_mfma_f32_16x16x32_bf16 v[100:103], v[16:19], v[148:151], v[100:103]
    ds_read_b64_tr_b16 v[14:15], v2 offset:7008
    v_permlane16_swap_b32 v49, v51
    v_permlane16_swap_b32 v56, v58
    s_waitcnt lgkmcnt(4)
    v_mfma_f32_16x16x32_bf16 v[104:107], v[20:23], v[144:147], v[104:107]
    ds_read_b64_tr_b16 v[16:17], v2 offset:6272
    v_permlane16_swap_b32 v57, v59
    v_mul_f32 v64, s92, v64
    v_mfma_f32_16x16x32_bf16 v[108:111], v[20:23], v[148:151], v[108:111]
    ds_read_b64_tr_b16 v[18:19], v2 offset:7040
    v_mul_f32 v65, s92, v65
    v_mul_f32 v66, s92, v66
    v_mfma_f32_16x16x32_bf16 v[112:115], v[24:27], v[144:147], v[112:115]
    ds_read_b64_tr_b16 v[20:21], v2 offset:6304
    v_mul_f32 v67, s92, v67
    v_mul_f32 v68, s92, v68
    v_mfma_f32_16x16x32_bf16 v[116:119], v[24:27], v[148:151], v[116:119]
    ds_read_b64_tr_b16 v[22:23], v2 offset:7072
    v_mul_f32 v69, s92, v69
    v_mul_f32 v70, s92, v70
    v_mfma_f32_16x16x32_bf16 v[120:123], v[28:31], v[144:147], v[120:123]
    ds_read_b64_tr_b16 v[24:25], v2 offset:6336
    v_mul_f32 v71, s92, v71
    v_mul_f32 v72, s92, v72
    v_mfma_f32_16x16x32_bf16 v[124:127], v[28:31], v[148:151], v[124:127]
    ds_read_b64_tr_b16 v[26:27], v2 offset:7104
    v_mul_f32 v73, s92, v73
    v_mul_f32 v74, s92, v74
    s_waitcnt lgkmcnt(4)
    v_mfma_f32_16x16x32_bf16 v[80:83], v[8:11], v[152:155], v[80:83]
    ds_read_b64_tr_b16 v[28:29], v2 offset:6368
    buffer_store_dwordx4 v[40:43], v3, s[40:43], s93 offen sc1
    s_add_u32 s93, s93, 0x10000
    v_mul_f32 v75, s92, v75
    v_mfma_f32_16x16x32_bf16 v[84:87], v[8:11], v[156:159], v[84:87]
    ds_read_b64_tr_b16 v[30:31], v2 offset:7136
    v_mul_f32 v76, s92, v76
    v_mfma_f32_16x16x32_bf16 v[88:91], v[12:15], v[152:155], v[88:91]
    ds_read_b64_tr_b16 v[8:9], v0 offset:12416
    v_mul_f32 v77, s92, v77
    v_mul_f32 v78, s92, v78
    v_mfma_f32_16x16x32_bf16 v[92:95], v[12:15], v[156:159], v[92:95]
    ds_read_b64_tr_b16 v[10:11], v0 offset:13184
    v_mul_f32 v79, s92, v79
    v_cvt_pk_bf16_f32 v64, v64, v65
    v_mfma_f32_16x16x32_bf16 v[96:99], v[16:19], v[152:155], v[96:99]
    ds_read_b64_tr_b16 v[12:13], v0 offset:12448
    v_cvt_pk_bf16_f32 v65, v66, v67
    v_cvt_pk_bf16_f32 v66, v68, v69
    v_mfma_f32_16x16x32_bf16 v[100:103], v[16:19], v[156:159], v[100:103]
    ds_read_b64_tr_b16 v[14:15], v0 offset:13216
    v_cvt_pk_bf16_f32 v67, v70, v71
    v_cvt_pk_bf16_f32 v72, v72, v73
    s_waitcnt lgkmcnt(4)
    v_mfma_f32_16x16x32_bf16 v[104:107], v[20:23], v[152:155], v[104:107]
    ds_read_b64_tr_b16 v[16:17], v0 offset:12480
    v_cvt_pk_bf16_f32 v73, v74, v75
    v_cvt_pk_bf16_f32 v74, v76, v77
    v_mfma_f32_16x16x32_bf16 v[108:111], v[20:23], v[156:159], v[108:111]
    ds_read_b64_tr_b16 v[18:19], v0 offset:13248
    v_cvt_pk_bf16_f32 v75, v78, v79
    v_permlane16_swap_b32 v64, v66
    v_mfma_f32_16x16x32_bf16 v[112:115], v[24:27], v[152:155], v[112:115]
    ds_read_b64_tr_b16 v[20:21], v0 offset:12512
    v_permlane16_swap_b32 v65, v67
    v_permlane16_swap_b32 v72, v74
    v_mfma_f32_16x16x32_bf16 v[116:119], v[24:27], v[156:159], v[116:119]
    ds_read_b64_tr_b16 v[22:23], v0 offset:13280
    v_permlane16_swap_b32 v73, v75
    v_mfma_f32_16x16x32_bf16 v[120:123], v[28:31], v[152:155], v[120:123]
    ds_read_b64_tr_b16 v[24:25], v0 offset:12544
    v_mfma_f32_16x16x32_bf16 v[124:127], v[28:31], v[156:159], v[124:127]
    ds_read_b64_tr_b16 v[26:27], v0 offset:13312
    s_waitcnt lgkmcnt(4)
    v_mfma_f32_16x16x32_bf16 v[80:83], v[8:11], v[160:163], v[80:83]
    ds_read_b64_tr_b16 v[28:29], v0 offset:12576
    buffer_store_dwordx4 v[48:51], v3, s[40:43], s93 offen sc1
    s_add_u32 s93, s93, 0x10000
    v_mfma_f32_16x16x32_bf16 v[84:87], v[8:11], v[164:167], v[84:87]
    ds_read_b64_tr_b16 v[30:31], v0 offset:13344
    v_mfma_f32_16x16x32_bf16 v[88:91], v[12:15], v[160:163], v[88:91]
    ds_read_b64_tr_b16 v[8:9], v0 offset:18624
    v_mfma_f32_16x16x32_bf16 v[92:95], v[12:15], v[164:167], v[92:95]
    ds_read_b64_tr_b16 v[10:11], v0 offset:19392
    v_mfma_f32_16x16x32_bf16 v[96:99], v[16:19], v[160:163], v[96:99]
    ds_read_b64_tr_b16 v[12:13], v0 offset:18656
    v_mfma_f32_16x16x32_bf16 v[100:103], v[16:19], v[164:167], v[100:103]
    ds_read_b64_tr_b16 v[14:15], v0 offset:19424
    s_waitcnt lgkmcnt(4)
    v_mfma_f32_16x16x32_bf16 v[104:107], v[20:23], v[160:163], v[104:107]
    ds_read_b64_tr_b16 v[16:17], v0 offset:18688
    v_mfma_f32_16x16x32_bf16 v[108:111], v[20:23], v[164:167], v[108:111]
    ds_read_b64_tr_b16 v[18:19], v0 offset:19456
    v_mfma_f32_16x16x32_bf16 v[112:115], v[24:27], v[160:163], v[112:115]
    ds_read_b64_tr_b16 v[20:21], v0 offset:18720
    v_mfma_f32_16x16x32_bf16 v[116:119], v[24:27], v[164:167], v[116:119]
    ds_read_b64_tr_b16 v[22:23], v0 offset:19488
    v_mfma_f32_16x16x32_bf16 v[120:123], v[28:31], v[160:163], v[120:123]
    ds_read_b64_tr_b16 v[24:25], v0 offset:18752
    v_mfma_f32_16x16x32_bf16 v[124:127], v[28:31], v[164:167], v[124:127]
    ds_read_b64_tr_b16 v[26:27], v0 offset:19520
    s_waitcnt lgkmcnt(4)
    v_mfma_f32_16x16x32_bf16 v[80:83], v[8:11], v[168:171], v[80:83]
    ds_read_b64_tr_b16 v[28:29], v0 offset:18784
    buffer_store_dwordx4 v[56:59], v3, s[40:43], s93 offen sc1
    s_add_u32 s93, s93, 0x10000
    v_mfma_f32_16x16x32_bf16 v[84:87], v[8:11], v[172:175], v[84:87]
    ds_read_b64_tr_b16 v[30:31], v0 offset:19552
    v_mfma_f32_16x16x32_bf16 v[88:91], v[12:15], v[168:171], v[88:91]
    ds_read_b64_tr_b16 v[8:9], v2 offset:24832
    v_mfma_f32_16x16x32_bf16 v[92:95], v[12:15], v[172:175], v[92:95]
    ds_read_b64_tr_b16 v[10:11], v2 offset:25600
    v_mfma_f32_16x16x32_bf16 v[96:99], v[16:19], v[168:171], v[96:99]
    ds_read_b64_tr_b16 v[12:13], v2 offset:24864
    v_mfma_f32_16x16x32_bf16 v[100:103], v[16:19], v[172:175], v[100:103]
    ds_read_b64_tr_b16 v[14:15], v2 offset:25632
    s_waitcnt lgkmcnt(4)
    v_mfma_f32_16x16x32_bf16 v[104:107], v[20:23], v[168:171], v[104:107]
    ds_read_b64_tr_b16 v[16:17], v2 offset:24896
    v_mfma_f32_16x16x32_bf16 v[108:111], v[20:23], v[172:175], v[108:111]
    ds_read_b64_tr_b16 v[18:19], v2 offset:25664
    v_mfma_f32_16x16x32_bf16 v[112:115], v[24:27], v[168:171], v[112:115]
    ds_read_b64_tr_b16 v[20:21], v2 offset:24928
    v_mfma_f32_16x16x32_bf16 v[116:119], v[24:27], v[172:175], v[116:119]
    ds_read_b64_tr_b16 v[22:23], v2 offset:25696
    v_mfma_f32_16x16x32_bf16 v[120:123], v[28:31], v[168:171], v[120:123]
    ds_read_b64_tr_b16 v[24:25], v2 offset:24960
    v_mfma_f32_16x16x32_bf16 v[124:127], v[28:31], v[172:175], v[124:127]
    ds_read_b64_tr_b16 v[26:27], v2 offset:25728
    s_waitcnt lgkmcnt(4)
    v_mfma_f32_16x16x32_bf16 v[80:83], v[8:11], v[176:179], v[80:83]
    ds_read_b64_tr_b16 v[28:29], v2 offset:24992
    buffer_store_dwordx4 v[64:67], v3, s[40:43], s93 offen sc1
    s_add_u32 s93, s93, 0x10000
    v_mfma_f32_16x16x32_bf16 v[84:87], v[8:11], v[180:183], v[84:87]
    ds_read_b64_tr_b16 v[30:31], v2 offset:25760
    v_mfma_f32_16x16x32_bf16 v[88:91], v[12:15], v[176:179], v[88:91]
    ds_read_b64_tr_b16 v[8:9], v2 offset:31040
    v_mfma_f32_16x16x32_bf16 v[92:95], v[12:15], v[180:183], v[92:95]
    ds_read_b64_tr_b16 v[10:11], v2 offset:31808
    v_mfma_f32_16x16x32_bf16 v[96:99], v[16:19], v[176:179], v[96:99]
    ds_read_b64_tr_b16 v[12:13], v2 offset:31072
    v_mfma_f32_16x16x32_bf16 v[100:103], v[16:19], v[180:183], v[100:103]
    ds_read_b64_tr_b16 v[14:15], v2 offset:31840
    s_waitcnt lgkmcnt(4)
    v_mfma_f32_16x16x32_bf16 v[104:107], v[20:23], v[176:179], v[104:107]
    ds_read_b64_tr_b16 v[16:17], v2 offset:31104
    v_mfma_f32_16x16x32_bf16 v[108:111], v[20:23], v[180:183], v[108:111]
    ds_read_b64_tr_b16 v[18:19], v2 offset:31872
    v_mfma_f32_16x16x32_bf16 v[112:115], v[24:27], v[176:179], v[112:115]
    ds_read_b64_tr_b16 v[20:21], v2 offset:31136
    v_mfma_f32_16x16x32_bf16 v[116:119], v[24:27], v[180:183], v[116:119]
    ds_read_b64_tr_b16 v[22:23], v2 offset:31904
    v_mfma_f32_16x16x32_bf16 v[120:123], v[28:31], v[176:179], v[120:123]
    ds_read_b64_tr_b16 v[24:25], v2 offset:31168
    v_mfma_f32_16x16x32_bf16 v[124:127], v[28:31], v[180:183], v[124:127]
    ds_read_b64_tr_b16 v[26:27], v2 offset:31936
    s_waitcnt lgkmcnt(4)
    v_mfma_f32_16x16x32_bf16 v[80:83], v[8:11], v[184:187], v[80:83]
    ds_read_b64_tr_b16 v[28:29], v2 offset:31200
    buffer_store_dwordx4 v[72:75], v3, s[40:43], s93 offen sc1
    s_add_u32 s93, s93, 0x10000
    v_mfma_f32_16x16x32_bf16 v[84:87], v[8:11], v[188:191], v[84:87]
    ds_read_b64_tr_b16 v[30:31], v2 offset:31968
    v_mfma_f32_16x16x32_bf16 v[88:91], v[12:15], v[184:187], v[88:91]
    ds_read_b64_tr_b16 v[8:9], v0 offset:24832
    v_mfma_f32_16x16x32_bf16 v[92:95], v[12:15], v[188:191], v[92:95]
    ds_read_b64_tr_b16 v[10:11], v0 offset:25600
    v_mfma_f32_16x16x32_bf16 v[96:99], v[16:19], v[184:187], v[96:99]
    ds_read_b64_tr_b16 v[12:13], v0 offset:24864
    v_mfma_f32_16x16x32_bf16 v[100:103], v[16:19], v[188:191], v[100:103]
    ds_read_b64_tr_b16 v[14:15], v0 offset:25632
    s_waitcnt lgkmcnt(4)
    v_mfma_f32_16x16x32_bf16 v[104:107], v[20:23], v[184:187], v[104:107]
    ds_read_b64_tr_b16 v[16:17], v0 offset:24896
    v_mfma_f32_16x16x32_bf16 v[108:111], v[20:23], v[188:191], v[108:111]
    ds_read_b64_tr_b16 v[18:19], v0 offset:25664
    v_mfma_f32_16x16x32_bf16 v[112:115], v[24:27], v[184:187], v[112:115]
    ds_read_b64_tr_b16 v[20:21], v0 offset:24928
    v_mfma_f32_16x16x32_bf16 v[116:119], v[24:27], v[188:191], v[116:119]
    ds_read_b64_tr_b16 v[22:23], v0 offset:25696
    v_mfma_f32_16x16x32_bf16 v[120:123], v[28:31], v[184:187], v[120:123]
    ds_read_b64_tr_b16 v[24:25], v0 offset:24960
    v_mfma_f32_16x16x32_bf16 v[124:127], v[28:31], v[188:191], v[124:127]
    ds_read_b64_tr_b16 v[26:27], v0 offset:25728
    s_waitcnt lgkmcnt(4)
    v_mfma_f32_16x16x32_bf16 v[80:83], v[8:11], v[192:195], v[80:83]
    ds_read_b64_tr_b16 v[28:29], v0 offset:24992
    v_mfma_f32_16x16x32_bf16 v[84:87], v[8:11], v[196:199], v[84:87]
    ds_read_b64_tr_b16 v[30:31], v0 offset:25760
    v_mfma_f32_16x16x32_bf16 v[88:91], v[12:15], v[192:195], v[88:91]
    ds_read_b64_tr_b16 v[8:9], v0 offset:31040
    v_mfma_f32_16x16x32_bf16 v[92:95], v[12:15], v[196:199], v[92:95]
    ds_read_b64_tr_b16 v[10:11], v0 offset:31808
    v_mfma_f32_16x16x32_bf16 v[96:99], v[16:19], v[192:195], v[96:99]
    ds_read_b64_tr_b16 v[12:13], v0 offset:31072
    v_mfma_f32_16x16x32_bf16 v[100:103], v[16:19], v[196:199], v[100:103]
    ds_read_b64_tr_b16 v[14:15], v0 offset:31840
    s_waitcnt lgkmcnt(4)
    v_mfma_f32_16x16x32_bf16 v[104:107], v[20:23], v[192:195], v[104:107]
    ds_read_b64_tr_b16 v[16:17], v0 offset:31104
    v_mfma_f32_16x16x32_bf16 v[108:111], v[20:23], v[196:199], v[108:111]
    ds_read_b64_tr_b16 v[18:19], v0 offset:31872
    v_mfma_f32_16x16x32_bf16 v[112:115], v[24:27], v[192:195], v[112:115]
    ds_read_b64_tr_b16 v[20:21], v0 offset:31136
    v_mfma_f32_16x16x32_bf16 v[116:119], v[24:27], v[196:199], v[116:119]
    ds_read_b64_tr_b16 v[22:23], v0 offset:31904
    v_mfma_f32_16x16x32_bf16 v[120:123], v[28:31], v[192:195], v[120:123]
    ds_read_b64_tr_b16 v[24:25], v0 offset:31168
    v_mfma_f32_16x16x32_bf16 v[124:127], v[28:31], v[196:199], v[124:127]
    ds_read_b64_tr_b16 v[26:27], v0 offset:31936
    s_waitcnt lgkmcnt(4)
    v_mfma_f32_16x16x32_bf16 v[80:83], v[8:11], v[200:203], v[80:83]
    ds_read_b64_tr_b16 v[28:29], v0 offset:31200
    v_mfma_f32_16x16x32_bf16 v[84:87], v[8:11], v[204:207], v[84:87]
    ds_read_b64_tr_b16 v[30:31], v0 offset:31968
    v_mfma_f32_16x16x32_bf16 v[88:91], v[12:15], v[200:203], v[88:91]
    s_barrier
    ds_read_b64_tr_b16 v[8:9], v0 offset:37248
    v_mfma_f32_16x16x32_bf16 v[92:95], v[12:15], v[204:207], v[92:95]
    ds_read_b64_tr_b16 v[10:11], v0 offset:38016
    v_mfma_f32_16x16x32_bf16 v[96:99], v[16:19], v[200:203], v[96:99]
    ds_read_b64_tr_b16 v[12:13], v0 offset:37280
    v_mfma_f32_16x16x32_bf16 v[100:103], v[16:19], v[204:207], v[100:103]
    ds_read_b64_tr_b16 v[14:15], v0 offset:38048
    s_waitcnt lgkmcnt(4)
    v_mfma_f32_16x16x32_bf16 v[104:107], v[20:23], v[200:203], v[104:107]
    ds_read_b64_tr_b16 v[16:17], v0 offset:37312
    v_mfma_f32_16x16x32_bf16 v[108:111], v[20:23], v[204:207], v[108:111]
    ds_read_b64_tr_b16 v[18:19], v0 offset:38080
    v_mfma_f32_16x16x32_bf16 v[112:115], v[24:27], v[200:203], v[112:115]
    ds_read_b64_tr_b16 v[20:21], v0 offset:37344
    v_mfma_f32_16x16x32_bf16 v[116:119], v[24:27], v[204:207], v[116:119]
    ds_read_b64_tr_b16 v[22:23], v0 offset:38112
    v_mfma_f32_16x16x32_bf16 v[120:123], v[28:31], v[200:203], v[120:123]
    ds_read_b64_tr_b16 v[24:25], v0 offset:37376
    v_mfma_f32_16x16x32_bf16 v[124:127], v[28:31], v[204:207], v[124:127]
    ds_read_b64_tr_b16 v[26:27], v0 offset:38144
    s_waitcnt lgkmcnt(4)
    v_mfma_f32_16x16x32_bf16 v[80:83], v[8:11], v[208:211], v[80:83]
    ds_read_b64_tr_b16 v[28:29], v0 offset:37408
    v_mfma_f32_16x16x32_bf16 v[84:87], v[8:11], v[212:215], v[84:87]
    ds_read_b64_tr_b16 v[30:31], v0 offset:38176
    v_mfma_f32_16x16x32_bf16 v[88:91], v[12:15], v[208:211], v[88:91]
    ds_read_b64_tr_b16 v[8:9], v0 offset:43456
    v_mfma_f32_16x16x32_bf16 v[92:95], v[12:15], v[212:215], v[92:95]
    ds_read_b64_tr_b16 v[10:11], v0 offset:44224
    v_mfma_f32_16x16x32_bf16 v[96:99], v[16:19], v[208:211], v[96:99]
    ds_read_b64_tr_b16 v[12:13], v0 offset:43488
    v_mfma_f32_16x16x32_bf16 v[100:103], v[16:19], v[212:215], v[100:103]
    ds_read_b64_tr_b16 v[14:15], v0 offset:44256
    s_waitcnt lgkmcnt(4)
    v_mfma_f32_16x16x32_bf16 v[104:107], v[20:23], v[208:211], v[104:107]
    ds_read_b64_tr_b16 v[16:17], v0 offset:43520
    v_mfma_f32_16x16x32_bf16 v[108:111], v[20:23], v[212:215], v[108:111]
    ds_read_b64_tr_b16 v[18:19], v0 offset:44288
    v_mfma_f32_16x16x32_bf16 v[112:115], v[24:27], v[208:211], v[112:115]
    ds_read_b64_tr_b16 v[20:21], v0 offset:43552
    v_mfma_f32_16x16x32_bf16 v[116:119], v[24:27], v[212:215], v[116:119]
    ds_read_b64_tr_b16 v[22:23], v0 offset:44320
    v_mfma_f32_16x16x32_bf16 v[120:123], v[28:31], v[208:211], v[120:123]
    ds_read_b64_tr_b16 v[24:25], v0 offset:43584
    v_mfma_f32_16x16x32_bf16 v[124:127], v[28:31], v[212:215], v[124:127]
    ds_read_b64_tr_b16 v[26:27], v0 offset:44352
    s_waitcnt lgkmcnt(4)
    v_mfma_f32_16x16x32_bf16 v[80:83], v[8:11], v[216:219], v[80:83]
    ds_read_b64_tr_b16 v[28:29], v0 offset:43616
    v_mfma_f32_16x16x32_bf16 v[84:87], v[8:11], v[220:223], v[84:87]
    ds_read_b64_tr_b16 v[30:31], v0 offset:44384
    v_mfma_f32_16x16x32_bf16 v[88:91], v[12:15], v[216:219], v[88:91]
    ds_read_b64_tr_b16 v[8:9], v1 offset:0
    v_mfma_f32_16x16x32_bf16 v[92:95], v[12:15], v[220:223], v[92:95]
    ds_read_b64_tr_b16 v[10:11], v1 offset:768
    v_mfma_f32_16x16x32_bf16 v[96:99], v[16:19], v[216:219], v[96:99]
    ds_read_b64_tr_b16 v[12:13], v1 offset:32
    v_mfma_f32_16x16x32_bf16 v[100:103], v[16:19], v[220:223], v[100:103]
    ds_read_b64_tr_b16 v[14:15], v1 offset:800
    s_waitcnt lgkmcnt(4)
    v_mfma_f32_16x16x32_bf16 v[104:107], v[20:23], v[216:219], v[104:107]
    ds_read_b64_tr_b16 v[16:17], v1 offset:64
    v_mfma_f32_16x16x32_bf16 v[108:111], v[20:23], v[220:223], v[108:111]
    ds_read_b64_tr_b16 v[18:19], v1 offset:832
    v_mfma_f32_16x16x32_bf16 v[112:115], v[24:27], v[216:219], v[112:115]
    ds_read_b64_tr_b16 v[20:21], v1 offset:96
    v_mfma_f32_16x16x32_bf16 v[116:119], v[24:27], v[220:223], v[116:119]
    ds_read_b64_tr_b16 v[22:23], v1 offset:864
    v_mfma_f32_16x16x32_bf16 v[120:123], v[28:31], v[216:219], v[120:123]
    ds_read_b64_tr_b16 v[24:25], v1 offset:128
    v_mfma_f32_16x16x32_bf16 v[124:127], v[28:31], v[220:223], v[124:127]
    ds_read_b64_tr_b16 v[26:27], v1 offset:896
    s_waitcnt lgkmcnt(4)
    v_mfma_f32_16x16x32_bf16 v[80:83], v[8:11], v[224:227], v[80:83]
    ds_read_b64_tr_b16 v[28:29], v1 offset:160
    v_mfma_f32_16x16x32_bf16 v[84:87], v[8:11], v[228:231], v[84:87]
    ds_read_b64_tr_b16 v[30:31], v1 offset:928
    v_mfma_f32_16x16x32_bf16 v[88:91], v[12:15], v[224:227], v[88:91]
    ds_read_b64_tr_b16 v[8:9], v1 offset:6208
    v_mfma_f32_16x16x32_bf16 v[92:95], v[12:15], v[228:231], v[92:95]
    ds_read_b64_tr_b16 v[10:11], v1 offset:6976
    v_mfma_f32_16x16x32_bf16 v[96:99], v[16:19], v[224:227], v[96:99]
    ds_read_b64_tr_b16 v[12:13], v1 offset:6240
    v_mfma_f32_16x16x32_bf16 v[100:103], v[16:19], v[228:231], v[100:103]
    ds_read_b64_tr_b16 v[14:15], v1 offset:7008
    s_waitcnt lgkmcnt(4)
    v_mfma_f32_16x16x32_bf16 v[104:107], v[20:23], v[224:227], v[104:107]
    ds_read_b64_tr_b16 v[16:17], v1 offset:6272
    v_mfma_f32_16x16x32_bf16 v[108:111], v[20:23], v[228:231], v[108:111]
    ds_read_b64_tr_b16 v[18:19], v1 offset:7040
    v_mfma_f32_16x16x32_bf16 v[112:115], v[24:27], v[224:227], v[112:115]
    ds_read_b64_tr_b16 v[20:21], v1 offset:6304
    v_mfma_f32_16x16x32_bf16 v[116:119], v[24:27], v[228:231], v[116:119]
    ds_read_b64_tr_b16 v[22:23], v1 offset:7072
    v_mfma_f32_16x16x32_bf16 v[120:123], v[28:31], v[224:227], v[120:123]
    ds_read_b64_tr_b16 v[24:25], v1 offset:6336
    v_mfma_f32_16x16x32_bf16 v[124:127], v[28:31], v[228:231], v[124:127]
    ds_read_b64_tr_b16 v[26:27], v1 offset:7104
    s_waitcnt lgkmcnt(4)
    v_mfma_f32_16x16x32_bf16 v[80:83], v[8:11], v[232:235], v[80:83]
    ds_read_b64_tr_b16 v[28:29], v1 offset:6368
    v_mfma_f32_16x16x32_bf16 v[84:87], v[8:11], v[236:239], v[84:87]
    ds_read_b64_tr_b16 v[30:31], v1 offset:7136
    v_mfma_f32_16x16x32_bf16 v[88:91], v[12:15], v[232:235], v[88:91]
    ds_read_b64_tr_b16 v[8:9], v1 offset:12416
    v_mfma_f32_16x16x32_bf16 v[92:95], v[12:15], v[236:239], v[92:95]
    ds_read_b64_tr_b16 v[10:11], v1 offset:13184
    v_mfma_f32_16x16x32_bf16 v[96:99], v[16:19], v[232:235], v[96:99]
    ds_read_b64_tr_b16 v[12:13], v1 offset:12448
    v_mfma_f32_16x16x32_bf16 v[100:103], v[16:19], v[236:239], v[100:103]
    ds_read_b64_tr_b16 v[14:15], v1 offset:13216
    s_waitcnt lgkmcnt(4)
    v_mfma_f32_16x16x32_bf16 v[104:107], v[20:23], v[232:235], v[104:107]
    ds_read_b64_tr_b16 v[16:17], v1 offset:12480
    v_mfma_f32_16x16x32_bf16 v[108:111], v[20:23], v[236:239], v[108:111]
    ds_read_b64_tr_b16 v[18:19], v1 offset:13248
    v_mfma_f32_16x16x32_bf16 v[112:115], v[24:27], v[232:235], v[112:115]
    ds_read_b64_tr_b16 v[20:21], v1 offset:12512
    v_mfma_f32_16x16x32_bf16 v[116:119], v[24:27], v[236:239], v[116:119]
    ds_read_b64_tr_b16 v[22:23], v1 offset:13280
    v_mfma_f32_16x16x32_bf16 v[120:123], v[28:31], v[232:235], v[120:123]
    ds_read_b64_tr_b16 v[24:25], v1 offset:12544
    v_mfma_f32_16x16x32_bf16 v[124:127], v[28:31], v[236:239], v[124:127]
    ds_read_b64_tr_b16 v[26:27], v1 offset:13312
    s_waitcnt lgkmcnt(4)
    v_mfma_f32_16x16x32_bf16 v[80:83], v[8:11], v[240:243], v[80:83]
    ds_read_b64_tr_b16 v[28:29], v1 offset:12576
    v_mfma_f32_16x16x32_bf16 v[84:87], v[8:11], v[244:247], v[84:87]
    ds_read_b64_tr_b16 v[30:31], v1 offset:13344
    s_waitcnt vmcnt(0)
    v_mov_b32 v3, 0
    v_mov_b32 v4, 1
    s_mov_b64 exec, 1
    buffer_store_dword v4, v3, s[40:43], s95 offen sc1
    s_mov_b64 exec, -1
    v_mfma_f32_16x16x32_bf16 v[88:91], v[12:15], v[240:243], v[88:91]
    ds_read_b64_tr_b16 v[8:9], v1 offset:18624
    v_mfma_f32_16x16x32_bf16 v[92:95], v[12:15], v[244:247], v[92:95]
    ds_read_b64_tr_b16 v[10:11], v1 offset:19392
    v_mfma_f32_16x16x32_bf16 v[96:99], v[16:19], v[240:243], v[96:99]
    ds_read_b64_tr_b16 v[12:13], v1 offset:18656
    v_mfma_f32_16x16x32_bf16 v[100:103], v[16:19], v[244:247], v[100:103]
    ds_read_b64_tr_b16 v[14:15], v1 offset:19424
    s_waitcnt lgkmcnt(4)
    v_mfma_f32_16x16x32_bf16 v[104:107], v[20:23], v[240:243], v[104:107]
    ds_read_b64_tr_b16 v[16:17], v1 offset:18688
    v_mfma_f32_16x16x32_bf16 v[108:111], v[20:23], v[244:247], v[108:111]
    ds_read_b64_tr_b16 v[18:19], v1 offset:19456
    v_mfma_f32_16x16x32_bf16 v[112:115], v[24:27], v[240:243], v[112:115]
    ds_read_b64_tr_b16 v[20:21], v1 offset:18720
    v_mfma_f32_16x16x32_bf16 v[116:119], v[24:27], v[244:247], v[116:119]
    ds_read_b64_tr_b16 v[22:23], v1 offset:19488
    v_mfma_f32_16x16x32_bf16 v[120:123], v[28:31], v[240:243], v[120:123]
    ds_read_b64_tr_b16 v[24:25], v1 offset:18752
    v_mfma_f32_16x16x32_bf16 v[124:127], v[28:31], v[244:247], v[124:127]
    ds_read_b64_tr_b16 v[26:27], v1 offset:19520
    s_waitcnt lgkmcnt(4)
    v_mfma_f32_16x16x32_bf16 v[80:83], v[8:11], v[248:251], v[80:83]
    ds_read_b64_tr_b16 v[28:29], v1 offset:18784
    v_mfma_f32_16x16x32_bf16 v[84:87], v[8:11], v[252:255], v[84:87]
    ds_read_b64_tr_b16 v[30:31], v1 offset:19552
    v_mfma_f32_16x16x32_bf16 v[88:91], v[12:15], v[248:251], v[88:91]
    ds_read_b64_tr_b16 v[8:9], v2 offset:12416
    v_mfma_f32_16x16x32_bf16 v[92:95], v[12:15], v[252:255], v[92:95]
    ds_read_b64_tr_b16 v[10:11], v2 offset:13184
    v_mfma_f32_16x16x32_bf16 v[96:99], v[16:19], v[248:251], v[96:99]
    ds_read_b64_tr_b16 v[12:13], v2 offset:12448
    v_mfma_f32_16x16x32_bf16 v[100:103], v[16:19], v[252:255], v[100:103]
    ds_read_b64_tr_b16 v[14:15], v2 offset:13216
    s_waitcnt lgkmcnt(4)
    v_mfma_f32_16x16x32_bf16 v[104:107], v[20:23], v[248:251], v[104:107]
    ds_read_b64_tr_b16 v[16:17], v2 offset:12480
    v_mfma_f32_16x16x32_bf16 v[108:111], v[20:23], v[252:255], v[108:111]
    ds_read_b64_tr_b16 v[18:19], v2 offset:13248
    v_mfma_f32_16x16x32_bf16 v[112:115], v[24:27], v[248:251], v[112:115]
    ds_read_b64_tr_b16 v[20:21], v2 offset:12512
    v_mfma_f32_16x16x32_bf16 v[116:119], v[24:27], v[252:255], v[116:119]
    ds_read_b64_tr_b16 v[22:23], v2 offset:13280
    v_mfma_f32_16x16x32_bf16 v[120:123], v[28:31], v[248:251], v[120:123]
    ds_read_b64_tr_b16 v[24:25], v2 offset:12544
    v_mfma_f32_16x16x32_bf16 v[124:127], v[28:31], v[252:255], v[124:127]
    ds_read_b64_tr_b16 v[26:27], v2 offset:13312
    s_nop 0
    s_branch PK_part2
PK_kkv:
    s_waitcnt lgkmcnt(4)
    v_mfma_f32_16x16x32_bf16 v[80:83], v[8:11], v[128:131], 0
    ds_read_b64_tr_b16 v[28:29], v1 offset:37408
    v_mbcnt_lo_u32_b32 v7, -1, 0
    v_mbcnt_hi_u32_b32 v7, -1, v7
    v_mfma_f32_16x16x32_bf16 v[84:87], v[8:11], v[132:135], 0
    ds_read_b64_tr_b16 v[30:31], v1 offset:38176
    v_and_b32 v4, 31, v7
    v_mul_u32_u24 v4, 80, v4
    v_mfma_f32_16x16x32_bf16 v[88:91], v[12:15], v[128:131], 0
    ds_read_b64_tr_b16 v[8:9], v1 offset:43456
    v_lshrrev_b32 v3, 5, v7
    v_lshl_add_u32 v4, v3, 4, v4
    v_mfma_f32_16x16x32_bf16 v[92:95], v[12:15], v[132:135], 0
    ds_read_b64_tr_b16 v[10:11], v1 offset:44224
    v_add_u32 v4, s94, v4
    v_lshrrev_b32 v3, 5, v7
    v_mfma_f32_16x16x32_bf16 v[96:99], v[16:19], v[128:131], 0
    ds_read_b64_tr_b16 v[12:13], v1 offset:43488
    v_bfe_u32 v6, v7, 2, 2
    v_lshl_add_u32 v3, v3, 3, v6
    v_mfma_f32_16x16x32_bf16 v[100:103], v[16:19], v[132:135], 0
    ds_read_b64_tr_b16 v[14:15], v1 offset:44256
    v_mul_u32_u24 v5, 80, v3
    v_bfe_u32 v3, v7, 4, 1
    s_waitcnt lgkmcnt(4)
    v_mfma_f32_16x16x32_bf16 v[104:107], v[20:23], v[128:131], 0
    ds_read_b64_tr_b16 v[16:17], v1 offset:43520
    v_lshl_add_u32 v5, v3, 5, v5
    v_and_b32 v3, 1, v7
    v_mfma_f32_16x16x32_bf16 v[108:111], v[20:23], v[132:135], 0
    ds_read_b64_tr_b16 v[18:19], v1 offset:44288
    v_lshl_add_u32 v5, v3, 4, v5
    v_bfe_u32 v3, v7, 1, 1
    v_mfma_f32_16x16x32_bf16 v[112:115], v[24:27], v[128:131], 0
    ds_read_b64_tr_b16 v[20:21], v1 offset:43552
    v_lshl_add_u32 v5, v3, 3, v5
    v_add_u32 v5, s94, v5
    v_mfma_f32_16x16x32_bf16 v[116:119], v[24:27], v[132:135], 0
    ds_read_b64_tr_b16 v[22:23], v1 offset:44320
    v_bfe_u32 v6, v7, 4, 1
    v_lshlrev_b32 v6, 16, v6
    v_mfma_f32_16x16x32_bf16 v[120:123], v[28:31], v[128:131], 0
    ds_read_b64_tr_b16 v[24:25], v1 offset:43584
    v_lshrrev_b32 v3, 5, v7
    v_lshl_add_u32 v6, v3, 8, v6
    v_mfma_f32_16x16x32_bf16 v[124:127], v[28:31], v[132:135], 0
    ds_read_b64_tr_b16 v[26:27], v1 offset:44352
    v_and_b32 v3, 15, v7
    v_lshl_add_u32 v6, v3, 4, v6
    s_waitcnt lgkmcnt(4)
    v_mfma_f32_16x16x32_bf16 v[80:83], v[8:11], v[136:139], v[80:83]
    ds_read_b64_tr_b16 v[28:29], v1 offset:43616
    v_lshlrev_b32 v3, 4, v7
    v_cvt_pk_bf16_f32 v32, v32, v33
    v_mfma_f32_16x16x32_bf16 v[84:87], v[8:11], v[140:143], v[84:87]
    ds_read_b64_tr_b16 v[30:31], v1 offset:44384
    v_cvt_pk_bf16_f32 v33, v34, v35
    v_cvt_pk_bf16_f32 v34, v36, v37
    v_mfma_f32_16x16x32_bf16 v[88:91], v[12:15], v[136:139], v[88:91]
    ds_read_b64_tr_b16 v[8:9], v2 offset:0
    v_cvt_pk_bf16_f32 v35, v38, v39
    v_cvt_pk_bf16_f32 v40, v40, v41
    v_mfma_f32_16x16x32_bf16 v[92:95], v[12:15], v[140:143], v[92:95]
    ds_read_b64_tr_b16 v[10:11], v2 offset:768
    v_cvt_pk_bf16_f32 v41, v42, v43
    v_cvt_pk_bf16_f32 v42, v44, v45
    v_mfma_f32_16x16x32_bf16 v[96:99], v[16:19], v[136:139], v[96:99]
    ds_read_b64_tr_b16 v[12:13], v2 offset:32
    v_cvt_pk_bf16_f32 v43, v46, v47
    v_permlane16_swap_b32 v32, v34
    v_mfma_f32_16x16x32_bf16 v[100:103], v[16:19], v[140:143], v[100:103]
    ds_read_b64_tr_b16 v[14:15], v2 offset:800
    v_permlane16_swap_b32 v33, v35
    v_permlane16_swap_b32 v40, v42
    s_waitcnt lgkmcnt(4)
    v_mfma_f32_16x16x32_bf16 v[104:107], v[20:23], v[136:139], v[104:107]
    ds_read_b64_tr_b16 v[16:17], v2 offset:64
    v_permlane16_swap_b32 v41, v43
    v_cvt_pk_bf16_f32 v48, v48, v49
    v_mfma_f32_16x16x32_bf16 v[108:111], v[20:23], v[140:143], v[108:111]
    ds_read_b64_tr_b16 v[18:19], v2 offset:832
    v_cvt_pk_bf16_f32 v49, v50, v51
    v_cvt_pk_bf16_f32 v50, v52, v53
    v_mfma_f32_16x16x32_bf16 v[112:115], v[24:27], v[136:139], v[112:115]
    ds_read_b64_tr_b16 v[20:21], v2 offset:96
    v_cvt_pk_bf16_f32 v51, v54, v55
    v_cvt_pk_bf16_f32 v56, v56, v57
    v_mfma_f32_16x16x32_bf16 v[116:119], v[24:27], v[140:143], v[116:119]
    ds_read_b64_tr_b16 v[22:23], v2 offset:864
    v_cvt_pk_bf16_f32 v57, v58, v59
    v_cvt_pk_bf16_f32 v58, v60, v61
    v_mfma_f32_16x16x32_bf16 v[120:123], v[28:31], v[136:139], v[120:123]
    ds_read_b64_tr_b16 v[24:25], v2 offset:128
    v_cvt_pk_bf16_f32 v59, v62, v63
    v_permlane16_swap_b32 v48, v50
    v_mfma_f32_16x16x32_bf16 v[124:127], v[28:31], v[140:143], v[124:127]
    ds_read_b64_tr_b16 v[26:27], v2 offset:896
    v_permlane16_swap_b32 v49, v51
    v_permlane16_swap_b32 v56, v58
    s_waitcnt lgkmcnt(4)
    v_mfma_f32_16x16x32_bf16 v[80:83], v[8:11], v[144:147], v[80:83]
    ds_read_b64_tr_b16 v[28:29], v2 offset:160
    buffer_store_dwordx4 v[32:35], v3, s[40:43], s93 offen sc1
    s_add_u32 s93, s93, 0x10000
    v_permlane16_swap_b32 v57, v59
    v_mfma_f32_16x16x32_bf16 v[84:87], v[8:11], v[148:151], v[84:87]
    ds_read_b64_tr_b16 v[30:31], v2 offset:928
    v_cvt_pk_bf16_f32 v64, v64, v65
    v_mfma_f32_16x16x32_bf16 v[88:91], v[12:15], v[144:147], v[88:91]
    ds_read_b64_tr_b16 v[8:9], v2 offset:6208
    v_cvt_pk_bf16_f32 v65, v66, v67
    v_cvt_pk_bf16_f32 v66, v68, v69
    v_mfma_f32_16x16x32_bf16 v[92:95], v[12:15], v[148:151], v[92:95]
    ds_read_b64_tr_b16 v[10:11], v2 offset:6976
    v_cvt_pk_bf16_f32 v67, v70, v71
    v_cvt_pk_bf16_f32 v72, v72, v73
    v_mfma_f32_16x16x32_bf16 v[96:99], v[16:19], v[144:147], v[96:99]
    ds_read_b64_tr_b16 v[12:13], v2 offset:6240
    v_cvt_pk_bf16_f32 v73, v74, v75
    v_cvt_pk_bf16_f32 v74, v76, v77
    v_mfma_f32_16x16x32_bf16 v[100:103], v[16:19], v[148:151], v[100:103]
    ds_read_b64_tr_b16 v[14:15], v2 offset:7008
    v_cvt_pk_bf16_f32 v75, v78, v79
    v_permlane16_swap_b32 v64, v66
    s_waitcnt lgkmcnt(4)
    v_mfma_f32_16x16x32_bf16 v[104:107], v[20:23], v[144:147], v[104:107]
    ds_read_b64_tr_b16 v[16:17], v2 offset:6272
    v_permlane16_swap_b32 v65, v67
    v_permlane16_swap_b32 v72, v74
    v_mfma_f32_16x16x32_bf16 v[108:111], v[20:23], v[148:151], v[108:111]
    ds_read_b64_tr_b16 v[18:19], v2 offset:7040
    v_permlane16_swap_b32 v73, v75
    v_mfma_f32_16x16x32_bf16 v[112:115], v[24:27], v[144:147], v[112:115]
    ds_read_b64_tr_b16 v[20:21], v2 offset:6304
    ds_write_b128 v4, v[64:67]
    ds_write_b128 v4, v[72:75] offset:32
    v_mfma_f32_16x16x32_bf16 v[116:119], v[24:27], v[148:151], v[116:119]
    ds_read_b64_tr_b16 v[22:23], v2 offset:7072
    v_mfma_f32_16x16x32_bf16 v[120:123], v[28:31], v[144:147], v[120:123]
    ds_read_b64_tr_b16 v[24:25], v2 offset:6336
    v_mfma_f32_16x16x32_bf16 v[124:127], v[28:31], v[148:151], v[124:127]
    ds_read_b64_tr_b16 v[26:27], v2 offset:7104
    s_waitcnt lgkmcnt(6)
    v_mfma_f32_16x16x32_bf16 v[80:83], v[8:11], v[152:155], v[80:83]
    ds_read_b64_tr_b16 v[28:29], v2 offset:6368
    buffer_store_dwordx4 v[40:43], v3, s[40:43], s93 offen sc1
    s_add_u32 s93, s93, 0x10000
    v_mfma_f32_16x16x32_bf16 v[84:87], v[8:11], v[156:159], v[84:87]
    ds_read_b64_tr_b16 v[30:31], v2 offset:7136
    v_mfma_f32_16x16x32_bf16 v[88:91], v[12:15], v[152:155], v[88:91]
    ds_read_b64_tr_b16 v[8:9], v0 offset:12416
    s_waitcnt lgkmcnt(6)
    ds_read_b64_tr_b16 v[68:69], v5 offset:0
    ds_read_b64_tr_b16 v[70:71], v5 offset:320
    ds_read_b64_tr_b16 v[76:77], v5 offset:1280
    v_mfma_f32_16x16x32_bf16 v[92:95], v[12:15], v[156:159], v[92:95]
    ds_read_b64_tr_b16 v[10:11], v0 offset:13184
    v_mfma_f32_16x16x32_bf16 v[96:99], v[16:19], v[152:155], v[96:99]
    ds_read_b64_tr_b16 v[12:13], v0 offset:12448
    ds_read_b64_tr_b16 v[78:79], v5 offset:1600
    v_mfma_f32_16x16x32_bf16 v[100:103], v[16:19], v[156:159], v[100:103]
    ds_read_b64_tr_b16 v[14:15], v0 offset:13216
    s_waitcnt lgkmcnt(8)
    v_mfma_f32_16x16x32_bf16 v[104:107], v[20:23], v[152:155], v[104:107]
    ds_read_b64_tr_b16 v[16:17], v0 offset:12480
    v_mfma_f32_16x16x32_bf16 v[108:111], v[20:23], v[156:159], v[108:111]
    ds_read_b64_tr_b16 v[18:19], v0 offset:13248
    v_mfma_f32_16x16x32_bf16 v[112:115], v[24:27], v[152:155], v[112:115]
    ds_read_b64_tr_b16 v[20:21], v0 offset:12512
    s_waitcnt lgkmcnt(4)
    v_mfma_f32_16x16x32_bf16 v[116:119], v[24:27], v[156:159], v[116:119]
    ds_read_b64_tr_b16 v[22:23], v0 offset:13280
    v_mfma_f32_16x16x32_bf16 v[120:123], v[28:31], v[152:155], v[120:123]
    ds_read_b64_tr_b16 v[24:25], v0 offset:12544
    v_mfma_f32_16x16x32_bf16 v[124:127], v[28:31], v[156:159], v[124:127]
    ds_read_b64_tr_b16 v[26:27], v0 offset:13312
    s_waitcnt lgkmcnt(4)
    v_mfma_f32_16x16x32_bf16 v[80:83], v[8:11], v[160:163], v[80:83]
    ds_read_b64_tr_b16 v[28:29], v0 offset:12576
    buffer_store_dwordx4 v[48:51], v3, s[40:43], s93 offen sc1
    s_add_u32 s93, s93, 0x10000
    v_mfma_f32_16x16x32_bf16 v[84:87], v[8:11], v[164:167], v[84:87]
    ds_read_b64_tr_b16 v[30:31], v0 offset:13344
    v_mfma_f32_16x16x32_bf16 v[88:91], v[12:15], v[160:163], v[88:91]
    ds_read_b64_tr_b16 v[8:9], v0 offset:18624
    v_mfma_f32_16x16x32_bf16 v[92:95], v[12:15], v[164:167], v[92:95]
    ds_read_b64_tr_b16 v[10:11], v0 offset:19392
    v_mfma_f32_16x16x32_bf16 v[96:99], v[16:19], v[160:163], v[96:99]
    ds_read_b64_tr_b16 v[12:13], v0 offset:18656
    v_mfma_f32_16x16x32_bf16 v[100:103], v[16:19], v[164:167], v[100:103]
    ds_read_b64_tr_b16 v[14:15], v0 offset:19424
    s_waitcnt lgkmcnt(4)
    v_mfma_f32_16x16x32_bf16 v[104:107], v[20:23], v[160:163], v[104:107]
    ds_read_b64_tr_b16 v[16:17], v0 offset:18688
    v_mfma_f32_16x16x32_bf16 v[108:111], v[20:23], v[164:167], v[108:111]
    ds_read_b64_tr_b16 v[18:19], v0 offset:19456
    v_mfma_f32_16x16x32_bf16 v[112:115], v[24:27], v[160:163], v[112:115]
    ds_read_b64_tr_b16 v[20:21], v0 offset:18720
    v_mfma_f32_16x16x32_bf16 v[116:119], v[24:27], v[164:167], v[116:119]
    ds_read_b64_tr_b16 v[22:23], v0 offset:19488
    v_mfma_f32_16x16x32_bf16 v[120:123], v[28:31], v[160:163], v[120:123]
    ds_read_b64_tr_b16 v[24:25], v0 offset:18752
    v_mfma_f32_16x16x32_bf16 v[124:127], v[28:31], v[164:167], v[124:127]
    ds_read_b64_tr_b16 v[26:27], v0 offset:19520
    s_waitcnt lgkmcnt(4)
    v_mfma_f32_16x16x32_bf16 v[80:83], v[8:11], v[168:171], v[80:83]
    ds_read_b64_tr_b16 v[28:29], v0 offset:18784
    buffer_store_dwordx4 v[56:59], v3, s[40:43], s93 offen sc1
    s_add_u32 s93, s93, 0x10000
    v_mfma_f32_16x16x32_bf16 v[84:87], v[8:11], v[172:175], v[84:87]
    ds_read_b64_tr_b16 v[30:31], v0 offset:19552
    v_mfma_f32_16x16x32_bf16 v[88:91], v[12:15], v[168:171], v[88:91]
    ds_read_b64_tr_b16 v[8:9], v2 offset:24832
    v_mfma_f32_16x16x32_bf16 v[92:95], v[12:15], v[172:175], v[92:95]
    ds_read_b64_tr_b16 v[10:11], v2 offset:25600
    v_mfma_f32_16x16x32_bf16 v[96:99], v[16:19], v[168:171], v[96:99]
    ds_read_b64_tr_b16 v[12:13], v2 offset:24864
    v_mfma_f32_16x16x32_bf16 v[100:103], v[16:19], v[172:175], v[100:103]
    ds_read_b64_tr_b16 v[14:15], v2 offset:25632
    s_waitcnt lgkmcnt(4)
    v_mfma_f32_16x16x32_bf16 v[104:107], v[20:23], v[168:171], v[104:107]
    ds_read_b64_tr_b16 v[16:17], v2 offset:24896
    v_mfma_f32_16x16x32_bf16 v[108:111], v[20:23], v[172:175], v[108:111]
    ds_read_b64_tr_b16 v[18:19], v2 offset:25664
    v_mfma_f32_16x16x32_bf16 v[112:115], v[24:27], v[168:171], v[112:115]
    ds_read_b64_tr_b16 v[20:21], v2 offset:24928
    v_mfma_f32_16x16x32_bf16 v[116:119], v[24:27], v[172:175], v[116:119]
    ds_read_b64_tr_b16 v[22:23], v2 offset:25696
    v_mfma_f32_16x16x32_bf16 v[120:123], v[28:31], v[168:171], v[120:123]
    ds_read_b64_tr_b16 v[24:25], v2 offset:24960
    v_mfma_f32_16x16x32_bf16 v[124:127], v[28:31], v[172:175], v[124:127]
    ds_read_b64_tr_b16 v[26:27], v2 offset:25728
    s_waitcnt lgkmcnt(4)
    v_mfma_f32_16x16x32_bf16 v[80:83], v[8:11], v[176:179], v[80:83]
    ds_read_b64_tr_b16 v[28:29], v2 offset:24992
    buffer_store_dwordx4 v[68:71], v6, s[40:43], s93 offen sc1
    v_mfma_f32_16x16x32_bf16 v[84:87], v[8:11], v[180:183], v[84:87]
    ds_read_b64_tr_b16 v[30:31], v2 offset:25760
    v_mfma_f32_16x16x32_bf16 v[88:91], v[12:15], v[176:179], v[88:91]
    ds_read_b64_tr_b16 v[8:9], v2 offset:31040
    v_mfma_f32_16x16x32_bf16 v[92:95], v[12:15], v[180:183], v[92:95]
    ds_read_b64_tr_b16 v[10:11], v2 offset:31808
    v_mfma_f32_16x16x32_bf16 v[96:99], v[16:19], v[176:179], v[96:99]
    ds_read_b64_tr_b16 v[12:13], v2 offset:31072
    v_mfma_f32_16x16x32_bf16 v[100:103], v[16:19], v[180:183], v[100:103]
    ds_read_b64_tr_b16 v[14:15], v2 offset:31840
    s_waitcnt lgkmcnt(4)
    v_mfma_f32_16x16x32_bf16 v[104:107], v[20:23], v[176:179], v[104:107]
    ds_read_b64_tr_b16 v[16:17], v2 offset:31104
    v_mfma_f32_16x16x32_bf16 v[108:111], v[20:23], v[180:183], v[108:111]
    ds_read_b64_tr_b16 v[18:19], v2 offset:31872
    v_mfma_f32_16x16x32_bf16 v[112:115], v[24:27], v[176:179], v[112:115]
    ds_read_b64_tr_b16 v[20:21], v2 offset:31136
    v_mfma_f32_16x16x32_bf16 v[116:119], v[24:27], v[180:183], v[116:119]
    ds_read_b64_tr_b16 v[22:23], v2 offset:31904
    v_mfma_f32_16x16x32_bf16 v[120:123], v[28:31], v[176:179], v[120:123]
    ds_read_b64_tr_b16 v[24:25], v2 offset:31168
    v_mfma_f32_16x16x32_bf16 v[124:127], v[28:31], v[180:183], v[124:127]
    ds_read_b64_tr_b16 v[26:27], v2 offset:31936
    s_waitcnt lgkmcnt(4)
    v_mfma_f32_16x16x32_bf16 v[80:83], v[8:11], v[184:187], v[80:83]
    ds_read_b64_tr_b16 v[28:29], v2 offset:31200
    buffer_store_dwordx4 v[76:79], v6, s[40:43], s93 offen offset:512 sc1
    s_add_u32 s93, s93, 0x20000
    v_mfma_f32_16x16x32_bf16 v[84:87], v[8:11], v[188:191], v[84:87]
    ds_read_b64_tr_b16 v[30:31], v2 offset:31968
    v_mfma_f32_16x16x32_bf16 v[88:91], v[12:15], v[184:187], v[88:91]
    ds_read_b64_tr_b16 v[8:9], v0 offset:24832
    v_mfma_f32_16x16x32_bf16 v[92:95], v[12:15], v[188:191], v[92:95]
    ds_read_b64_tr_b16 v[10:11], v0 offset:25600
    v_mfma_f32_16x16x32_bf16 v[96:99], v[16:19], v[184:187], v[96:99]
    ds_read_b64_tr_b16 v[12:13], v0 offset:24864
    v_mfma_f32_16x16x32_bf16 v[100:103], v[16:19], v[188:191], v[100:103]
    ds_read_b64_tr_b16 v[14:15], v0 offset:25632
    s_waitcnt lgkmcnt(4)
    v_mfma_f32_16x16x32_bf16 v[104:107], v[20:23], v[184:187], v[104:107]
    ds_read_b64_tr_b16 v[16:17], v0 offset:24896
    v_mfma_f32_16x16x32_bf16 v[108:111], v[20:23], v[188:191], v[108:111]
    ds_read_b64_tr_b16 v[18:19], v0 offset:25664
    v_mfma_f32_16x16x32_bf16 v[112:115], v[24:27], v[184:187], v[112:115]
    ds_read_b64_tr_b16 v[20:21], v0 offset:24928
    v_mfma_f32_16x16x32_bf16 v[116:119], v[24:27], v[188:191], v[116:119]
    ds_read_b64_tr_b16 v[22:23], v0 offset:25696
    v_mfma_f32_16x16x32_bf16 v[120:123], v[28:31], v[184:187], v[120:123]
    ds_read_b64_tr_b16 v[24:25], v0 offset:24960
    v_mfma_f32_16x16x32_bf16 v[124:127], v[28:31], v[188:191], v[124:127]
    ds_read_b64_tr_b16 v[26:27], v0 offset:25728
    s_waitcnt lgkmcnt(4)
    v_mfma_f32_16x16x32_bf16 v[80:83], v[8:11], v[192:195], v[80:83]
    ds_read_b64_tr_b16 v[28:29], v0 offset:24992
    v_mfma_f32_16x16x32_bf16 v[84:87], v[8:11], v[196:199], v[84:87]
    ds_read_b64_tr_b16 v[30:31], v0 offset:25760
    v_mfma_f32_16x16x32_bf16 v[88:91], v[12:15], v[192:195], v[88:91]
    ds_read_b64_tr_b16 v[8:9], v0 offset:31040
    v_mfma_f32_16x16x32_bf16 v[92:95], v[12:15], v[196:199], v[92:95]
    ds_read_b64_tr_b16 v[10:11], v0 offset:31808
    v_mfma_f32_16x16x32_bf16 v[96:99], v[16:19], v[192:195], v[96:99]
    ds_read_b64_tr_b16 v[12:13], v0 offset:31072
    v_mfma_f32_16x16x32_bf16 v[100:103], v[16:19], v[196:199], v[100:103]
    ds_read_b64_tr_b16 v[14:15], v0 offset:31840
    s_waitcnt lgkmcnt(4)
    v_mfma_f32_16x16x32_bf16 v[104:107], v[20:23], v[192:195], v[104:107]
    ds_read_b64_tr_b16 v[16:17], v0 offset:31104
    v_mfma_f32_16x16x32_bf16 v[108:111], v[20:23], v[196:199], v[108:111]
    ds_read_b64_tr_b16 v[18:19], v0 offset:31872
    v_mfma_f32_16x16x32_bf16 v[112:115], v[24:27], v[192:195], v[112:115]
    ds_read_b64_tr_b16 v[20:21], v0 offset:31136
    v_mfma_f32_16x16x32_bf16 v[116:119], v[24:27], v[196:199], v[116:119]
    ds_read_b64_tr_b16 v[22:23], v0 offset:31904
    v_mfma_f32_16x16x32_bf16 v[120:123], v[28:31], v[192:195], v[120:123]
    ds_read_b64_tr_b16 v[24:25], v0 offset:31168
    v_mfma_f32_16x16x32_bf16 v[124:127], v[28:31], v[196:199], v[124:127]
    ds_read_b64_tr_b16 v[26:27], v0 offset:31936
    s_waitcnt lgkmcnt(4)
    v_mfma_f32_16x16x32_bf16 v[80:83], v[8:11], v[200:203], v[80:83]
    ds_read_b64_tr_b16 v[28:29], v0 offset:31200
    v_mfma_f32_16x16x32_bf16 v[84:87], v[8:11], v[204:207], v[84:87]
    ds_read_b64_tr_b16 v[30:31], v0 offset:31968
    v_mfma_f32_16x16x32_bf16 v[88:91], v[12:15], v[200:203], v[88:91]
    s_barrier
    ds_read_b64_tr_b16 v[8:9], v0 offset:37248
    v_mfma_f32_16x16x32_bf16 v[92:95], v[12:15], v[204:207], v[92:95]
    ds_read_b64_tr_b16 v[10:11], v0 offset:38016
    v_mfma_f32_16x16x32_bf16 v[96:99], v[16:19], v[200:203], v[96:99]
    ds_read_b64_tr_b16 v[12:13], v0 offset:37280
    v_mfma_f32_16x16x32_bf16 v[100:103], v[16:19], v[204:207], v[100:103]
    ds_read_b64_tr_b16 v[14:15], v0 offset:38048
    s_waitcnt lgkmcnt(4)
    v_mfma_f32_16x16x32_bf16 v[104:107], v[20:23], v[200:203], v[104:107]
    ds_read_b64_tr_b16 v[16:17], v0 offset:37312
    v_mfma_f32_16x16x32_bf16 v[108:111], v[20:23], v[204:207], v[108:111]
    ds_read_b64_tr_b16 v[18:19], v0 offset:38080
    v_mfma_f32_16x16x32_bf16 v[112:115], v[24:27], v[200:203], v[112:115]
    ds_read_b64_tr_b16 v[20:21], v0 offset:37344
    v_mfma_f32_16x16x32_bf16 v[116:119], v[24:27], v[204:207], v[116:119]
    ds_read_b64_tr_b16 v[22:23], v0 offset:38112
    v_mfma_f32_16x16x32_bf16 v[120:123], v[28:31], v[200:203], v[120:123]
    ds_read_b64_tr_b16 v[24:25], v0 offset:37376
    v_mfma_f32_16x16x32_bf16 v[124:127], v[28:31], v[204:207], v[124:127]
    ds_read_b64_tr_b16 v[26:27], v0 offset:38144
    s_waitcnt lgkmcnt(4)
    v_mfma_f32_16x16x32_bf16 v[80:83], v[8:11], v[208:211], v[80:83]
    ds_read_b64_tr_b16 v[28:29], v0 offset:37408
    v_mfma_f32_16x16x32_bf16 v[84:87], v[8:11], v[212:215], v[84:87]
    ds_read_b64_tr_b16 v[30:31], v0 offset:38176
    v_mfma_f32_16x16x32_bf16 v[88:91], v[12:15], v[208:211], v[88:91]
    ds_read_b64_tr_b16 v[8:9], v0 offset:43456
    v_mfma_f32_16x16x32_bf16 v[92:95], v[12:15], v[212:215], v[92:95]
    ds_read_b64_tr_b16 v[10:11], v0 offset:44224
    v_mfma_f32_16x16x32_bf16 v[96:99], v[16:19], v[208:211], v[96:99]
    ds_read_b64_tr_b16 v[12:13], v0 offset:43488
    v_mfma_f32_16x16x32_bf16 v[100:103], v[16:19], v[212:215], v[100:103]
    ds_read_b64_tr_b16 v[14:15], v0 offset:44256
    s_waitcnt lgkmcnt(4)
    v_mfma_f32_16x16x32_bf16 v[104:107], v[20:23], v[208:211], v[104:107]
    ds_read_b64_tr_b16 v[16:17], v0 offset:43520
    v_mfma_f32_16x16x32_bf16 v[108:111], v[20:23], v[212:215], v[108:111]
    ds_read_b64_tr_b16 v[18:19], v0 offset:44288
    v_mfma_f32_16x16x32_bf16 v[112:115], v[24:27], v[208:211], v[112:115]
    ds_read_b64_tr_b16 v[20:21], v0 offset:43552
    v_mfma_f32_16x16x32_bf16 v[116:119], v[24:27], v[212:215], v[116:119]
    ds_read_b64_tr_b16 v[22:23], v0 offset:44320
    v_mfma_f32_16x16x32_bf16 v[120:123], v[28:31], v[208:211], v[120:123]
    ds_read_b64_tr_b16 v[24:25], v0 offset:43584
    v_mfma_f32_16x16x32_bf16 v[124:127], v[28:31], v[212:215], v[124:127]
    ds_read_b64_tr_b16 v[26:27], v0 offset:44352
    s_waitcnt lgkmcnt(4)
    v_mfma_f32_16x16x32_bf16 v[80:83], v[8:11], v[216:219], v[80:83]
    ds_read_b64_tr_b16 v[28:29], v0 offset:43616
    v_mfma_f32_16x16x32_bf16 v[84:87], v[8:11], v[220:223], v[84:87]
    ds_read_b64_tr_b16 v[30:31], v0 offset:44384
    v_mfma_f32_16x16x32_bf16 v[88:91], v[12:15], v[216:219], v[88:91]
    ds_read_b64_tr_b16 v[8:9], v1 offset:0
    v_mfma_f32_16x16x32_bf16 v[92:95], v[12:15], v[220:223], v[92:95]
    ds_read_b64_tr_b16 v[10:11], v1 offset:768
    v_mfma_f32_16x16x32_bf16 v[96:99], v[16:19], v[216:219], v[96:99]
    ds_read_b64_tr_b16 v[12:13], v1 offset:32
    v_mfma_f32_16x16x32_bf16 v[100:103], v[16:19], v[220:223], v[100:103]
    ds_read_b64_tr_b16 v[14:15], v1 offset:800
    s_waitcnt lgkmcnt(4)
    v_mfma_f32_16x16x32_bf16 v[104:107], v[20:23], v[216:219], v[104:107]
    ds_read_b64_tr_b16 v[16:17], v1 offset:64
    v_mfma_f32_16x16x32_bf16 v[108:111], v[20:23], v[220:223], v[108:111]
    ds_read_b64_tr_b16 v[18:19], v1 offset:832
    v_mfma_f32_16x16x32_bf16 v[112:115], v[24:27], v[216:219], v[112:115]
    ds_read_b64_tr_b16 v[20:21], v1 offset:96
    v_mfma_f32_16x16x32_bf16 v[116:119], v[24:27], v[220:223], v[116:119]
    ds_read_b64_tr_b16 v[22:23], v1 offset:864
    v_mfma_f32_16x16x32_bf16 v[120:123], v[28:31], v[216:219], v[120:123]
    ds_read_b64_tr_b16 v[24:25], v1 offset:128
    v_mfma_f32_16x16x32_bf16 v[124:127], v[28:31], v[220:223], v[124:127]
    ds_read_b64_tr_b16 v[26:27], v1 offset:896
    s_waitcnt lgkmcnt(4)
    v_mfma_f32_16x16x32_bf16 v[80:83], v[8:11], v[224:227], v[80:83]
    ds_read_b64_tr_b16 v[28:29], v1 offset:160
    v_mfma_f32_16x16x32_bf16 v[84:87], v[8:11], v[228:231], v[84:87]
    ds_read_b64_tr_b16 v[30:31], v1 offset:928
    v_mfma_f32_16x16x32_bf16 v[88:91], v[12:15], v[224:227], v[88:91]
    ds_read_b64_tr_b16 v[8:9], v1 offset:6208
    v_mfma_f32_16x16x32_bf16 v[92:95], v[12:15], v[228:231], v[92:95]
    ds_read_b64_tr_b16 v[10:11], v1 offset:6976
    v_mfma_f32_16x16x32_bf16 v[96:99], v[16:19], v[224:227], v[96:99]
    ds_read_b64_tr_b16 v[12:13], v1 offset:6240
    v_mfma_f32_16x16x32_bf16 v[100:103], v[16:19], v[228:231], v[100:103]
    ds_read_b64_tr_b16 v[14:15], v1 offset:7008
    s_waitcnt lgkmcnt(4)
    v_mfma_f32_16x16x32_bf16 v[104:107], v[20:23], v[224:227], v[104:107]
    ds_read_b64_tr_b16 v[16:17], v1 offset:6272
    v_mfma_f32_16x16x32_bf16 v[108:111], v[20:23], v[228:231], v[108:111]
    ds_read_b64_tr_b16 v[18:19], v1 offset:7040
    v_mfma_f32_16x16x32_bf16 v[112:115], v[24:27], v[224:227], v[112:115]
    ds_read_b64_tr_b16 v[20:21], v1 offset:6304
    v_mfma_f32_16x16x32_bf16 v[116:119], v[24:27], v[228:231], v[116:119]
    ds_read_b64_tr_b16 v[22:23], v1 offset:7072
    v_mfma_f32_16x16x32_bf16 v[120:123], v[28:31], v[224:227], v[120:123]
    ds_read_b64_tr_b16 v[24:25], v1 offset:6336
    v_mfma_f32_16x16x32_bf16 v[124:127], v[28:31], v[228:231], v[124:127]
    ds_read_b64_tr_b16 v[26:27], v1 offset:7104
    s_waitcnt lgkmcnt(4)
    v_mfma_f32_16x16x32_bf16 v[80:83], v[8:11], v[232:235], v[80:83]
    ds_read_b64_tr_b16 v[28:29], v1 offset:6368
    v_mfma_f32_16x16x32_bf16 v[84:87], v[8:11], v[236:239], v[84:87]
    ds_read_b64_tr_b16 v[30:31], v1 offset:7136
    v_mfma_f32_16x16x32_bf16 v[88:91], v[12:15], v[232:235], v[88:91]
    ds_read_b64_tr_b16 v[8:9], v1 offset:12416
    v_mfma_f32_16x16x32_bf16 v[92:95], v[12:15], v[236:239], v[92:95]
    ds_read_b64_tr_b16 v[10:11], v1 offset:13184
    v_mfma_f32_16x16x32_bf16 v[96:99], v[16:19], v[232:235], v[96:99]
    ds_read_b64_tr_b16 v[12:13], v1 offset:12448
    v_mfma_f32_16x16x32_bf16 v[100:103], v[16:19], v[236:239], v[100:103]
    ds_read_b64_tr_b16 v[14:15], v1 offset:13216
    s_waitcnt lgkmcnt(4)
    v_mfma_f32_16x16x32_bf16 v[104:107], v[20:23], v[232:235], v[104:107]
    ds_read_b64_tr_b16 v[16:17], v1 offset:12480
    v_mfma_f32_16x16x32_bf16 v[108:111], v[20:23], v[236:239], v[108:111]
    ds_read_b64_tr_b16 v[18:19], v1 offset:13248
    v_mfma_f32_16x16x32_bf16 v[112:115], v[24:27], v[232:235], v[112:115]
    ds_read_b64_tr_b16 v[20:21], v1 offset:12512
    v_mfma_f32_16x16x32_bf16 v[116:119], v[24:27], v[236:239], v[116:119]
    ds_read_b64_tr_b16 v[22:23], v1 offset:13280
    v_mfma_f32_16x16x32_bf16 v[120:123], v[28:31], v[232:235], v[120:123]
    ds_read_b64_tr_b16 v[24:25], v1 offset:12544
    v_mfma_f32_16x16x32_bf16 v[124:127], v[28:31], v[236:239], v[124:127]
    ds_read_b64_tr_b16 v[26:27], v1 offset:13312
    s_waitcnt lgkmcnt(4)
    v_mfma_f32_16x16x32_bf16 v[80:83], v[8:11], v[240:243], v[80:83]
    ds_read_b64_tr_b16 v[28:29], v1 offset:12576
    v_mfma_f32_16x16x32_bf16 v[84:87], v[8:11], v[244:247], v[84:87]
    ds_read_b64_tr_b16 v[30:31], v1 offset:13344
    s_waitcnt vmcnt(0)
    v_mov_b32 v3, 0
    v_mov_b32 v4, 1
    s_mov_b64 exec, 1
    buffer_store_dword v4, v3, s[40:43], s95 offen sc1
    s_mov_b64 exec, -1
    v_mfma_f32_16x16x32_bf16 v[88:91], v[12:15], v[240:243], v[88:91]
    ds_read_b64_tr_b16 v[8:9], v1 offset:18624
    v_mfma_f32_16x16x32_bf16 v[92:95], v[12:15], v[244:247], v[92:95]
    ds_read_b64_tr_b16 v[10:11], v1 offset:19392
    v_mfma_f32_16x16x32_bf16 v[96:99], v[16:19], v[240:243], v[96:99]
    ds_read_b64_tr_b16 v[12:13], v1 offset:18656
    v_mfma_f32_16x16x32_bf16 v[100:103], v[16:19], v[244:247], v[100:103]
    ds_read_b64_tr_b16 v[14:15], v1 offset:19424
    s_waitcnt lgkmcnt(4)
    v_mfma_f32_16x16x32_bf16 v[104:107], v[20:23], v[240:243], v[104:107]
    ds_read_b64_tr_b16 v[16:17], v1 offset:18688
    v_mfma_f32_16x16x32_bf16 v[108:111], v[20:23], v[244:247], v[108:111]
    ds_read_b64_tr_b16 v[18:19], v1 offset:19456
    v_mfma_f32_16x16x32_bf16 v[112:115], v[24:27], v[240:243], v[112:115]
    ds_read_b64_tr_b16 v[20:21], v1 offset:18720
    v_mfma_f32_16x16x32_bf16 v[116:119], v[24:27], v[244:247], v[116:119]
    ds_read_b64_tr_b16 v[22:23], v1 offset:19488
    v_mfma_f32_16x16x32_bf16 v[120:123], v[28:31], v[240:243], v[120:123]
    ds_read_b64_tr_b16 v[24:25], v1 offset:18752
    v_mfma_f32_16x16x32_bf16 v[124:127], v[28:31], v[244:247], v[124:127]
    ds_read_b64_tr_b16 v[26:27], v1 offset:19520
    s_waitcnt lgkmcnt(4)
    v_mfma_f32_16x16x32_bf16 v[80:83], v[8:11], v[248:251], v[80:83]
    ds_read_b64_tr_b16 v[28:29], v1 offset:18784
    v_mfma_f32_16x16x32_bf16 v[84:87], v[8:11], v[252:255], v[84:87]
    ds_read_b64_tr_b16 v[30:31], v1 offset:19552
    v_mfma_f32_16x16x32_bf16 v[88:91], v[12:15], v[248:251], v[88:91]
    ds_read_b64_tr_b16 v[8:9], v2 offset:12416
    v_mfma_f32_16x16x32_bf16 v[92:95], v[12:15], v[252:255], v[92:95]
    ds_read_b64_tr_b16 v[10:11], v2 offset:13184
    v_mfma_f32_16x16x32_bf16 v[96:99], v[16:19], v[248:251], v[96:99]
    ds_read_b64_tr_b16 v[12:13], v2 offset:12448
    v_mfma_f32_16x16x32_bf16 v[100:103], v[16:19], v[252:255], v[100:103]
    ds_read_b64_tr_b16 v[14:15], v2 offset:13216
    s_waitcnt lgkmcnt(4)
    v_mfma_f32_16x16x32_bf16 v[104:107], v[20:23], v[248:251], v[104:107]
    ds_read_b64_tr_b16 v[16:17], v2 offset:12480
    v_mfma_f32_16x16x32_bf16 v[108:111], v[20:23], v[252:255], v[108:111]
    ds_read_b64_tr_b16 v[18:19], v2 offset:13248
    v_mfma_f32_16x16x32_bf16 v[112:115], v[24:27], v[248:251], v[112:115]
    ds_read_b64_tr_b16 v[20:21], v2 offset:12512
    v_mfma_f32_16x16x32_bf16 v[116:119], v[24:27], v[252:255], v[116:119]
    ds_read_b64_tr_b16 v[22:23], v2 offset:13280
    v_mfma_f32_16x16x32_bf16 v[120:123], v[28:31], v[248:251], v[120:123]
    ds_read_b64_tr_b16 v[24:25], v2 offset:12544
    v_mfma_f32_16x16x32_bf16 v[124:127], v[28:31], v[252:255], v[124:127]
    ds_read_b64_tr_b16 v[26:27], v2 offset:13312
    s_nop 0
    s_branch PK_part2
PK_loader:
    v_mov_b32 v247, v0
    s_and_b32 s38, s24, 3
    s_lshl_b32 s33, s101, 2
    v_add_u32 v65, 0, v247
    v_mul_u32_u24 v66, 43691, v65
    v_lshrrev_b32 v66, 19, v66
    v_mul_u32_u24 v67, 12, v66
    v_sub_u32 v67, v65, v67
    v_cmp_gt_u32 vcc, s33, v67
    v_lshlrev_b32 v67, 4, v67
    v_subrev_u32 v67, 0, v67
    v_mul_u32_u24 v65, 3072, v66
    v_add_u32 v68, v65, v67
    v_mul_u32_u24 v66, 2752, v66
    v_add_u32 v66, v66, v67
    v_mov_b32 v65, 0x40000000
    v_cndmask_b32 v72, v65, v66, vcc
    v_add_u32 v65, 64, v247
    v_mul_u32_u24 v66, 43691, v65
    v_lshrrev_b32 v66, 19, v66
    v_mul_u32_u24 v67, 12, v66
    v_sub_u32 v67, v65, v67
    v_cmp_gt_u32 vcc, s33, v67
    v_lshlrev_b32 v67, 4, v67
    v_subrev_u32 v67, 1024, v67
    v_mul_u32_u24 v65, 3072, v66
    v_add_u32 v69, v65, v67
    v_mul_u32_u24 v66, 2752, v66
    v_add_u32 v66, v66, v67
    v_mov_b32 v65, 0x40000000
    v_cndmask_b32 v73, v65, v66, vcc
    v_add_u32 v65, 128, v247
    v_mul_u32_u24 v66, 43691, v65
    v_lshrrev_b32 v66, 19, v66
    v_mul_u32_u24 v67, 12, v66
    v_sub_u32 v67, v65, v67
    v_cmp_gt_u32 vcc, s33, v67
    v_lshlrev_b32 v67, 4, v67
    v_subrev_u32 v67, 2048, v67
    v_mul_u32_u24 v65, 3072, v66
    v_add_u32 v70, v65, v67
    v_mul_u32_u24 v66, 2752, v66
    v_add_u32 v66, v66, v67
    v_mov_b32 v65, 0x40000000
    v_cndmask_b32 v74, v65, v66, vcc
    s_mul_i32 s34, s38, 49152
    s_mul_i32 s32, s3, 192
    s_add_u32 s34, s34, s32
    s_mul_i32 s35, s38, 44032
    s_lshl_b32 s32, s100, 6
    s_add_u32 s35, s35, s32
    s_mul_i32 s37, s38, 3104
    s_waitcnt lgkmcnt(0)
    s_mov_b32 s44, s6
    s_and_b32 s45, s7, 0xffff
    s_mov_b32 s46, 1572864
    s_mov_b32 s47, 0x20000
    s_mov_b32 s48, s12
    s_and_b32 s49, s13, 0xffff
    s_mov_b32 s50, 1409024
    s_mov_b32 s51, 0x20000
    s_mov_b32 s56, s14
    s_and_b32 s57, s15, 0xffff
    s_mov_b32 s58, 1409024
    s_mov_b32 s59, 0x20000
    v_lshlrev_b32 v245, 4, v247
    v_lshrrev_b32 v249, 5, v247
    v_and_b32 v250, 15, v247
    v_lshlrev_b32 v250, 4, v250
    v_lshl_add_u32 v246, v249, 8, v250
    v_and_b32 v250, 31, v247
    v_lshlrev_b32 v250, 10, v250
    v_lshl_add_u32 v248, v249, 4, v250
    v_and_b32 v249, 27, v247
    v_cmp_eq_u32 vcc, 16, v249
    v_mov_b32 v249, s62
    s_nop 0
    v_cndmask_b32 v124, 0, v249, vcc
    v_mov_b32 v125, v124
    v_mov_b32 v126, v124
    v_mov_b32 v127, v124
    v_mov_b32 v128, v124
    v_mov_b32 v129, v124
    v_mov_b32 v130, v124
    v_mov_b32 v131, v124
    v_mov_b32 v132, v124
    v_mov_b32 v133, v124
    v_mov_b32 v134, v124
    v_mov_b32 v135, v124
    v_mov_b32 v136, v124
    v_mov_b32 v137, v124
    v_mov_b32 v138, v124
    v_mov_b32 v139, v124
    v_mov_b32 v140, v124
    v_mov_b32 v141, v124
    v_mov_b32 v142, v124
    v_mov_b32 v143, v124
    v_mov_b32 v144, v124
    v_mov_b32 v145, v124
    v_mov_b32 v146, v124
    v_mov_b32 v147, v124
    v_mov_b32 v88, 0
    v_mov_b32 v89, 0
    v_mov_b32 v90, 0
    v_mov_b32 v91, 0
    v_mov_b32 v244, 0xdddddddd
    s_nop 0
    v_mfma_f32_32x32x16_bf16 v[0:15], v[88:91], v[88:91], 0
    v_mfma_f32_32x32x16_bf16 v[16:31], v[88:91], v[88:91], 0
    v_mfma_f32_32x32x16_bf16 v[32:47], v[88:91], v[88:91], 0
    v_mfma_f32_32x32x16_bf16 v[48:63], v[88:91], v[88:91], 0
    s_lshr_b32 s32, s27, 1
    v_and_b32 v184, 7, v247
    s_lshl_b32 s33, s28, 3
    v_add_u32 v184, s33, v184
    v_and_b32 v190, 15, v247
    v_lshlrev_b32 v190, 4, v190
    s_add_u32 s33, s32, 0
    s_mul_i32 s33, s33, 21846
    s_lshr_b32 s33, s33, 16
    s_lshl_b32 s33, s33, 8
    s_add_u32 s33, s33, 16252928
    v_lshl_add_u32 v184, v184, 2, s33
    s_add_u32 s33, s32, 16
    s_mul_i32 s33, s33, 21846
    s_lshr_b32 s33, s33, 16
    s_lshl_b32 s33, s33, 8
    s_add_u32 s33, s33, 16252928
    v_lshl_add_u32 v185, v247, 2, s33
    s_add_u32 s33, s32, 32
    s_mul_i32 s33, s33, 21846
    s_lshr_b32 s33, s33, 16
    s_lshl_b32 s33, s33, 8
    s_add_u32 s33, s33, 16252928
    v_lshl_add_u32 v186, v247, 2, s33
    v_lshrrev_b32 v251, 3, v247
    v_lshlrev_b32 v251, 10, v251
    v_and_b32 v252, 7, v247
    v_bfe_u32 v253, v247, 4, 1
    v_lshlrev_b32 v253, 2, v253
    v_xor_b32 v252, v252, v253
    v_lshl_add_u32 v249, v252, 4, v251
    v_add_u32 v250, 7168, v249
    v_lshrrev_b32 v252, 5, v247
    v_bfe_u32 v253, v247, 2, 2
    v_lshl_add_u32 v252, v252, 3, v253
    v_mul_u32_u24 v251, 128, v252
    v_bfe_u32 v252, v247, 4, 1
    v_lshl_add_u32 v251, v252, 5, v251
    v_and_b32 v252, 1, v247
    v_lshl_add_u32 v251, v252, 4, v251
    v_bfe_u32 v252, v247, 1, 1
    v_lshl_add_u32 v251, v252, 3, v251
    v_bfe_u32 v252, v247, 3, 1
    v_lshl_add_u32 v251, v252, 6, v251
    s_and_b32 s32, s24, 3
    s_lshl_b32 s33, s32, 5
    v_xor_b32 v251, s33, v251
    s_lshl_b32 s33, s32, 14
    v_add_u32 v251, s33, v251
    v_xor_b32 v252, 64, v251
    s_add_u32 s32, s29, 0
    s_and_b32 s32, s32, 7
    s_mul_i32 s32, s32, 196608
    s_add_u32 m0, s37, 0
    s_add_u32 s32, s32, s34
    buffer_load_dwordx4 v68, s[44:47], s32 offen offset:0 lds
    buffer_load_dwordx4 v69, s[44:47], s32 offen offset:1024 lds
    buffer_load_dwordx4 v70, s[44:47], s32 offen offset:2048 lds
    s_add_u32 s32, s29, 1
    s_and_b32 s32, s32, 7
    s_mul_i32 s32, s32, 196608
    s_add_u32 m0, s37, 12416
    s_add_u32 s32, s32, s34
    buffer_load_dwordx4 v68, s[44:47], s32 offen offset:0 lds
    buffer_load_dwordx4 v69, s[44:47], s32 offen offset:1024 lds
    buffer_load_dwordx4 v70, s[44:47], s32 offen offset:2048 lds
    s_add_u32 s32, s29, 2
    s_and_b32 s32, s32, 7
    s_mul_i32 s32, s32, 196608
    s_add_u32 m0, s37, 24832
    s_add_u32 s32, s32, s34
    buffer_load_dwordx4 v68, s[44:47], s32 offen offset:0 lds
    buffer_load_dwordx4 v69, s[44:47], s32 offen offset:1024 lds
    buffer_load_dwordx4 v70, s[44:47], s32 offen offset:2048 lds
    s_add_u32 s32, s29, 3
    s_and_b32 s32, s32, 7
    s_mul_i32 s32, s32, 196608
    s_add_u32 m0, s37, 37248
    s_add_u32 s32, s32, s34
    buffer_load_dwordx4 v68, s[44:47], s32 offen offset:0 lds
    buffer_load_dwordx4 v69, s[44:47], s32 offen offset:1024 lds
    buffer_load_dwordx4 v70, s[44:47], s32 offen offset:2048 lds
    s_mov_b32 s40, s22
    s_and_b32 s41, s23, 0xffff
    s_mov_b32 s42, 16777216
    s_mov_b32 s43, 0x20000
    s_waitcnt vmcnt(9)
    s_barrier
    s_add_u32 s32, s29, 4
    s_and_b32 s32, s32, 7
    s_mul_i32 s32, s32, 196608
    s_add_u32 m0, s37, 49664
    s_add_u32 s32, s32, s34
    buffer_load_dwordx4 v68, s[44:47], s32 offen offset:0 lds
    buffer_load_dwordx4 v69, s[44:47], s32 offen offset:1024 lds
    buffer_load_dwordx4 v70, s[44:47], s32 offen offset:2048 lds
    s_add_u32 s32, s29, 5
    s_and_b32 s32, s32, 7
    s_mul_i32 s32, s32, 196608
    s_add_u32 m0, s37, 62080
    s_add_u32 s32, s32, s34
    buffer_load_dwordx4 v68, s[44:47], s32 offen offset:0 lds
    buffer_load_dwordx4 v69, s[44:47], s32 offen offset:1024 lds
    buffer_load_dwordx4 v70, s[44:47], s32 offen offset:2048 lds
    s_add_u32 s32, s29, 6
    s_and_b32 s32, s32, 7
    s_mul_i32 s32, s32, 196608
    s_add_u32 m0, s37, 74496
    s_add_u32 s32, s32, s34
    buffer_load_dwordx4 v68, s[44:47], s32 offen offset:0 lds
    buffer_load_dwordx4 v69, s[44:47], s32 offen offset:1024 lds
    buffer_load_dwordx4 v70, s[44:47], s32 offen offset:2048 lds
    s_lshl_b32 s32, s3, 8
    s_lshl_b32 s33, s25, 4
    s_add_u32 s32, s32, s33
    s_add_u32 s32, s32, 16252928
    v_lshl_add_u32 v76, v247, 2, s32
    s_lshl_b32 s32, s25, 8
    s_lshl_b32 s33, s26, 2
    s_add_u32 s32, s32, s33
    s_add_u32 s32, s32, 16318464
    v_lshl_add_u32 v77, v247, 6, s32
    s_bitcmp1_b32 s38, 0
    s_cselect_b64 vcc, -1, 0
    v_mov_b32 v79, 0
    v_mov_b32 v80, 159744
    v_cndmask_b32 v76, v76, v77, vcc
    s_mov_b64 exec, 15
    buffer_store_dword v79, v76, s[40:43], 0 offen sc1
    ds_write_b32 v80, v79
    s_mov_b64 exec, -1
    s_lshl_b32 s32, s28, 3
    s_add_u32 s32, s32, s38
    s_lshl_b32 s32, s32, 5
    s_add_u32 s32, s32, s27
    s_lshl_b32 s32, s32, 10
    s_add_u32 s32, s32, 6291456
    s_add_u32 s33, s32, 131072
    v_mov_b32 v84, -1
    v_mov_b32 v85, -1
    v_mov_b32 v86, -1
    v_mov_b32 v87, -1
    buffer_store_dwordx4 v[84:87], v245, s[40:43], s32 offen sc1
    buffer_store_dwordx4 v[84:87], v245, s[40:43], s33 offen sc1
    s_waitcnt vmcnt(15)
    s_barrier
    s_add_u32 s32, s29, 0
    s_and_b32 s32, s32, 7
    s_mul_i32 s32, s32, 176128
    s_add_u32 m0, s37, 86912
    s_add_u32 s32, s32, s35
    buffer_load_dwordx4 v72, s[48:51], s32 offen offset:0 lds
    buffer_load_dwordx4 v73, s[48:51], s32 offen offset:1024 lds
    buffer_load_dwordx4 v74, s[48:51], s32 offen offset:2048 lds
    s_add_u32 s32, s29, 1
    s_and_b32 s32, s32, 7
    s_mul_i32 s32, s32, 176128
    s_add_u32 m0, s37, 99328
    s_add_u32 s32, s32, s35
    buffer_load_dwordx4 v72, s[48:51], s32 offen offset:0 lds
    buffer_load_dwordx4 v73, s[48:51], s32 offen offset:1024 lds
    buffer_load_dwordx4 v74, s[48:51], s32 offen offset:2048 lds
    s_add_u32 s32, s29, 0
    s_and_b32 s32, s32, 7
    s_mul_i32 s32, s32, 176128
    s_add_u32 m0, s37, 111744
    s_add_u32 s32, s32, s35
    buffer_load_dwordx4 v72, s[56:59], s32 offen offset:0 lds
    buffer_load_dwordx4 v73, s[56:59], s32 offen offset:1024 lds
    buffer_load_dwordx4 v74, s[56:59], s32 offen offset:2048 lds
    s_waitcnt vmcnt(15)
    s_barrier
    s_add_u32 s32, s29, 7
    s_and_b32 s32, s32, 7
    s_mul_i32 s32, s32, 196608
    s_add_u32 m0, s37, 0
    s_add_u32 s32, s32, s34
    buffer_load_dwordx4 v68, s[44:47], s32 offen offset:0 lds
    buffer_load_dwordx4 v69, s[44:47], s32 offen offset:1024 lds
    buffer_load_dwordx4 v70, s[44:47], s32 offen offset:2048 lds
    s_add_u32 s32, s29, 2
    s_and_b32 s32, s32, 7
    s_mul_i32 s32, s32, 176128
    s_add_u32 m0, s37, 12416
    s_add_u32 s32, s32, s35
    buffer_load_dwordx4 v72, s[48:51], s32 offen offset:0 lds
    buffer_load_dwordx4 v73, s[48:51], s32 offen offset:1024 lds
    buffer_load_dwordx4 v74, s[48:51], s32 offen offset:2048 lds
    s_add_u32 s32, s29, 3
    s_and_b32 s32, s32, 7
    s_mul_i32 s32, s32, 176128
    s_add_u32 m0, s37, 124160
    s_add_u32 s32, s32, s35
    buffer_load_dwordx4 v72, s[48:51], s32 offen offset:0 lds
    buffer_load_dwordx4 v73, s[48:51], s32 offen offset:1024 lds
    buffer_load_dwordx4 v74, s[48:51], s32 offen offset:2048 lds
    s_add_u32 s32, s29, 1
    s_and_b32 s32, s32, 7
    s_mul_i32 s32, s32, 176128
    s_add_u32 m0, s37, 136576
    s_add_u32 s32, s32, s35
    buffer_load_dwordx4 v72, s[56:59], s32 offen offset:0 lds
    buffer_load_dwordx4 v73, s[56:59], s32 offen offset:1024 lds
    buffer_load_dwordx4 v74, s[56:59], s32 offen offset:2048 lds
    s_waitcnt vmcnt(9)
    s_waitcnt lgkmcnt(0)
    s_barrier
    s_add_u32 s32, s29, 4
    s_and_b32 s32, s32, 7
    s_mul_i32 s32, s32, 176128
    s_add_u32 m0, s37, 24832
    s_add_u32 s32, s32, s35
    buffer_load_dwordx4 v72, s[48:51], s32 offen offset:0 lds
    buffer_load_dwordx4 v73, s[48:51], s32 offen offset:1024 lds
    buffer_load_dwordx4 v74, s[48:51], s32 offen offset:2048 lds
    s_add_u32 s32, s29, 5
    s_and_b32 s32, s32, 7
    s_mul_i32 s32, s32, 176128
    s_add_u32 m0, s37, 37248
    s_add_u32 s32, s32, s35
    buffer_load_dwordx4 v72, s[48:51], s32 offen offset:0 lds
    buffer_load_dwordx4 v73, s[48:51], s32 offen offset:1024 lds
    buffer_load_dwordx4 v74, s[48:51], s32 offen offset:2048 lds
    s_add_u32 s32, s29, 6
    s_and_b32 s32, s32, 7
    s_mul_i32 s32, s32, 176128
    s_add_u32 m0, s37, 49664
    s_add_u32 s32, s32, s35
    buffer_load_dwordx4 v72, s[48:51], s32 offen offset:0 lds
    buffer_load_dwordx4 v73, s[48:51], s32 offen offset:1024 lds
    buffer_load_dwordx4 v74, s[48:51], s32 offen offset:2048 lds
    s_waitcnt vmcnt(6)
    s_barrier
    s_add_u32 s32, s29, 7
    s_and_b32 s32, s32, 7
    s_mul_i32 s32, s32, 176128
    s_add_u32 m0, s37, 62080
    s_add_u32 s32, s32, s35
    buffer_load_dwordx4 v72, s[48:51], s32 offen offset:0 lds
    buffer_load_dwordx4 v73, s[48:51], s32 offen offset:1024 lds
    buffer_load_dwordx4 v74, s[48:51], s32 offen offset:2048 lds
    s_add_u32 s32, s29, 2
    s_and_b32 s32, s32, 7
    s_mul_i32 s32, s32, 176128
    s_add_u32 m0, s37, 74496
    s_add_u32 s32, s32, s35
    buffer_load_dwordx4 v72, s[56:59], s32 offen offset:0 lds
    buffer_load_dwordx4 v73, s[56:59], s32 offen offset:1024 lds
    buffer_load_dwordx4 v74, s[56:59], s32 offen offset:2048 lds
    s_waitcnt vmcnt(3)
    s_barrier
    s_add_u32 s32, s29, 3
    s_and_b32 s32, s32, 7
    s_mul_i32 s32, s32, 176128
    s_add_u32 m0, s37, 0
    s_add_u32 s32, s32, s35
    buffer_load_dwordx4 v72, s[56:59], s32 offen offset:0 lds
    buffer_load_dwordx4 v73, s[56:59], s32 offen offset:1024 lds
    buffer_load_dwordx4 v74, s[56:59], s32 offen offset:2048 lds
    s_add_u32 s32, s29, 4
    s_and_b32 s32, s32, 7
    s_mul_i32 s32, s32, 176128
    s_add_u32 m0, s37, 12416
    s_add_u32 s32, s32, s35
    buffer_load_dwordx4 v72, s[56:59], s32 offen offset:0 lds
    buffer_load_dwordx4 v73, s[56:59], s32 offen offset:1024 lds
    buffer_load_dwordx4 v74, s[56:59], s32 offen offset:2048 lds
    s_add_u32 s32, s29, 5
    s_and_b32 s32, s32, 7
    s_mul_i32 s32, s32, 176128
    s_add_u32 m0, s37, 86912
    s_add_u32 s32, s32, s35
    buffer_load_dwordx4 v72, s[56:59], s32 offen offset:0 lds
    buffer_load_dwordx4 v73, s[56:59], s32 offen offset:1024 lds
    buffer_load_dwordx4 v74, s[56:59], s32 offen offset:2048 lds
    s_add_u32 s32, s29, 6
    s_and_b32 s32, s32, 7
    s_mul_i32 s32, s32, 176128
    s_add_u32 m0, s37, 99328
    s_add_u32 s32, s32, s35
    buffer_load_dwordx4 v72, s[56:59], s32 offen offset:0 lds
    buffer_load_dwordx4 v73, s[56:59], s32 offen offset:1024 lds
    buffer_load_dwordx4 v74, s[56:59], s32 offen offset:2048 lds
    s_add_u32 s32, s29, 7
    s_and_b32 s32, s32, 7
    s_mul_i32 s32, s32, 176128
    s_add_u32 m0, s37, 124160
    s_add_u32 s32, s32, s35
    buffer_load_dwordx4 v72, s[56:59], s32 offen offset:0 lds
    buffer_load_dwordx4 v73, s[56:59], s32 offen offset:1024 lds
    buffer_load_dwordx4 v74, s[56:59], s32 offen offset:2048 lds
    s_waitcnt vmcnt(0)
    s_barrier
    s_lshl_b32 s36, s27, 16
    s_add_u32 s44, s36, 2097152
    s_add_u32 s44, s44, s22
    s_addc_u32 s45, s23, 0
    s_and_b32 s45, s45, 0xffff
    s_mov_b32 s46, 65536
    s_mov_b32 s47, 0x20000
    s_add_u32 s48, s36, 4194304
    s_add_u32 s48, s48, s22
    s_addc_u32 s49, s23, 0
    s_and_b32 s49, s49, 0xffff
    s_mov_b32 s50, 65536
    s_mov_b32 s51, 0x20000
    s_lshr_b32 s33, s24, 2
    s_lshl_b32 s33, s33, 15
    s_add_u32 s32, s36, s33
    s_lshl_b32 s33, s28, 7
    s_add_u32 s32, s32, s33
    s_and_b32 s33, s24, 3
    s_lshl_b32 s33, s33, 5
    s_add_u32 s39, s32, s33
    s_min_u32 s32, s31, 2
    s_mul_i32 s33, s32, 25600
    s_cmp_eq_u32 s31, 3
    s_cselect_b32 s32, 7168, 0
    s_add_u32 s33, s33, s32
    s_lshl_b32 s99, s28, 3
    s_lshl_b32 s32, s63, 2
    s_add_u32 s99, s99, s32
    s_cmp_lg_u32 s24, 4
    s_cbranch_scc1 PK_lwait
    s_mov_b32 s52, s20
    s_and_b32 s53, s21, 0xffff
    s_mov_b32 s54, 256
    s_mov_b32 s55, 0x20000
    s_mov_b32 s98, 60000
PK_p0:
    buffer_load_dword v191, v190, s[52:55], 0 offen sc1
    s_waitcnt vmcnt(0)
    v_cmp_le_u32 vcc, 16, v191
    s_sub_u32 s98, s98, 1
    s_cmp_eq_u64 vcc, -1
    s_cbranch_scc1 PK_p0_ok
    s_cmp_lg_u32 s98, 0
    s_cbranch_scc1 PK_p0
PK_p0_ok:
    s_mov_b32 s98, 60000
PK_p1:
    buffer_load_dword v187, v184, s[40:43], 0 offen sc1
    buffer_load_dword v188, v185, s[40:43], 0 offen sc1
    buffer_load_dword v189, v186, s[40:43], 0 offen sc1
    s_waitcnt vmcnt(0)
    v_add3_u32 v187, v187, v188, v189
    v_cmp_eq_u32 vcc, 3, v187
    s_sub_u32 s98, s98, 1
    s_cmp_eq_u64 vcc, -1
    s_cbranch_scc1 PK_p1_ok
    s_cmp_lg_u32 s98, 0
    s_cbranch_scc1 PK_p1
PK_p1_ok:
    v_mov_b32 v253, 159744
    v_mov_b32 v254, 1
    ds_write_b32 v253, v254
    s_branch PK_lgo
PK_lwait:
    v_mov_b32 v253, 159744
    s_mov_b32 s98, 480000
PK_lw:
    ds_read_b32 v254, v253
    s_waitcnt lgkmcnt(0)
    v_cmp_eq_u32 vcc, 1, v254
    s_sub_u32 s98, s98, 1
    s_cmp_eq_u64 vcc, -1
    s_cbranch_scc1 PK_lw_ok
    s_cmp_lg_u32 s98, 0
    s_cbranch_scc1 PK_lw
PK_lw_ok:
PK_lgo:
    s_waitcnt vmcnt(0)
    s_add_u32 s32, s31, 0
    s_and_b32 s32, s32, 3
    s_add_u32 s32, s32, s99
    s_lshl_b32 s32, s32, 10
    s_add_u32 s32, s32, s36
    buffer_load_dwordx4 v[96:99], v245, s[40:43], s32 offen sc1
    buffer_load_dwordx4 v[112:115], v245, s[44:47], s33 offen offset:0 sc1
    s_add_u32 s32, s31, 1
    s_and_b32 s32, s32, 3
    s_add_u32 s32, s32, s99
    s_lshl_b32 s32, s32, 10
    s_add_u32 s32, s32, s36
    buffer_load_dwordx4 v[100:103], v245, s[40:43], s32 offen sc1
    s_add_u32 s32, s31, 2
    s_and_b32 s32, s32, 3
    s_add_u32 s32, s32, s99
    s_lshl_b32 s32, s32, 10
    s_add_u32 s32, s32, s36
    buffer_load_dwordx4 v[104:107], v245, s[40:43], s32 offen sc1
    s_add_u32 s32, s31, 3
    s_and_b32 s32, s32, 3
    s_add_u32 s32, s32, s99
    s_lshl_b32 s32, s32, 10
    s_add_u32 s32, s32, s36
    buffer_load_dwordx4 v[108:111], v245, s[40:43], s32 offen sc1
    s_mov_b64 exec, s[96:97]
    buffer_load_dwordx4 v[124:127], v246, s[48:51], s33 offen offset:0 sc1
    buffer_load_dwordx4 v[128:131], v246, s[48:51], s33 offen offset:512 sc1
    s_mov_b64 exec, -1
    buffer_load_dwordx4 v[116:119], v245, s[44:47], s33 offen offset:1024 sc1
    s_mov_b64 exec, s[96:97]
    buffer_load_dwordx4 v[132:135], v246, s[48:51], s33 offen offset:1024 sc1
    buffer_load_dwordx4 v[136:139], v246, s[48:51], s33 offen offset:1536 sc1
    s_mov_b64 exec, -1
    buffer_load_dwordx4 v[120:123], v245, s[44:47], s33 offen offset:2048 sc1
    s_mov_b64 exec, s[96:97]
    buffer_load_dwordx4 v[140:143], v246, s[48:51], s33 offen offset:2048 sc1
    buffer_load_dwordx4 v[144:147], v246, s[48:51], s33 offen offset:2560 sc1
    s_mov_b64 exec, -1
    s_lshl_b32 s38, s63, 2
    s_add_u32 s32, s38, s31
    s_mul_i32 s32, s32, 6912
    s_add_u32 s0, s32, 65536
    s_add_u32 s32, s31, 1
    s_and_b32 s32, s32, 3
    s_add_u32 s32, s32, s38
    s_mul_i32 s32, s32, 6912
    s_add_u32 s25, s32, 65536
    s_xor_b32 s32, s24, 1
    s_mul_i32 s32, s32, 6144
    s_add_u32 s95, s32, 0
    s_add_u32 s32, s31, 2
    s_and_b32 s32, s32, 3
    s_add_u32 s32, s32, s38
    s_mul_i32 s32, s32, 6912
    s_add_u32 s26, s32, 67840
    s_xor_b32 s32, s24, 2
    s_mul_i32 s32, s32, 6144
    s_add_u32 s100, s32, 2048
    s_add_u32 s32, s31, 3
    s_and_b32 s32, s32, 3
    s_add_u32 s32, s32, s38
    s_mul_i32 s32, s32, 6912
    s_add_u32 s29, s32, 70144
    s_xor_b32 s32, s24, 3
    s_mul_i32 s32, s32, 6144
    s_add_u32 s101, s32, 4096
    s_add_u32 s32, s99, s31
    s_lshl_b32 s32, s32, 5
    s_add_u32 s32, s32, s27
    s_lshl_b32 s32, s32, 10
    s_add_u32 s1, s32, 6291456
    s_lshl_b32 s32, s27, 1
    s_lshr_b32 s38, s24, 2
    s_add_u32 s32, s32, s38
    s_lshl_b32 s32, s32, 2
    s_and_b32 s38, s24, 3
    s_add_u32 s32, s32, s38
    s_lshl_b32 s32, s32, 13
    s_add_u32 s3, s32, 6291456
    s_add_u32 s10, s32, 6295552
    s_lshl_b32 s30, s38, 5
    s_lshl_b32 s34, s38, 14
    s_lshl_b32 s32, s24, 14
    s_add_u32 s11, s32, 65536
    s_lshl_b32 s32, s24, 11
    s_add_u32 s93, s32, 65536
    s_mul_i32 s32, s24, 6144
    s_add_u32 s94, s32, 0
    s_mov_b32 s4, s4
    s_and_b32 s5, s5, 0xffff
    s_mov_b32 s6, 2097152
    s_mov_b32 s7, 0x20000
    s_mov_b32 s12, s18
    s_and_b32 s13, s19, 0xffff
    s_mov_b32 s14, 2097152
    s_mov_b32 s15, 0x20000
    s_mov_b32 s56, s8
    s_and_b32 s57, s9, 0xffff
    s_mov_b32 s58, 524288
    s_mov_b32 s59, 0x20000
    s_and_b32 s38, s24, 3
    s_lshl_b32 s32, s38, 17
    s_lshl_b32 s88, s28, 7
    s_add_u32 s88, s88, s32
    s_lshl_b32 s38, s38, 14
    s_lshr_b32 s32, s27, 2
    s_lshl_b32 s89, s32, 14
    s_or_b32 s88, s88, s89
    s_lshl_b32 s32, s32, 11
    s_or_b32 s38, s38, s32
    s_barrier
    s_setprio 1
    s_waitcnt vmcnt(6)
    v_mfma_f32_32x32x16_bf16 v[64:79], v[112:115], v[96:99], 0
    s_nop 11
    v_exp_f32 v64, v64
    v_exp_f32 v65, v65
    v_exp_f32 v66, v66
    v_exp_f32 v67, v67
    v_exp_f32 v68, v68
    v_mfma_f32_32x32x16_bf16 v[80:95], v[112:115], v[100:103], 0
    v_exp_f32 v69, v69
    v_exp_f32 v70, v70
    v_exp_f32 v71, v71
    v_exp_f32 v72, v72
    v_exp_f32 v73, v73
    v_smfmac_f32_32x32x32_bf16 v[0:15], v[124:127], v[64:71], v244
    v_exp_f32 v74, v74
    v_exp_f32 v75, v75
    v_exp_f32 v76, v76
    v_exp_f32 v77, v77
    v_exp_f32 v78, v78
    v_exp_f32 v79, v79
    v_exp_f32 v80, v80
    v_exp_f32 v81, v81
    v_smfmac_f32_32x32x32_bf16 v[0:15], v[128:131], v[72:79], v244
    v_exp_f32 v82, v82
    v_exp_f32 v83, v83
    v_exp_f32 v84, v84
    v_mfma_f32_32x32x16_bf16 v[64:79], v[112:115], v[104:107], 0
    v_exp_f32 v85, v85
    v_exp_f32 v86, v86
    v_exp_f32 v87, v87
    v_exp_f32 v88, v88
    v_exp_f32 v89, v89
    v_smfmac_f32_32x32x32_bf16 v[16:31], v[124:127], v[80:87], v244
    v_exp_f32 v90, v90
    v_exp_f32 v91, v91
    v_exp_f32 v92, v92
    v_exp_f32 v93, v93
    v_exp_f32 v94, v94
    v_exp_f32 v95, v95
    v_exp_f32 v64, v64
    v_exp_f32 v65, v65
    v_smfmac_f32_32x32x32_bf16 v[16:31], v[128:131], v[88:95], v244
    v_exp_f32 v66, v66
    v_exp_f32 v67, v67
    v_exp_f32 v68, v68
    v_mfma_f32_32x32x16_bf16 v[80:95], v[112:115], v[108:111], 0
    v_exp_f32 v69, v69
    v_exp_f32 v70, v70
    v_exp_f32 v71, v71
    v_exp_f32 v72, v72
    v_exp_f32 v73, v73
    v_smfmac_f32_32x32x32_bf16 v[32:47], v[124:127], v[64:71], v244
    v_exp_f32 v74, v74
    v_exp_f32 v75, v75
    v_exp_f32 v76, v76
    v_exp_f32 v77, v77
    v_exp_f32 v78, v78
    v_exp_f32 v79, v79
    v_exp_f32 v80, v80
    v_exp_f32 v81, v81
    v_smfmac_f32_32x32x32_bf16 v[32:47], v[128:131], v[72:79], v244
    v_exp_f32 v82, v82
    v_exp_f32 v83, v83
    v_exp_f32 v84, v84
    s_waitcnt vmcnt(3)
    v_mfma_f32_32x32x16_bf16 v[64:79], v[116:119], v[96:99], 0
    buffer_load_dwordx4 v[112:115], v245, s[44:47], s33 offen offset:3072 sc1
    v_exp_f32 v85, v85
    v_exp_f32 v86, v86
    v_exp_f32 v87, v87
    v_exp_f32 v88, v88
    v_exp_f32 v89, v89
    v_smfmac_f32_32x32x32_bf16 v[48:63], v[124:127], v[80:87], v244
    v_exp_f32 v90, v90
    v_exp_f32 v91, v91
    v_exp_f32 v92, v92
    v_exp_f32 v93, v93
    v_exp_f32 v94, v94
    v_exp_f32 v95, v95
    v_exp_f32 v64, v64
    v_exp_f32 v65, v65
    v_smfmac_f32_32x32x32_bf16 v[48:63], v[128:131], v[88:95], v244
    s_mov_b64 exec, s[96:97]
    buffer_load_dwordx4 v[124:127], v246, s[48:51], s33 offen offset:3072 sc1
    buffer_load_dwordx4 v[128:131], v246, s[48:51], s33 offen offset:3584 sc1
    s_mov_b64 exec, -1
    v_exp_f32 v66, v66
    v_exp_f32 v67, v67
    v_exp_f32 v68, v68
    v_mfma_f32_32x32x16_bf16 v[80:95], v[116:119], v[100:103], 0
    v_exp_f32 v69, v69
    v_exp_f32 v70, v70
    v_exp_f32 v71, v71
    v_exp_f32 v72, v72
    v_exp_f32 v73, v73
    v_smfmac_f32_32x32x32_bf16 v[0:15], v[132:135], v[64:71], v244
    v_exp_f32 v74, v74
    v_exp_f32 v75, v75
    v_exp_f32 v76, v76
    v_exp_f32 v77, v77
    v_exp_f32 v78, v78
    v_exp_f32 v79, v79
    v_exp_f32 v80, v80
    v_exp_f32 v81, v81
    v_smfmac_f32_32x32x32_bf16 v[0:15], v[136:139], v[72:79], v244
    v_exp_f32 v82, v82
    v_exp_f32 v83, v83
    v_exp_f32 v84, v84
    v_mfma_f32_32x32x16_bf16 v[64:79], v[116:119], v[104:107], 0
    v_exp_f32 v85, v85
    v_exp_f32 v86, v86
    v_exp_f32 v87, v87
    v_exp_f32 v88, v88
    v_exp_f32 v89, v89
    v_smfmac_f32_32x32x32_bf16 v[16:31], v[132:135], v[80:87], v244
    v_exp_f32 v90, v90
    v_exp_f32 v91, v91
    v_exp_f32 v92, v92
    v_exp_f32 v93, v93
    v_exp_f32 v94, v94
    v_exp_f32 v95, v95
    v_exp_f32 v64, v64
    v_exp_f32 v65, v65
    v_smfmac_f32_32x32x32_bf16 v[16:31], v[136:139], v[88:95], v244
    v_exp_f32 v66, v66
    v_exp_f32 v67, v67
    v_exp_f32 v68, v68
    v_mfma_f32_32x32x16_bf16 v[80:95], v[116:119], v[108:111], 0
    v_exp_f32 v69, v69
    v_exp_f32 v70, v70
    v_exp_f32 v71, v71
    v_exp_f32 v72, v72
    v_exp_f32 v73, v73
    v_smfmac_f32_32x32x32_bf16 v[32:47], v[132:135], v[64:71], v244
    v_exp_f32 v74, v74
    v_exp_f32 v75, v75
    v_exp_f32 v76, v76
    v_exp_f32 v77, v77
    v_exp_f32 v78, v78
    v_exp_f32 v79, v79
    v_exp_f32 v80, v80
    v_exp_f32 v81, v81
    v_smfmac_f32_32x32x32_bf16 v[32:47], v[136:139], v[72:79], v244
    v_exp_f32 v82, v82
    v_exp_f32 v83, v83
    v_exp_f32 v84, v84
    s_waitcnt vmcnt(3)
    v_mfma_f32_32x32x16_bf16 v[64:79], v[120:123], v[96:99], 0
    s_add_u32 s33, s33, 4096
    buffer_load_dwordx4 v[116:119], v245, s[44:47], s33 offen offset:0 sc1
    v_exp_f32 v85, v85
    v_exp_f32 v86, v86
    v_exp_f32 v87, v87
    v_exp_f32 v88, v88
    v_exp_f32 v89, v89
    v_smfmac_f32_32x32x32_bf16 v[48:63], v[132:135], v[80:87], v244
    v_exp_f32 v90, v90
    v_exp_f32 v91, v91
    v_exp_f32 v92, v92
    v_exp_f32 v93, v93
    v_exp_f32 v94, v94
    v_exp_f32 v95, v95
    v_exp_f32 v64, v64
    v_exp_f32 v65, v65
    v_smfmac_f32_32x32x32_bf16 v[48:63], v[136:139], v[88:95], v244
    s_mov_b64 exec, s[96:97]
    buffer_load_dwordx4 v[132:135], v246, s[48:51], s33 offen offset:0 sc1
    buffer_load_dwordx4 v[136:139], v246, s[48:51], s33 offen offset:512 sc1
    s_mov_b64 exec, -1
    v_exp_f32 v66, v66
    v_exp_f32 v67, v67
    v_exp_f32 v68, v68
    v_mfma_f32_32x32x16_bf16 v[80:95], v[120:123], v[100:103], 0
    v_exp_f32 v69, v69
    v_exp_f32 v70, v70
    v_exp_f32 v71, v71
    v_exp_f32 v72, v72
    v_exp_f32 v73, v73
    v_smfmac_f32_32x32x32_bf16 v[0:15], v[140:143], v[64:71], v244
    v_exp_f32 v74, v74
    v_exp_f32 v75, v75
    v_exp_f32 v76, v76
    v_exp_f32 v77, v77
    v_exp_f32 v78, v78
    v_exp_f32 v79, v79
    v_exp_f32 v80, v80
    v_exp_f32 v81, v81
    v_smfmac_f32_32x32x32_bf16 v[0:15], v[144:147], v[72:79], v244
    v_exp_f32 v82, v82
    v_exp_f32 v83, v83
    v_exp_f32 v84, v84
    v_mfma_f32_32x32x16_bf16 v[64:79], v[120:123], v[104:107], 0
    v_exp_f32 v85, v85
    v_exp_f32 v86, v86
    v_exp_f32 v87, v87
    v_exp_f32 v88, v88
    v_exp_f32 v89, v89
    v_smfmac_f32_32x32x32_bf16 v[16:31], v[140:143], v[80:87], v244
    v_exp_f32 v90, v90
    v_exp_f32 v91, v91
    v_exp_f32 v92, v92
    v_exp_f32 v93, v93
    v_exp_f32 v94, v94
    v_exp_f32 v95, v95
    v_exp_f32 v64, v64
    v_exp_f32 v65, v65
    v_smfmac_f32_32x32x32_bf16 v[16:31], v[144:147], v[88:95], v244
    v_exp_f32 v66, v66
    v_exp_f32 v67, v67
    v_exp_f32 v68, v68
    v_mfma_f32_32x32x16_bf16 v[80:95], v[120:123], v[108:111], 0
    v_exp_f32 v69, v69
    v_exp_f32 v70, v70
    v_exp_f32 v71, v71
    v_exp_f32 v72, v72
    v_exp_f32 v73, v73
    v_smfmac_f32_32x32x32_bf16 v[32:47], v[140:143], v[64:71], v244
    v_exp_f32 v74, v74
    v_exp_f32 v75, v75
    v_exp_f32 v76, v76
    v_exp_f32 v77, v77
    v_exp_f32 v78, v78
    v_exp_f32 v79, v79
    v_exp_f32 v80, v80
    v_exp_f32 v81, v81
    v_smfmac_f32_32x32x32_bf16 v[32:47], v[144:147], v[72:79], v244
    v_exp_f32 v82, v82
    v_exp_f32 v83, v83
    v_exp_f32 v84, v84
    s_waitcnt vmcnt(3)
    v_mfma_f32_32x32x16_bf16 v[64:79], v[112:115], v[96:99], 0
    buffer_load_dwordx4 v[120:123], v245, s[44:47], s33 offen offset:1024 sc1
    v_exp_f32 v85, v85
    v_exp_f32 v86, v86
    v_exp_f32 v87, v87
    v_exp_f32 v88, v88
    v_exp_f32 v89, v89
    v_smfmac_f32_32x32x32_bf16 v[48:63], v[140:143], v[80:87], v244
    v_exp_f32 v90, v90
    v_exp_f32 v91, v91
    v_exp_f32 v92, v92
    v_exp_f32 v93, v93
    v_exp_f32 v94, v94
    v_exp_f32 v95, v95
    v_exp_f32 v64, v64
    v_exp_f32 v65, v65
    v_smfmac_f32_32x32x32_bf16 v[48:63], v[144:147], v[88:95], v244
    s_mov_b64 exec, s[96:97]
    buffer_load_dwordx4 v[140:143], v246, s[48:51], s33 offen offset:1024 sc1
    buffer_load_dwordx4 v[144:147], v246, s[48:51], s33 offen offset:1536 sc1
    s_mov_b64 exec, -1
    v_exp_f32 v66, v66
    v_exp_f32 v67, v67
    v_exp_f32 v68, v68
    v_mfma_f32_32x32x16_bf16 v[80:95], v[112:115], v[100:103], 0
    v_exp_f32 v69, v69
    v_exp_f32 v70, v70
    v_exp_f32 v71, v71
    v_exp_f32 v72, v72
    v_exp_f32 v73, v73
    v_smfmac_f32_32x32x32_bf16 v[0:15], v[124:127], v[64:71], v244
    v_exp_f32 v74, v74
    v_exp_f32 v75, v75
    v_exp_f32 v76, v76
    v_exp_f32 v77, v77
    v_exp_f32 v78, v78
    v_exp_f32 v79, v79
    v_exp_f32 v80, v80
    v_exp_f32 v81, v81
    v_smfmac_f32_32x32x32_bf16 v[0:15], v[128:131], v[72:79], v244
    v_exp_f32 v82, v82
    v_exp_f32 v83, v83
    v_exp_f32 v84, v84
    v_mfma_f32_32x32x16_bf16 v[64:79], v[112:115], v[104:107], 0
    v_exp_f32 v85, v85
    v_exp_f32 v86, v86
    v_exp_f32 v87, v87
    v_exp_f32 v88, v88
    v_exp_f32 v89, v89
    v_smfmac_f32_32x32x32_bf16 v[16:31], v[124:127], v[80:87], v244
    v_exp_f32 v90, v90
    v_exp_f32 v91, v91
    v_exp_f32 v92, v92
    v_exp_f32 v93, v93
    v_exp_f32 v94, v94
    v_exp_f32 v95, v95
    v_exp_f32 v64, v64
    v_exp_f32 v65, v65
    v_smfmac_f32_32x32x32_bf16 v[16:31], v[128:131], v[88:95], v244
    v_exp_f32 v66, v66
    v_exp_f32 v67, v67
    v_exp_f32 v68, v68
    v_mfma_f32_32x32x16_bf16 v[80:95], v[112:115], v[108:111], 0
    v_exp_f32 v69, v69
    v_exp_f32 v70, v70
    v_exp_f32 v71, v71
    v_exp_f32 v72, v72
    v_exp_f32 v73, v73
    v_smfmac_f32_32x32x32_bf16 v[32:47], v[124:127], v[64:71], v244
    v_exp_f32 v74, v74
    v_exp_f32 v75, v75
    v_exp_f32 v76, v76
    v_exp_f32 v77, v77
    v_exp_f32 v78, v78
    v_exp_f32 v79, v79
    v_exp_f32 v80, v80
    v_exp_f32 v81, v81
    v_smfmac_f32_32x32x32_bf16 v[32:47], v[128:131], v[72:79], v244
    v_exp_f32 v82, v82
    v_exp_f32 v83, v83
    v_exp_f32 v84, v84
    s_waitcnt vmcnt(3)
    v_mfma_f32_32x32x16_bf16 v[64:79], v[116:119], v[96:99], 0
    buffer_load_dwordx4 v[112:115], v245, s[44:47], s33 offen offset:2048 sc1
    v_exp_f32 v85, v85
    v_exp_f32 v86, v86
    v_exp_f32 v87, v87
    v_exp_f32 v88, v88
    v_exp_f32 v89, v89
    v_smfmac_f32_32x32x32_bf16 v[48:63], v[124:127], v[80:87], v244
    v_exp_f32 v90, v90
    v_exp_f32 v91, v91
    v_exp_f32 v92, v92
    v_exp_f32 v93, v93
    v_exp_f32 v94, v94
    v_exp_f32 v95, v95
    v_exp_f32 v64, v64
    v_exp_f32 v65, v65
    v_smfmac_f32_32x32x32_bf16 v[48:63], v[128:131], v[88:95], v244
    s_mov_b64 exec, s[96:97]
    buffer_load_dwordx4 v[124:127], v246, s[48:51], s33 offen offset:2048 sc1
    buffer_load_dwordx4 v[128:131], v246, s[48:51], s33 offen offset:2560 sc1
    s_mov_b64 exec, -1
    v_exp_f32 v66, v66
    v_exp_f32 v67, v67
    v_exp_f32 v68, v68
    v_mfma_f32_32x32x16_bf16 v[80:95], v[116:119], v[100:103], 0
    s_xor_b32 m0, s38, 0
    s_xor_b32 s32, s88, 0
    buffer_load_dwordx4 v249, s[56:59], s32 offen lds
    buffer_load_dwordx4 v250, s[56:59], s32 offen offset:1024 lds
    s_xor_b32 m0, s38, 2048
    s_xor_b32 s32, s88, 16384
    buffer_load_dwordx4 v249, s[56:59], s32 offen lds
    buffer_load_dwordx4 v250, s[56:59], s32 offen offset:1024 lds
    s_xor_b32 m0, s38, 4096
    s_xor_b32 s32, s88, 32768
    buffer_load_dwordx4 v249, s[56:59], s32 offen lds
    buffer_load_dwordx4 v250, s[56:59], s32 offen offset:1024 lds
    s_xor_b32 m0, s38, 6144
    s_xor_b32 s32, s88, 49152
    buffer_load_dwordx4 v249, s[56:59], s32 offen lds
    buffer_load_dwordx4 v250, s[56:59], s32 offen offset:1024 lds
    v_exp_f32 v69, v69
    v_exp_f32 v70, v70
    v_exp_f32 v71, v71
    v_exp_f32 v72, v72
    v_exp_f32 v73, v73
    v_smfmac_f32_32x32x32_bf16 v[0:15], v[132:135], v[64:71], v244
    v_exp_f32 v74, v74
    v_exp_f32 v75, v75
    v_exp_f32 v76, v76
    v_exp_f32 v77, v77
    v_exp_f32 v78, v78
    v_exp_f32 v79, v79
    v_exp_f32 v80, v80
    v_exp_f32 v81, v81
    v_smfmac_f32_32x32x32_bf16 v[0:15], v[136:139], v[72:79], v244
    v_exp_f32 v82, v82
    v_exp_f32 v83, v83
    v_exp_f32 v84, v84
    v_mfma_f32_32x32x16_bf16 v[64:79], v[116:119], v[104:107], 0
    v_exp_f32 v85, v85
    v_exp_f32 v86, v86
    v_exp_f32 v87, v87
    v_exp_f32 v88, v88
    v_exp_f32 v89, v89
    v_smfmac_f32_32x32x32_bf16 v[16:31], v[132:135], v[80:87], v244
    v_exp_f32 v90, v90
    v_exp_f32 v91, v91
    v_exp_f32 v92, v92
    v_exp_f32 v93, v93
    v_exp_f32 v94, v94
    v_exp_f32 v95, v95
    v_exp_f32 v64, v64
    v_exp_f32 v65, v65
    v_smfmac_f32_32x32x32_bf16 v[16:31], v[136:139], v[88:95], v244
    v_exp_f32 v66, v66
    v_exp_f32 v67, v67
    v_exp_f32 v68, v68
    v_mfma_f32_32x32x16_bf16 v[80:95], v[116:119], v[108:111], 0
    v_exp_f32 v69, v69
    v_exp_f32 v70, v70
    v_exp_f32 v71, v71
    v_exp_f32 v72, v72
    v_exp_f32 v73, v73
    v_smfmac_f32_32x32x32_bf16 v[32:47], v[132:135], v[64:71], v244
    v_exp_f32 v74, v74
    v_exp_f32 v75, v75
    v_exp_f32 v76, v76
    v_exp_f32 v77, v77
    v_exp_f32 v78, v78
    v_exp_f32 v79, v79
    v_exp_f32 v80, v80
    v_exp_f32 v81, v81
    v_smfmac_f32_32x32x32_bf16 v[32:47], v[136:139], v[72:79], v244
    v_exp_f32 v82, v82
    v_exp_f32 v83, v83
    v_exp_f32 v84, v84
    s_waitcnt vmcnt(11)
    v_mfma_f32_32x32x16_bf16 v[64:79], v[120:123], v[96:99], 0
    v_exp_f32 v85, v85
    v_exp_f32 v86, v86
    v_exp_f32 v87, v87
    v_exp_f32 v88, v88
    v_exp_f32 v89, v89
    v_smfmac_f32_32x32x32_bf16 v[48:63], v[132:135], v[80:87], v244
    v_exp_f32 v90, v90
    v_exp_f32 v91, v91
    v_exp_f32 v92, v92
    v_exp_f32 v93, v93
    v_exp_f32 v94, v94
    v_exp_f32 v95, v95
    v_exp_f32 v64, v64
    v_exp_f32 v65, v65
    v_smfmac_f32_32x32x32_bf16 v[48:63], v[136:139], v[88:95], v244
    v_exp_f32 v66, v66
    v_exp_f32 v67, v67
    v_exp_f32 v68, v68
    v_mfma_f32_32x32x16_bf16 v[80:95], v[120:123], v[100:103], 0
    s_xor_b32 m0, s38, 8192
    s_xor_b32 s32, s88, 65536
    buffer_load_dwordx4 v249, s[56:59], s32 offen lds
    buffer_load_dwordx4 v250, s[56:59], s32 offen offset:1024 lds
    s_xor_b32 m0, s38, 10240
    s_xor_b32 s32, s88, 81920
    buffer_load_dwordx4 v249, s[56:59], s32 offen lds
    buffer_load_dwordx4 v250, s[56:59], s32 offen offset:1024 lds
    s_xor_b32 m0, s38, 12288
    s_xor_b32 s32, s88, 98304
    buffer_load_dwordx4 v249, s[56:59], s32 offen lds
    buffer_load_dwordx4 v250, s[56:59], s32 offen offset:1024 lds
    s_xor_b32 m0, s38, 14336
    s_xor_b32 s32, s88, 114688
    buffer_load_dwordx4 v249, s[56:59], s32 offen lds
    buffer_load_dwordx4 v250, s[56:59], s32 offen offset:1024 lds
    v_exp_f32 v69, v69
    v_exp_f32 v70, v70
    v_exp_f32 v71, v71
    v_exp_f32 v72, v72
    v_exp_f32 v73, v73
    v_smfmac_f32_32x32x32_bf16 v[0:15], v[140:143], v[64:71], v244
    v_exp_f32 v74, v74
    v_exp_f32 v75, v75
    v_exp_f32 v76, v76
    v_exp_f32 v77, v77
    v_exp_f32 v78, v78
    v_exp_f32 v79, v79
    v_exp_f32 v80, v80
    v_exp_f32 v81, v81
    v_smfmac_f32_32x32x32_bf16 v[0:15], v[144:147], v[72:79], v244
    v_exp_f32 v82, v82
    v_exp_f32 v83, v83
    v_exp_f32 v84, v84
    v_mfma_f32_32x32x16_bf16 v[64:79], v[120:123], v[104:107], 0
    v_exp_f32 v85, v85
    v_exp_f32 v86, v86
    v_exp_f32 v87, v87
    v_exp_f32 v88, v88
    v_exp_f32 v89, v89
    v_smfmac_f32_32x32x32_bf16 v[16:31], v[140:143], v[80:87], v244
    v_exp_f32 v90, v90
    v_exp_f32 v91, v91
    v_exp_f32 v92, v92
    v_exp_f32 v93, v93
    v_exp_f32 v94, v94
    v_exp_f32 v95, v95
    v_exp_f32 v64, v64
    v_exp_f32 v65, v65
    v_smfmac_f32_32x32x32_bf16 v[16:31], v[144:147], v[88:95], v244
    v_exp_f32 v66, v66
    v_exp_f32 v67, v67
    v_exp_f32 v68, v68
    v_mfma_f32_32x32x16_bf16 v[80:95], v[120:123], v[108:111], 0
    v_exp_f32 v69, v69
    v_exp_f32 v70, v70
    v_exp_f32 v71, v71
    v_exp_f32 v72, v72
    v_exp_f32 v73, v73
    v_smfmac_f32_32x32x32_bf16 v[32:47], v[140:143], v[64:71], v244
    v_exp_f32 v74, v74
    v_exp_f32 v75, v75
    v_exp_f32 v76, v76
    v_exp_f32 v77, v77
    v_exp_f32 v78, v78
    v_exp_f32 v79, v79
    v_exp_f32 v80, v80
    v_exp_f32 v81, v81
    v_smfmac_f32_32x32x32_bf16 v[32:47], v[144:147], v[72:79], v244
    v_exp_f32 v82, v82
    v_exp_f32 v83, v83
    v_exp_f32 v84, v84
    s_waitcnt vmcnt(0)
    v_mfma_f32_32x32x16_bf16 v[64:79], v[112:115], v[96:99], 0
    v_exp_f32 v85, v85
    v_exp_f32 v86, v86
    v_exp_f32 v87, v87
    v_exp_f32 v88, v88
    v_exp_f32 v89, v89
    v_smfmac_f32_32x32x32_bf16 v[48:63], v[140:143], v[80:87], v244
    v_exp_f32 v90, v90
    v_exp_f32 v91, v91
    v_exp_f32 v92, v92
    v_exp_f32 v93, v93
    v_exp_f32 v94, v94
    v_exp_f32 v95, v95
    v_exp_f32 v64, v64
    v_exp_f32 v65, v65
    v_smfmac_f32_32x32x32_bf16 v[48:63], v[144:147], v[88:95], v244
    v_exp_f32 v66, v66
    v_exp_f32 v67, v67
    v_exp_f32 v68, v68
    v_mfma_f32_32x32x16_bf16 v[80:95], v[112:115], v[100:103], 0
    ds_read_b64_tr_b16 v[180:181], v251 offset:0
    ds_read_b64_tr_b16 v[182:183], v251 offset:512
    ds_read_b64_tr_b16 v[184:185], v252 offset:0
    ds_read_b64_tr_b16 v[186:187], v252 offset:512
    v_exp_f32 v69, v69
    v_exp_f32 v70, v70
    v_exp_f32 v71, v71
    v_exp_f32 v72, v72
    v_exp_f32 v73, v73
    v_smfmac_f32_32x32x32_bf16 v[0:15], v[124:127], v[64:71], v244
    ds_read_b64_tr_b16 v[188:189], v251 offset:2048
    ds_read_b64_tr_b16 v[190:191], v251 offset:2560
    ds_read_b64_tr_b16 v[192:193], v252 offset:2048
    ds_read_b64_tr_b16 v[194:195], v252 offset:2560
    v_exp_f32 v74, v74
    v_exp_f32 v75, v75
    v_exp_f32 v76, v76
    v_exp_f32 v77, v77
    v_exp_f32 v78, v78
    v_exp_f32 v79, v79
    v_exp_f32 v80, v80
    v_exp_f32 v81, v81
    v_smfmac_f32_32x32x32_bf16 v[0:15], v[128:131], v[72:79], v244
    v_exp_f32 v82, v82
    v_exp_f32 v83, v83
    v_exp_f32 v84, v84
    v_mfma_f32_32x32x16_bf16 v[64:79], v[112:115], v[104:107], 0
    ds_read_b64_tr_b16 v[196:197], v251 offset:4096
    ds_read_b64_tr_b16 v[198:199], v251 offset:4608
    ds_read_b64_tr_b16 v[200:201], v252 offset:4096
    ds_read_b64_tr_b16 v[202:203], v252 offset:4608
    v_exp_f32 v85, v85
    v_exp_f32 v86, v86
    v_exp_f32 v87, v87
    v_exp_f32 v88, v88
    v_exp_f32 v89, v89
    v_smfmac_f32_32x32x32_bf16 v[16:31], v[124:127], v[80:87], v244
    ds_read_b64_tr_b16 v[204:205], v251 offset:6144
    ds_read_b64_tr_b16 v[206:207], v251 offset:6656
    ds_read_b64_tr_b16 v[208:209], v252 offset:6144
    ds_read_b64_tr_b16 v[210:211], v252 offset:6656
    v_exp_f32 v90, v90
    v_exp_f32 v91, v91
    v_exp_f32 v92, v92
    v_exp_f32 v93, v93
    v_exp_f32 v94, v94
    v_exp_f32 v95, v95
    v_exp_f32 v64, v64
    v_exp_f32 v65, v65
    v_smfmac_f32_32x32x32_bf16 v[16:31], v[128:131], v[88:95], v244
    v_exp_f32 v66, v66
    v_exp_f32 v67, v67
    v_exp_f32 v68, v68
    v_mfma_f32_32x32x16_bf16 v[80:95], v[112:115], v[108:111], 0
    ds_read_b64_tr_b16 v[212:213], v251 offset:8192
    ds_read_b64_tr_b16 v[214:215], v251 offset:8704
    ds_read_b64_tr_b16 v[216:217], v252 offset:8192
    ds_read_b64_tr_b16 v[218:219], v252 offset:8704
    v_exp_f32 v69, v69
    v_exp_f32 v70, v70
    v_exp_f32 v71, v71
    v_exp_f32 v72, v72
    v_exp_f32 v73, v73
    v_smfmac_f32_32x32x32_bf16 v[32:47], v[124:127], v[64:71], v244
    ds_read_b64_tr_b16 v[220:221], v251 offset:10240
    ds_read_b64_tr_b16 v[222:223], v251 offset:10752
    ds_read_b64_tr_b16 v[224:225], v252 offset:10240
    ds_read_b64_tr_b16 v[226:227], v252 offset:10752
    v_exp_f32 v74, v74
    v_exp_f32 v75, v75
    v_exp_f32 v76, v76
    v_exp_f32 v77, v77
    v_exp_f32 v78, v78
    v_exp_f32 v79, v79
    v_exp_f32 v80, v80
    v_exp_f32 v81, v81
    v_smfmac_f32_32x32x32_bf16 v[32:47], v[128:131], v[72:79], v244
    v_exp_f32 v82, v82
    v_exp_f32 v83, v83
    v_exp_f32 v84, v84
    ds_read_b64_tr_b16 v[228:229], v251 offset:12288
    ds_read_b64_tr_b16 v[230:231], v251 offset:12800
    ds_read_b64_tr_b16 v[232:233], v252 offset:12288
    ds_read_b64_tr_b16 v[234:235], v252 offset:12800
    v_exp_f32 v85, v85
    v_exp_f32 v86, v86
    v_exp_f32 v87, v87
    v_exp_f32 v88, v88
    v_exp_f32 v89, v89
    v_smfmac_f32_32x32x32_bf16 v[48:63], v[124:127], v[80:87], v244
    ds_read_b64_tr_b16 v[236:237], v251 offset:14336
    ds_read_b64_tr_b16 v[238:239], v251 offset:14848
    ds_read_b64_tr_b16 v[240:241], v252 offset:14336
    ds_read_b64_tr_b16 v[242:243], v252 offset:14848
    v_exp_f32 v90, v90
    v_exp_f32 v91, v91
    v_exp_f32 v92, v92
    v_exp_f32 v93, v93
    v_exp_f32 v94, v94
    v_exp_f32 v95, v95
    s_nop 1
    v_smfmac_f32_32x32x32_bf16 v[48:63], v[128:131], v[88:95], v244
PK_join:
    v_lshlrev_b32 v254, 2, v247
    v_add_u32 v253, s25, v245
    v_add_u32 v255, s25, v254
    ds_write_b128 v253, v[16:19]
    ds_write_b128 v253, v[20:23] offset:1024
    ds_write_b32 v255, v24 offset:2048
    v_add_u32 v253, s26, v245
    v_add_u32 v255, s26, v254
    ds_write_b128 v253, v[32:35]
    ds_write_b128 v253, v[36:39] offset:1024
    ds_write_b32 v255, v40 offset:2048
    v_add_u32 v253, s29, v245
    v_add_u32 v255, s29, v254
    s_nop 1
    ds_write_b128 v253, v[48:51]
    ds_write_b128 v253, v[52:55] offset:1024
    ds_write_b32 v255, v56 offset:2048
    v_add_u32 v164, s0, v245
    v_lshl_add_u32 v165, v247, 2, s0
    s_mov_b32 s32, 0x21800000
    s_mov_b32 s33, 0x5d800000
    s_mov_b32 s38, 0x7e800000
    s_waitcnt vmcnt(0) lgkmcnt(0)
    s_barrier
    ds_read_b128 v[16:19], v164 offset:0
    ds_read_b128 v[20:23], v164 offset:1024
    ds_read_b32 v24, v165 offset:2048
    ds_read_b128 v[32:35], v164 offset:2304
    ds_read_b128 v[36:39], v164 offset:3328
    ds_read_b32 v40, v165 offset:4352
    ds_read_b128 v[48:51], v164 offset:4608
    ds_read_b128 v[52:55], v164 offset:5632
    ds_read_b32 v56, v165 offset:6656
    s_waitcnt lgkmcnt(6)
    v_add_f32 v0, v0, v16
    v_add_f32 v1, v1, v17
    v_add_f32 v2, v2, v18
    v_add_f32 v3, v3, v19
    v_add_f32 v4, v4, v20
    v_add_f32 v5, v5, v21
    v_add_f32 v6, v6, v22
    v_add_f32 v7, v7, v23
    v_add_f32 v8, v8, v24
    s_waitcnt lgkmcnt(3)
    v_add_f32 v0, v0, v32
    v_add_f32 v1, v1, v33
    v_add_f32 v2, v2, v34
    v_add_f32 v3, v3, v35
    v_add_f32 v4, v4, v36
    v_add_f32 v5, v5, v37
    v_add_f32 v6, v6, v38
    v_add_f32 v7, v7, v39
    v_add_f32 v8, v8, v40
    s_waitcnt lgkmcnt(0)
    v_add_f32 v0, v0, v48
    v_add_f32 v1, v1, v49
    v_add_f32 v2, v2, v50
    v_add_f32 v3, v3, v51
    v_add_f32 v4, v4, v52
    v_add_f32 v5, v5, v53
    v_add_f32 v6, v6, v54
    v_add_f32 v7, v7, v55
    v_add_f32 v8, v8, v56
    v_max3_f32 v164, abs(v0), abs(v1), abs(v2)
    v_max3_f32 v164, v164, abs(v3), abs(v4)
    v_max3_f32 v164, v164, abs(v5), abs(v6)
    v_max_f32 v164, v164, abs(v7)
    v_cmp_le_f32 s[88:89], s32, v8
    v_cmp_ge_f32 s[90:91], s33, v8
    v_cmp_ge_f32 vcc, s38, v164
    s_and_b64 s[88:89], s[88:89], s[90:91]
    s_and_b64 s[88:89], s[88:89], vcc
    s_cmp_eq_u64 s[88:89], -1
    s_cbranch_scc0 PK_slow
PK_store:
    v_rcp_f32 v164, v8
    s_nop 0
    v_mul_f32 v0, v0, v164
    v_mul_f32 v1, v1, v164
    v_mul_f32 v2, v2, v164
    v_mul_f32 v3, v3, v164
    v_mul_f32 v4, v4, v164
    v_mul_f32 v5, v5, v164
    v_mul_f32 v6, v6, v164
    v_mul_f32 v7, v7, v164
    v_cvt_pk_bf16_f32 v0, v0, v1
    v_cvt_pk_bf16_f32 v1, v2, v3
    v_cvt_pk_bf16_f32 v2, v4, v5
    v_cvt_pk_bf16_f32 v3, v6, v7
    v_min_u32 v0, -2, v0
    v_min_u32 v1, -2, v1
    v_min_u32 v2, -2, v2
    v_min_u32 v3, -2, v3
    buffer_store_dwordx4 v[0:3], v245, s[40:43], s1 offen sc1
    s_barrier
    buffer_load_dwordx4 v[160:163], v248, s[4:7], s39 offen
    s_mov_b32 s38, 0xfffffffe
    s_mov_b32 s35, 0xff
    s_mov_b32 s98, 15000
    s_cmp_ge_u32 s24, 4
    s_cbranch_scc1 PK_nogp
    v_add_u32 v174, s11, v245
    ds_write_b128 v174, v[180:183] offset:0
    v_subrev_u32 v166, s37, v251
    v_xor_b32 v166, s30, v166
    v_add_u32 v166, s34, v166
    v_xor_b32 v167, 64, v166
    ds_write_b128 v174, v[184:187] offset:1024
    ds_write_b128 v174, v[188:191] offset:2048
    ds_write_b128 v174, v[192:195] offset:3072
    ds_write_b128 v174, v[196:199] offset:4096
    ds_write_b128 v174, v[200:203] offset:5120
    ds_write_b128 v174, v[204:207] offset:6144
    ds_write_b128 v174, v[208:211] offset:7168
    ds_write_b128 v174, v[212:215] offset:8192
    ds_write_b128 v174, v[216:219] offset:9216
    ds_write_b128 v174, v[220:223] offset:10240
    ds_write_b128 v174, v[224:227] offset:11264
    ds_write_b128 v174, v[228:231] offset:12288
    ds_write_b128 v174, v[232:235] offset:13312
    ds_write_b128 v174, v[236:239] offset:14336
    ds_write_b128 v174, v[240:243] offset:15360
    ds_read_b64_tr_b16 v[180:181], v166 offset:0
    ds_read_b64_tr_b16 v[182:183], v166 offset:512
    ds_read_b64_tr_b16 v[184:185], v167 offset:0
    ds_read_b64_tr_b16 v[186:187], v167 offset:512
    ds_read_b64_tr_b16 v[188:189], v166 offset:2048
    ds_read_b64_tr_b16 v[190:191], v166 offset:2560
    ds_read_b64_tr_b16 v[192:193], v167 offset:2048
    ds_read_b64_tr_b16 v[194:195], v167 offset:2560
    ds_read_b64_tr_b16 v[196:197], v166 offset:4096
    ds_read_b64_tr_b16 v[198:199], v166 offset:4608
    ds_read_b64_tr_b16 v[200:201], v167 offset:4096
    ds_read_b64_tr_b16 v[202:203], v167 offset:4608
    ds_read_b64_tr_b16 v[204:205], v166 offset:6144
    ds_read_b64_tr_b16 v[206:207], v166 offset:6656
    ds_read_b64_tr_b16 v[208:209], v167 offset:6144
    ds_read_b64_tr_b16 v[210:211], v167 offset:6656
    ds_read_b64_tr_b16 v[212:213], v166 offset:8192
    ds_read_b64_tr_b16 v[214:215], v166 offset:8704
    ds_read_b64_tr_b16 v[216:217], v167 offset:8192
    ds_read_b64_tr_b16 v[218:219], v167 offset:8704
    ds_read_b64_tr_b16 v[220:221], v166 offset:10240
    ds_read_b64_tr_b16 v[222:223], v166 offset:10752
    ds_read_b64_tr_b16 v[224:225], v167 offset:10240
    ds_read_b64_tr_b16 v[226:227], v167 offset:10752
    ds_read_b64_tr_b16 v[228:229], v166 offset:12288
    ds_read_b64_tr_b16 v[230:231], v166 offset:12800
    ds_read_b64_tr_b16 v[232:233], v167 offset:12288
    ds_read_b64_tr_b16 v[234:235], v167 offset:12800
    ds_read_b64_tr_b16 v[236:237], v166 offset:14336
    ds_read_b64_tr_b16 v[238:239], v166 offset:14848
    ds_read_b64_tr_b16 v[240:241], v167 offset:14336
    ds_read_b64_tr_b16 v[242:243], v167 offset:14848
PK_nogp:
    v_add_u32 v169, s93, v245
    v_add_u32 v170, s94, v245
    v_add_u32 v171, s95, v245
    v_add_u32 v172, s100, v245
    v_add_u32 v173, s101, v245
    s_waitcnt lgkmcnt(0)
    s_barrier
    buffer_load_dwordx4 v[16:19], v245, s[40:43], s3 offen offset:0 sc1
    buffer_load_dwordx4 v[20:23], v245, s[40:43], s3 offen offset:1024 sc1
    buffer_load_dwordx4 v[24:27], v245, s[40:43], s3 offen offset:2048 sc1
    buffer_load_dwordx4 v[28:31], v245, s[40:43], s3 offen offset:3072 sc1
    buffer_load_dwordx4 v[32:35], v245, s[40:43], s10 offen offset:0 sc1
    buffer_load_dwordx4 v[36:39], v245, s[40:43], s10 offen offset:1024 sc1
    buffer_load_dwordx4 v[40:43], v245, s[40:43], s10 offen offset:2048 sc1
    buffer_load_dwordx4 v[44:47], v245, s[40:43], s10 offen offset:3072 sc1
    ds_read_b128 v[64:67], v169 offset:0
    ds_read_b128 v[68:71], v169 offset:1024
    ds_read_b128 v[72:75], v169 offset:16384
    ds_read_b128 v[76:79], v169 offset:17408
    ds_read_b128 v[80:83], v169 offset:32768
    ds_read_b128 v[84:87], v169 offset:33792
    ds_read_b128 v[88:91], v169 offset:49152
    ds_read_b128 v[92:95], v169 offset:50176
    s_waitcnt lgkmcnt(0)
    s_waitcnt vmcnt(8)
    v_add_f32 v64, v64, v72
    v_add_f32 v80, v80, v88
    v_add_f32 v65, v65, v73
    v_add_f32 v81, v81, v89
    v_add_f32 v66, v66, v74
    v_add_f32 v82, v82, v90
    v_add_f32 v67, v67, v75
    v_add_f32 v83, v83, v91
    v_add_f32 v68, v68, v76
    v_add_f32 v84, v84, v92
    v_add_f32 v69, v69, v77
    v_add_f32 v85, v85, v93
    v_add_f32 v70, v70, v78
    v_add_f32 v86, v86, v94
    v_add_f32 v71, v71, v79
    v_add_f32 v87, v87, v95
    v_add_f32 v64, v64, v80
    v_add_f32 v65, v65, v81
    v_add_f32 v66, v66, v82
    v_add_f32 v67, v67, v83
    v_add_f32 v68, v68, v84
    v_add_f32 v69, v69, v85
    v_add_f32 v70, v70, v86
    v_add_f32 v71, v71, v87
    v_mul_f32 v72, s61, v64
    v_mul_f32 v73, s61, v65
    v_mul_f32 v74, s61, v66
    v_mul_f32 v75, s61, v67
    v_mul_f32 v76, s61, v68
    v_mul_f32 v77, s61, v69
    v_mul_f32 v78, s61, v70
    v_mul_f32 v79, s61, v71
    v_exp_f32 v72, v72
    v_exp_f32 v73, v73
    v_exp_f32 v74, v74
    v_exp_f32 v75, v75
    v_exp_f32 v76, v76
    v_exp_f32 v77, v77
    v_exp_f32 v78, v78
    v_exp_f32 v79, v79
    v_add_f32 v72, 1.0, v72
    v_add_f32 v73, 1.0, v73
    v_add_f32 v74, 1.0, v74
    v_add_f32 v75, 1.0, v75
    v_add_f32 v76, 1.0, v76
    v_add_f32 v77, 1.0, v77
    v_add_f32 v78, 1.0, v78
    v_add_f32 v79, 1.0, v79
    v_rcp_f32 v72, v72
    v_rcp_f32 v73, v73
    v_rcp_f32 v74, v74
    v_rcp_f32 v75, v75
    v_rcp_f32 v76, v76
    v_rcp_f32 v77, v77
    v_rcp_f32 v78, v78
    v_rcp_f32 v79, v79
    v_mul_f32 v64, v64, v72
    v_mul_f32 v65, v65, v73
    v_mul_f32 v66, v66, v74
    v_mul_f32 v67, v67, v75
    v_mul_f32 v68, v68, v76
    v_mul_f32 v69, v69, v77
    v_mul_f32 v70, v70, v78
    v_mul_f32 v71, v71, v79
    v_lshlrev_b32 v72, 16, v160
    v_and_b32 v73, s60, v160
    v_lshlrev_b32 v74, 16, v161
    v_and_b32 v75, s60, v161
    v_lshlrev_b32 v76, 16, v162
    v_and_b32 v77, s60, v162
    v_lshlrev_b32 v78, 16, v163
    v_and_b32 v79, s60, v163
    s_waitcnt vmcnt(7)
    v_max3_u32 v168, v16, v17, v18
    v_max_u32 v168, v168, v19
    v_cmp_lt_u32 vcc, s38, v168
    s_cbranch_vccnz PK_ozero
    v_mfma_f32_32x32x16_bf16 v[128:143], v[180:183], v[16:19], 0
    v_mfma_f32_32x32x16_bf16 v[144:159], v[184:187], v[16:19], 0
    s_bitset0_b32 s35, 0
PK_om0:
    s_waitcnt vmcnt(6)
    v_max3_u32 v168, v20, v21, v22
    v_max_u32 v168, v168, v23
    v_cmp_lt_u32 vcc, s38, v168
    s_cbranch_vccnz PK_om1
    v_mfma_f32_32x32x16_bf16 v[128:143], v[188:191], v[20:23], v[128:143]
    v_mfma_f32_32x32x16_bf16 v[144:159], v[192:195], v[20:23], v[144:159]
    s_bitset0_b32 s35, 1
PK_om1:
    s_waitcnt vmcnt(5)
    v_max3_u32 v168, v24, v25, v26
    v_max_u32 v168, v168, v27
    v_cmp_lt_u32 vcc, s38, v168
    s_cbranch_vccnz PK_om2
    v_mfma_f32_32x32x16_bf16 v[128:143], v[196:199], v[24:27], v[128:143]
    v_mfma_f32_32x32x16_bf16 v[144:159], v[200:203], v[24:27], v[144:159]
    s_bitset0_b32 s35, 2
PK_om2:
    s_waitcnt vmcnt(4)
    v_max3_u32 v168, v28, v29, v30
    v_max_u32 v168, v168, v31
    v_cmp_lt_u32 vcc, s38, v168
    s_cbranch_vccnz PK_om3
    v_mfma_f32_32x32x16_bf16 v[128:143], v[204:207], v[28:31], v[128:143]
    v_mfma_f32_32x32x16_bf16 v[144:159], v[208:211], v[28:31], v[144:159]
    s_bitset0_b32 s35, 3
PK_om3:
    s_waitcnt vmcnt(3)
    v_max3_u32 v168, v32, v33, v34
    v_max_u32 v168, v168, v35
    v_cmp_lt_u32 vcc, s38, v168
    s_cbranch_vccnz PK_om4
    v_mfma_f32_32x32x16_bf16 v[128:143], v[212:215], v[32:35], v[128:143]
    v_mfma_f32_32x32x16_bf16 v[144:159], v[216:219], v[32:35], v[144:159]
    s_bitset0_b32 s35, 4
PK_om4:
    s_waitcnt vmcnt(2)
    v_max3_u32 v168, v36, v37, v38
    v_max_u32 v168, v168, v39
    v_cmp_lt_u32 vcc, s38, v168
    s_cbranch_vccnz PK_om5
    v_mfma_f32_32x32x16_bf16 v[128:143], v[220:223], v[36:39], v[128:143]
    v_mfma_f32_32x32x16_bf16 v[144:159], v[224:227], v[36:39], v[144:159]
    s_bitset0_b32 s35, 5
PK_om5:
    s_waitcnt vmcnt(1)
    v_max3_u32 v168, v40, v41, v42
    v_max_u32 v168, v168, v43
    v_cmp_lt_u32 vcc, s38, v168
    s_cbranch_vccnz PK_om6
    v_mfma_f32_32x32x16_bf16 v[128:143], v[228:231], v[40:43], v[128:143]
    v_mfma_f32_32x32x16_bf16 v[144:159], v[232:235], v[40:43], v[144:159]
    s_bitset0_b32 s35, 6
PK_om6:
    s_waitcnt vmcnt(0)
    v_max3_u32 v168, v44, v45, v46
    v_max_u32 v168, v168, v47
    v_cmp_lt_u32 vcc, s38, v168
    s_cbranch_vccnz PK_om7
    v_mfma_f32_32x32x16_bf16 v[128:143], v[236:239], v[44:47], v[128:143]
    v_mfma_f32_32x32x16_bf16 v[144:159], v[240:243], v[44:47], v[144:159]
    s_bitset0_b32 s35, 7
PK_om7:
    s_cmp_eq_u32 s35, 0
    s_cbranch_scc1 PK_odone
PK_oloop:
    s_bitcmp1_b32 s35, 0
    s_cbranch_scc0 PK_ol0
    buffer_load_dwordx4 v[16:19], v245, s[40:43], s3 offen offset:0 sc1
PK_ol0:
    s_bitcmp1_b32 s35, 1
    s_cbranch_scc0 PK_ol1
    buffer_load_dwordx4 v[20:23], v245, s[40:43], s3 offen offset:1024 sc1
PK_ol1:
    s_bitcmp1_b32 s35, 2
    s_cbranch_scc0 PK_ol2
    buffer_load_dwordx4 v[24:27], v245, s[40:43], s3 offen offset:2048 sc1
PK_ol2:
    s_bitcmp1_b32 s35, 3
    s_cbranch_scc0 PK_ol3
    buffer_load_dwordx4 v[28:31], v245, s[40:43], s3 offen offset:3072 sc1
PK_ol3:
    s_bitcmp1_b32 s35, 4
    s_cbranch_scc0 PK_ol4
    buffer_load_dwordx4 v[32:35], v245, s[40:43], s10 offen offset:0 sc1
PK_ol4:
    s_bitcmp1_b32 s35, 5
    s_cbranch_scc0 PK_ol5
    buffer_load_dwordx4 v[36:39], v245, s[40:43], s10 offen offset:1024 sc1
PK_ol5:
    s_bitcmp1_b32 s35, 6
    s_cbranch_scc0 PK_ol6
    buffer_load_dwordx4 v[40:43], v245, s[40:43], s10 offen offset:2048 sc1
PK_ol6:
    s_bitcmp1_b32 s35, 7
    s_cbranch_scc0 PK_ol7
    buffer_load_dwordx4 v[44:47], v245, s[40:43], s10 offen offset:3072 sc1
PK_ol7:
    s_sub_u32 s98, s98, 1
    s_cselect_b32 s38, -1, s38
    s_waitcnt vmcnt(0)
    s_bitcmp1_b32 s35, 0
    s_cbranch_scc0 PK_on0
    v_max3_u32 v168, v16, v17, v18
    v_max_u32 v168, v168, v19
    v_cmp_lt_u32 vcc, s38, v168
    s_cbranch_vccnz PK_on0
    v_mfma_f32_32x32x16_bf16 v[128:143], v[180:183], v[16:19], v[128:143]
    v_mfma_f32_32x32x16_bf16 v[144:159], v[184:187], v[16:19], v[144:159]
    s_bitset0_b32 s35, 0
PK_on0:
    s_bitcmp1_b32 s35, 1
    s_cbranch_scc0 PK_on1
    v_max3_u32 v168, v20, v21, v22
    v_max_u32 v168, v168, v23
    v_cmp_lt_u32 vcc, s38, v168
    s_cbranch_vccnz PK_on1
    v_mfma_f32_32x32x16_bf16 v[128:143], v[188:191], v[20:23], v[128:143]
    v_mfma_f32_32x32x16_bf16 v[144:159], v[192:195], v[20:23], v[144:159]
    s_bitset0_b32 s35, 1
PK_on1:
    s_bitcmp1_b32 s35, 2
    s_cbranch_scc0 PK_on2
    v_max3_u32 v168, v24, v25, v26
    v_max_u32 v168, v168, v27
    v_cmp_lt_u32 vcc, s38, v168
    s_cbranch_vccnz PK_on2
    v_mfma_f32_32x32x16_bf16 v[128:143], v[196:199], v[24:27], v[128:143]
    v_mfma_f32_32x32x16_bf16 v[144:159], v[200:203], v[24:27], v[144:159]
    s_bitset0_b32 s35, 2
PK_on2:
    s_bitcmp1_b32 s35, 3
    s_cbranch_scc0 PK_on3
    v_max3_u32 v168, v28, v29, v30
    v_max_u32 v168, v168, v31
    v_cmp_lt_u32 vcc, s38, v168
    s_cbranch_vccnz PK_on3
    v_mfma_f32_32x32x16_bf16 v[128:143], v[204:207], v[28:31], v[128:143]
    v_mfma_f32_32x32x16_bf16 v[144:159], v[208:211], v[28:31], v[144:159]
    s_bitset0_b32 s35, 3
PK_on3:
    s_bitcmp1_b32 s35, 4
    s_cbranch_scc0 PK_on4
    v_max3_u32 v168, v32, v33, v34
    v_max_u32 v168, v168, v35
    v_cmp_lt_u32 vcc, s38, v168
    s_cbranch_vccnz PK_on4
    v_mfma_f32_32x32x16_bf16 v[128:143], v[212:215], v[32:35], v[128:143]
    v_mfma_f32_32x32x16_bf16 v[144:159], v[216:219], v[32:35], v[144:159]
    s_bitset0_b32 s35, 4
PK_on4:
    s_bitcmp1_b32 s35, 5
    s_cbranch_scc0 PK_on5
    v_max3_u32 v168, v36, v37, v38
    v_max_u32 v168, v168, v39
    v_cmp_lt_u32 vcc, s38, v168
    s_cbranch_vccnz PK_on5
    v_mfma_f32_32x32x16_bf16 v[128:143], v[220:223], v[36:39], v[128:143]
    v_mfma_f32_32x32x16_bf16 v[144:159], v[224:227], v[36:39], v[144:159]
    s_bitset0_b32 s35, 5
PK_on5:
    s_bitcmp1_b32 s35, 6
    s_cbranch_scc0 PK_on6
    v_max3_u32 v168, v40, v41, v42
    v_max_u32 v168, v168, v43
    v_cmp_lt_u32 vcc, s38, v168
    s_cbranch_vccnz PK_on6
    v_mfma_f32_32x32x16_bf16 v[128:143], v[228:231], v[40:43], v[128:143]
    v_mfma_f32_32x32x16_bf16 v[144:159], v[232:235], v[40:43], v[144:159]
    s_bitset0_b32 s35, 6
PK_on6:
    s_bitcmp1_b32 s35, 7
    s_cbranch_scc0 PK_on7
    v_max3_u32 v168, v44, v45, v46
    v_max_u32 v168, v168, v47
    v_cmp_lt_u32 vcc, s38, v168
    s_cbranch_vccnz PK_on7
    v_mfma_f32_32x32x16_bf16 v[128:143], v[236:239], v[44:47], v[128:143]
    v_mfma_f32_32x32x16_bf16 v[144:159], v[240:243], v[44:47], v[144:159]
    s_bitset0_b32 s35, 7
PK_on7:
    s_cmp_lg_u32 s35, 0
    s_cbranch_scc1 PK_oloop
PK_odone:
    s_nop 9
    ds_write_b128 v171, v[136:139]
    ds_write_b128 v171, v[140:143] offset:1024
    ds_write_b128 v172, v[144:147]
    ds_write_b128 v172, v[148:151] offset:1024
    ds_write_b128 v173, v[152:155]
    ds_write_b128 v173, v[156:159] offset:1024
    s_waitcnt lgkmcnt(0)
    s_barrier
    ds_read_b128 v[136:139], v170 offset:0
    ds_read_b128 v[140:143], v170 offset:1024
    ds_read_b128 v[144:147], v170 offset:2048
    ds_read_b128 v[148:151], v170 offset:3072
    ds_read_b128 v[152:155], v170 offset:4096
    ds_read_b128 v[156:159], v170 offset:5120
    s_waitcnt lgkmcnt(4)
    v_add_f32 v128, v128, v136
    v_add_f32 v129, v129, v137
    v_add_f32 v130, v130, v138
    v_add_f32 v131, v131, v139
    v_add_f32 v132, v132, v140
    v_add_f32 v133, v133, v141
    v_add_f32 v134, v134, v142
    v_add_f32 v135, v135, v143
    s_waitcnt lgkmcnt(2)
    v_add_f32 v128, v128, v144
    v_add_f32 v129, v129, v145
    v_add_f32 v130, v130, v146
    v_add_f32 v131, v131, v147
    v_add_f32 v132, v132, v148
    v_add_f32 v133, v133, v149
    v_add_f32 v134, v134, v150
    v_add_f32 v135, v135, v151
    s_waitcnt lgkmcnt(0)
    v_add_f32 v128, v128, v152
    v_add_f32 v129, v129, v153
    v_add_f32 v130, v130, v154
    v_add_f32 v131, v131, v155
    v_add_f32 v132, v132, v156
    v_add_f32 v133, v133, v157
    v_add_f32 v134, v134, v158
    v_add_f32 v135, v135, v159
    v_fma_f32 v128, v128, v64, v72
    v_fma_f32 v129, v129, v65, v73
    v_fma_f32 v130, v130, v66, v74
    v_fma_f32 v131, v131, v67, v75
    v_fma_f32 v132, v132, v68, v76
    v_fma_f32 v133, v133, v69, v77
    v_fma_f32 v134, v134, v70, v78
    v_fma_f32 v135, v135, v71, v79
    v_cvt_pk_bf16_f32 v128, v128, v129
    v_cvt_pk_bf16_f32 v129, v130, v131
    v_cvt_pk_bf16_f32 v130, v132, v133
    v_cvt_pk_bf16_f32 v131, v134, v135
    buffer_store_dwordx4 v[128:131], v248, s[12:15], s39 offen
PK_end:
    s_endpgm
PK_ozero:
    v_mov_b32 v128, 0
    v_mov_b32 v129, 0
    v_mov_b32 v130, 0
    v_mov_b32 v131, 0
    v_mov_b32 v132, 0
    v_mov_b32 v133, 0
    v_mov_b32 v134, 0
    v_mov_b32 v135, 0
    v_mov_b32 v136, 0
    v_mov_b32 v137, 0
    v_mov_b32 v138, 0
    v_mov_b32 v139, 0
    v_mov_b32 v140, 0
    v_mov_b32 v141, 0
    v_mov_b32 v142, 0
    v_mov_b32 v143, 0
    v_mov_b32 v144, 0
    v_mov_b32 v145, 0
    v_mov_b32 v146, 0
    v_mov_b32 v147, 0
    v_mov_b32 v148, 0
    v_mov_b32 v149, 0
    v_mov_b32 v150, 0
    v_mov_b32 v151, 0
    v_mov_b32 v152, 0
    v_mov_b32 v153, 0
    v_mov_b32 v154, 0
    v_mov_b32 v155, 0
    v_mov_b32 v156, 0
    v_mov_b32 v157, 0
    v_mov_b32 v158, 0
    v_mov_b32 v159, 0
    s_branch PK_om0
PK_slow:
    s_add_u32 s32, s99, s31
    s_lshl_b32 s32, s32, 10
    s_lshl_b32 s33, s27, 16
    s_add_u32 s32, s32, s33
    buffer_load_dwordx4 v[80:83], v245, s[40:43], s32 offen sc1
    s_mov_b32 s33, 0
    s_mov_b32 s35, 64
    v_mov_b32 v165, 0xff800000
    v_and_b32 v164, 27, v247
    v_cmp_eq_u32 vcc, 16, v164
    v_mov_b32 v164, s62
    s_nop 0
    v_cndmask_b32 v124, 0, v164, vcc
    v_mov_b32 v125, v124
    v_mov_b32 v126, v124
    v_mov_b32 v127, v124
    v_mov_b32 v128, v124
    v_mov_b32 v129, v124
    v_mov_b32 v130, v124
    v_mov_b32 v131, v124
PK_slow1:
    buffer_load_dwordx4 v[84:87], v245, s[44:47], s33 offen sc1
    s_add_u32 s33, s33, 1024
    s_waitcnt vmcnt(0)
    v_mfma_f32_32x32x16_bf16 v[64:79], v[84:87], v[80:83], 0
    s_nop 11
    v_max3_f32 v165, v165, v64, v65
    v_max3_f32 v165, v165, v66, v67
    v_max3_f32 v165, v165, v68, v69
    v_max3_f32 v165, v165, v70, v71
    v_max3_f32 v165, v165, v72, v73
    v_max3_f32 v165, v165, v74, v75
    v_max3_f32 v165, v165, v76, v77
    v_max3_f32 v165, v165, v78, v79
    s_sub_u32 s35, s35, 1
    s_cmp_lg_u32 s35, 0
    s_cbranch_scc1 PK_slow1
    v_mov_b32 v164, v165
    s_nop 1
    v_permlane32_swap_b32 v165, v164
    v_max_f32 v165, v165, v164
    s_mov_b32 s33, 0
    s_mov_b32 s35, 64
    v_mov_b32 v0, 0
    v_mov_b32 v1, 0
    v_mov_b32 v2, 0
    v_mov_b32 v3, 0
    v_mov_b32 v4, 0
    v_mov_b32 v5, 0
    v_mov_b32 v6, 0
    v_mov_b32 v7, 0
    v_mov_b32 v8, 0
    v_mov_b32 v9, 0
    v_mov_b32 v10, 0
    v_mov_b32 v11, 0
    v_mov_b32 v12, 0
    v_mov_b32 v13, 0
    v_mov_b32 v14, 0
    v_mov_b32 v15, 0
PK_slow2:
    buffer_load_dwordx4 v[84:87], v245, s[44:47], s33 offen sc1
    s_mov_b64 exec, s[96:97]
    buffer_load_dwordx4 v[124:127], v246, s[48:51], s33 offen offset:0 sc1
    buffer_load_dwordx4 v[128:131], v246, s[48:51], s33 offen offset:512 sc1
    s_mov_b64 exec, -1
    s_add_u32 s33, s33, 1024
    s_waitcnt vmcnt(0)
    v_mfma_f32_32x32x16_bf16 v[64:79], v[84:87], v[80:83], 0
    s_nop 11
    v_sub_f32 v64, v64, v165
    v_sub_f32 v65, v65, v165
    v_sub_f32 v66, v66, v165
    v_sub_f32 v67, v67, v165
    v_sub_f32 v68, v68, v165
    v_sub_f32 v69, v69, v165
    v_sub_f32 v70, v70, v165
    v_sub_f32 v71, v71, v165
    v_sub_f32 v72, v72, v165
    v_sub_f32 v73, v73, v165
    v_sub_f32 v74, v74, v165
    v_sub_f32 v75, v75, v165
    v_sub_f32 v76, v76, v165
    v_sub_f32 v77, v77, v165
    v_sub_f32 v78, v78, v165
    v_sub_f32 v79, v79, v165
    v_exp_f32 v64, v64
    v_exp_f32 v65, v65
    v_exp_f32 v66, v66
    v_exp_f32 v67, v67
    v_exp_f32 v68, v68
    v_exp_f32 v69, v69
    v_exp_f32 v70, v70
    v_exp_f32 v71, v71
    v_exp_f32 v72, v72
    v_exp_f32 v73, v73
    v_exp_f32 v74, v74
    v_exp_f32 v75, v75
    v_exp_f32 v76, v76
    v_exp_f32 v77, v77
    v_exp_f32 v78, v78
    v_exp_f32 v79, v79
    s_nop 1
    v_smfmac_f32_32x32x32_bf16 v[0:15], v[124:127], v[64:71], v244
    v_smfmac_f32_32x32x32_bf16 v[0:15], v[128:131], v[72:79], v244
    s_sub_u32 s35, s35, 1
    s_cmp_lg_u32 s35, 0
    s_cbranch_scc1 PK_slow2
    s_nop 11
    s_branch PK_store
PK_codeend:
.section .rodata,"a"
.p2align 6
.amdhsa_kernel recurrent_scan__mha_block__swiglu_ffn__prompt_kernel
  .amdhsa_next_free_vgpr 256
  .amdhsa_next_free_sgpr 102
  .amdhsa_accum_offset 256
  .amdhsa_group_segment_fixed_size 0
  .amdhsa_kernarg_size 80
  .amdhsa_user_sgpr_count 2
  .amdhsa_user_sgpr_kernarg_segment_ptr 1
  .amdhsa_system_sgpr_workgroup_id_x 1
.end_amdhsa_kernel
```
